```python
import torch

def _softmax(x, axis=-1):
    return torch.softmax(x, dim=axis)
def _gelu(x):
    return torch.nn.functional.gelu(x, approximate="tanh")
def _silu(x):
    return torch.nn.functional.silu(x)
def _sigmoid(x):
    return torch.sigmoid(x)
def _layernorm(x, axis=-1, eps=1e-5):
    m = x.mean(dim=axis, keepdim=True)
    v = x.var(dim=axis, keepdim=True, unbiased=False)
    return (x - m) / torch.sqrt(v + eps)
def _scatter_add(tgt, idx, src, axis=0):
    return tgt.clone().index_add_(axis, idx, src)
def _segment_sum(src, seg, n):
    out = torch.zeros((n,) + src.shape[1:], dtype=src.dtype)
    return out.index_add_(0, seg, src)
def _pad(x, pw):
    flat = tuple(v for pair in reversed(pw) for v in pair)
    return torch.nn.functional.pad(x, flat)

kernel_name = 'sequential_preLN__ssm_conv_s4d__geglu_ffn__prompt'

def setup_inputs():

    _w = (lambda a: (lambda t: t.to(torch.bfloat16) if t.is_floating_point() else t)(torch.as_tensor(a)))
    def _A_setup():
        Bsz, L, D, N = 1, 2048, 512, 128
        return {
            "u": _w((lambda *s: torch.randn(*s, dtype=torch.bfloat16) * 0.05)(Bsz, L, D)),
            "log_A_real": _w((lambda *s: torch.randn(*s, dtype=torch.bfloat16) * 6.4)(D, N) * 0.5),
            "A_imag": _w((lambda *s: torch.randn(*s, dtype=torch.bfloat16) * 0.05)(D, N) * 3.14),
            "C_real": _w((lambda *s: torch.randn(*s, dtype=torch.bfloat16) * 0.05)(D, N) / N ** 0.5),
            "C_imag": _w((lambda *s: torch.randn(*s, dtype=torch.bfloat16) * 0.05)(D, N) / N ** 0.5),
            "log_dt": _w((lambda *s: torch.randn(*s, dtype=torch.bfloat16) * 0.05)(D) * 0.5 - 4.0),
            "D_skip": _w((lambda *s: torch.randn(*s, dtype=torch.bfloat16) * 0.05)(D)),
        }
    _A_in = _A_setup()

    def _B_setup():
        B, S, D, F = 1, 2048, 512, 1376
        return {
            "x": _w((lambda *s: torch.randn(*s, dtype=torch.bfloat16) * 0.05)(B, S, D)),
            "w_gate": _w((lambda *s: torch.randn(*s, dtype=torch.bfloat16) * 0.05)(D, F)),
            "w_up": _w((lambda *s: torch.randn(*s, dtype=torch.bfloat16) * 0.05)(D, F)),
            "w_down": _w((lambda *s: torch.randn(*s, dtype=torch.bfloat16) * 0.05)(F, D)),
        }
    _B_in = _B_setup()

    return {
        "A_u": _A_in["u"],
        "A_log_A_real": _A_in["log_A_real"],
        "A_A_imag": _A_in["A_imag"],
        "A_C_real": _A_in["C_real"],
        "A_C_imag": _A_in["C_imag"],
        "A_log_dt": _A_in["log_dt"],
        "A_D_skip": _A_in["D_skip"],
        "B_x": _B_in["x"],
        "B_w_gate": _B_in["w_gate"],
        "B_w_up": _B_in["w_up"],
        "B_w_down": _B_in["w_down"],
    }

def reference(A_u, A_log_A_real, A_A_imag, A_C_real, A_C_imag, A_log_dt, A_D_skip, B_x, B_w_gate, B_w_up, B_w_down):
    def _A_ref(u, log_A_real, A_imag, C_real, C_imag, log_dt, D_skip):
        L = u.shape[1]
        dt = torch.exp(log_dt)
        A = -torch.exp(log_A_real) + 1j * A_imag
        C = (C_real + 1j * C_imag) * dt[:, None]
        pos = (lambda x, dt: x.to(dt))(torch.arange(L), log_dt.dtype)
        P = torch.exp((A * dt[:, None])[:, :, None] * pos[None, None, :])
        K = 2.0 * torch.einsum("dn,dnl->dl", C, P).real
        L2 = 2 * L
        u_t = (lambda x, *d: x.permute(*d))(u, 0, 2, 1)
        Kf = (lambda x, *a, **k: torch.fft.rfft(x.float(), *a, **k))(K, L2)
        Uf = (lambda x, *a, **k: torch.fft.rfft(x.float(), *a, **k))(u_t, L2)
        y = (lambda x, *a, **k: torch.fft.irfft(x, *a, **k).to(torch.bfloat16))(Uf * Kf[None, :, :], L2)[:, :, :L]
        y = (lambda x, *d: x.permute(*d))(y, 0, 2, 1)
        return y + u * D_skip[None, None, :]

    def _B_ref(x, w_gate, w_up, w_down):
        return (_gelu(x @ w_gate) * (x @ w_up)) @ w_down

    x = A_u
    h = x + _A_ref(_layernorm(x, axis=-1), A_log_A_real, A_A_imag, A_C_real, A_C_imag, A_log_dt, A_D_skip)
    h2 = h + _B_ref(_layernorm(h, axis=-1), B_w_gate, B_w_up, B_w_down)
    return h2
```

```asm
; @launch grid=(256,1,1) block=(256,1,1) lds=163840
.amdgcn_target "amdgcn-amd-amdhsa--gfx950"
.text
.globl sequential_preLN__ssm_conv_s4d__geglu_ffn__prompt_kernel
.p2align 8
.type sequential_preLN__ssm_conv_s4d__geglu_ffn__prompt_kernel,@function
sequential_preLN__ssm_conv_s4d__geglu_ffn__prompt_kernel:
    s_cmp_ge_u32 s2, 256
    s_cbranch_scc1 L_end
    s_load_dwordx16 s[16:31], s[0:1], 0
    s_load_dwordx8 s[32:39], s[0:1], 64
    s_load_dwordx4 s[40:43], s[0:1], 96
    s_getpc_b64 s[96:97]
L_pc:
    s_bfe_u32 s10, s2, 0x30003
    s_lshl_b32 s10, s10, 13
    v_lshrrev_b32 v2, 2, v0
    v_lshl_add_u32 v2, v2, 7, s10
    v_min_u32 v2, L_hot_end-L_pc, v2
    global_load_dword v255, v2, s[96:97]
    v_lshrrev_b32 v2, 6, v0
    v_and_b32 v1, 63, v0
    v_readfirstlane_b32 s3, v2
    v_and_b32 v5, 15, v0
    v_lshrrev_b32 v6, 4, v1
    s_and_b32 s6, s2, 7
    s_lshr_b32 s9, s2, 3
    s_and_b32 s7, s9, 3
    s_lshr_b32 s8, s2, 5
    s_lshl_b32 s13, s6, 5
    s_add_u32 s13, s13, s9
    s_and_b32 s12, s9, 7
    s_lshr_b32 s4, s3, 1
    s_and_b32 s5, s3, 1
    s_lshr_b32 s10, s13, 3
    s_lshl_b32 s10, s10, 1
    s_add_u32 s10, s10, s4
    s_lshl_b32 s10, s10, 8
    s_add_u32 s10, s10, s12
    s_lshl_b32 s10, s10, 1
    s_add_u32 s10, s10, s5
    s_add_u32 s10, s10, 64
    s_lshl_b32 s10, s10, 6
    s_lshl_b32 s11, s6, 3
    s_add_u32 s11, s11, s12
    s_lshl_b32 s11, s11, 2
    s_add_u32 s11, s11, s3
    s_lshl_b32 s11, s11, 2
    s_lshr_b32 s14, s9, 3
    s_add_u32 s11, s11, s14
    s_lshl_b32 s11, s11, 11
    v_lshl_add_u32 v3, v5, 2, s10
    v_lshl_add_u32 v2, v1, 4, s11
    v_lshl_add_u32 v49, v6, 13, v3
    s_lshl_b32 s10, s13, 9
    v_lshl_add_u32 v4, v0, 1, s10
    s_lshl_b32 s11, s13, 2
    s_and_b32 s57, s9, 15
    s_lshr_b32 s58, s13, 4
    s_mul_i32 s62, s58, 88064
    s_mul_i32 s15, s57, 172
    s_add_u32 s62, s62, s15
    s_mul_i32 s15, s5, 192
    s_mul_i32 s63, s3, 3072
    s_add_u32 s63, s63, 138816
    v_add_u32 v16, s15, v1
    v_add_u32 v17, 64, v16
    v_add_u32 v18, 0x80, v16
    v_cmp_gt_u32 vcc, 0x160, v18
    s_movk_i32 s10, 745
    s_movk_i32 s15, 2576
    v_mul_u32_u24 v31, s10, v16
    v_lshrrev_b32 v31, 13, v31
    v_mul_u32_u24 v31, s15, v31
    v_lshl_add_u32 v16, v16, 4, v31
    v_mul_u32_u24 v31, s10, v17
    v_lshrrev_b32 v31, 13, v31
    v_mul_u32_u24 v31, s15, v31
    v_lshl_add_u32 v17, v17, 4, v31
    v_mul_u32_u24 v31, s10, v18
    v_lshrrev_b32 v31, 13, v31
    v_mul_u32_u24 v31, s15, v31
    v_lshl_add_u32 v18, v18, 4, v31
    v_cndmask_b32 v18, 2.0, v18, vcc
    s_mov_b32 s46, 1409024
    s_mov_b32 s47, 0x20000
    s_cmp_ge_u32 s3, 2
    s_waitcnt lgkmcnt(0)
    global_load_ushort v24, v4, s[18:19] nt
    global_load_ushort v25, v4, s[20:21] nt
    global_load_ushort v26, v4, s[22:23] nt
    global_load_ushort v27, v4, s[24:25] nt
    global_load_dword v32, v49, s[16:17] offset:-4096 nt
    global_load_dword v33, v49, s[16:17] offset:-3072 nt
    global_load_dword v34, v49, s[16:17] offset:-2048 nt
    global_load_dword v36, v49, s[16:17] offset:-1024 nt
    global_load_dword v37, v49, s[16:17] offset:0 nt
    global_load_dword v38, v49, s[16:17] offset:1024 nt
    global_load_dword v40, v49, s[16:17] offset:2048 nt
    global_load_dword v41, v49, s[16:17] offset:3072 nt
    global_load_dwordx4 v[8:11], v2, s[16:17] nt
    global_load_dwordx4 v[12:15], v2, s[16:17] offset:1024 nt
    s_load_dword s52, s[42:43], 0
    s_load_dword s53, s[26:27], s11
    s_load_dword s54, s[28:29], s11
    s_cselect_b32 s44, s34, s32
    s_cselect_b32 s45, s35, s33
    s_mov_b32 s32, s62
    s_mov_b32 s33, s63
    s_mov_b32 m0, s33
    s_nop 0
    buffer_load_dwordx4 v16, s[44:47], s32 offen nt lds
    s_add_u32 m0, s33, 1024
    s_nop 0
    buffer_load_dwordx4 v17, s[44:47], s32 offen nt lds
    s_add_u32 m0, s33, 2048
    s_nop 0
    buffer_load_dwordx4 v18, s[44:47], s32 offen nt lds
    s_mov_b32 s48, s36
    s_mov_b32 s49, s37
    s_mov_b32 s50, 1409024
    s_mov_b32 s51, 0x20000
    s_mov_b32 s60, 0xffff0000
    v_and_b32 v2, 15, v1
    v_lshrrev_b32 v3, 4, v1
    s_and_b32 s10, s2, 0xfc
    s_add_u32 s10, s10, s3
    s_mul_i32 s11, s10, 745
    s_lshr_b32 s11, s11, 13
    s_mul_i32 s15, s11, 11
    s_sub_u32 s15, s10, s15
    s_mul_i32 s61, s15, 43
    s_lshr_b32 s61, s61, 7
    s_mul_i32 s62, s61, 3
    s_sub_u32 s62, s15, s62
    s_mul_i32 s61, s61, 24
    s_lshl_b32 s63, s62, 2
    s_cmp_eq_u32 s62, 2
    s_cselect_b32 s63, 16, s63
    s_cselect_b32 s62, 4, 8
    s_add_u32 s61, s61, s63
    v_and_b32 v62, 15, v1
    v_lshrrev_b32 v63, 4, v1
    v_lshrrev_b32 v61, 5, v1
    v_xor_b32 v60, v63, v61
    v_add_u32 v60, s61, v60
    s_mul_i32 s11, s11, 86
    s_and_b32 s15, s2, 3
    s_lshl_b32 s15, s15, 8
    s_lshl_b32 s11, s11, 10
    s_add_u32 s11, s11, s15
    s_cmp_lt_u32 s2, 176
    s_cselect_b32 s63, 86, 0
    v_lshl_add_u32 v64, v62, 4, s11
    s_lshl_b32 s34, s3, 11
    s_add_u32 s34, s34, 151104
    v_lshl_add_u32 v19, v60, 10, v64
    v_cmp_gt_u32 vcc, s63, v60
    v_add_u32 v60, s62, v60
    s_nop 0
    v_cndmask_b32 v19, 2.0, v19, vcc
    v_lshl_add_u32 v20, v60, 10, v64
    v_cmp_gt_u32 vcc, s63, v60
    s_nop 1
    v_cndmask_b32 v20, 2.0, v20, vcc
    s_mov_b32 m0, s34
    s_nop 0
    buffer_load_dwordx4 v19, s[48:51], 0 offen nt lds
    s_add_u32 m0, s34, 1024
    s_nop 0
    buffer_load_dwordx4 v20, s[48:51], 0 offen nt lds
    s_and_b32 s10, s6, 3
    s_lshl_b32 s10, s10, 2
    s_add_u32 s55, s10, s7
    s_lshr_b32 s10, s6, 2
    s_lshl_b32 s10, s10, 3
    s_add_u32 s56, s10, s8
    v_accvgpr_write_b32 a240, -1
    v_accvgpr_write_b32 a241, -1
    v_accvgpr_write_b32 a242, -1
    v_accvgpr_write_b32 a243, -1
    s_lshl_b32 s10, s12, 1
    s_add_u32 s10, s10, s5
    s_lshl_b32 s10, s10, 6
    s_lshr_b32 s11, s6, 1
    s_add_u32 s10, s10, s11
    s_mul_i32 s10, s10, 3072
    s_bfe_u32 s11, s13, 0x30003
    s_lshl_b32 s11, s11, 1
    s_add_u32 s11, s11, s4
    s_lshl_b32 s11, s11, 6
    s_add_u32 s10, s10, s11
    s_add_u32 s10, s10, 1048576
    v_lshl_add_u32 v28, v6, 4, s10
    v_mul_u32_u24 v29, 12288, v5
    v_add_u32 v28, v28, v29
    s_lshr_b32 s11, s6, 1
    s_lshl_b32 s11, s11, 2
    s_lshr_b32 s14, s9, 3
    s_add_u32 s11, s11, s14
    s_lshl_b32 s11, s11, 1
    s_and_b32 s14, s6, 1
    s_add_u32 s11, s11, s14
    s_lshl_b32 s11, s11, 3
    s_add_u32 s11, s11, s12
    s_lshl_b32 s11, s11, 6
    s_add_u32 s11, s11, 4096
    v_lshl_add_u32 v48, v1, 2, s11
    s_lshr_b32 s15, s13, 1
    s_lshl_b32 s15, s15, 7
    s_add_u32 s14, s15, 294784
    s_lshl_b32 s15, s13, 6
    s_add_u32 s15, s15, 262080
    v_mov_b32 v60, s14
    v_mov_b32 v61, s15
    v_cmp_gt_u32 vcc, 8, v1
    s_nop 1
    v_cndmask_b32 v60, v60, v61, vcc
    v_lshl_add_u32 v7, v1, 4, v60
    s_lshl_b32 s10, s3, 18
    s_lshl_b32 s15, s13, 7
    s_add_u32 s10, s10, s15
    s_add_u32 s10, s10, 5242880
    v_and_b32 v60, 7, v1
    v_lshl_add_u32 v60, v60, 4, s10
    v_lshrrev_b32 v61, 3, v1
    v_lshl_add_u32 v218, v61, 15, v60
    v_add_u32 v219, 0x100000, v218
    s_lshl_b32 s10, s13, 2
    s_add_u32 s10, s10, s3
    s_mul_i32 s10, s10, 3072
    s_add_u32 s10, s10, 1048576
    s_lshl_b32 s11, s3, 12
    s_add_u32 s11, s11, 4096
    v_lshl_add_u32 v4, v1, 4, s10
    v_lshl_add_u32 v5, v1, 4, s11
    s_lshr_b32 s98, s13, 4
    s_mul_i32 s10, s4, 34816
    s_lshl_b32 s11, s5, 8
    s_add_u32 s99, s10, s11
    s_mul_i32 s10, s57, 11
    s_mul_i32 s11, s3, 3
    s_add_u32 s10, s10, s11
    s_lshl_b32 s10, s10, 4
    s_add_u32 s10, s10, s58
    s_lshl_b32 s11, s10, 10
    s_add_u32 s11, s11, 7340032
    s_and_b32 s57, s9, 7
    s_bfe_u32 s58, s9, 0x10003
    v_lshl_add_u32 v220, v1, 4, s11
    v_add_u32 v221, 0x4000, v220
    v_add_u32 v222, 0x8000, v220
    s_lshl_b32 s10, s10, 6
    s_add_u32 s10, s10, 65536
    v_lshl_add_u32 v223, v1, 2, s10
    s_lshl_b32 s10, s2, 2
    s_add_u32 s10, s10, s3
    s_lshl_b32 s10, s10, 7
    s_add_u32 s10, s10, 327680
    v_lshl_add_u32 v60, v1, 4, s10
    v_lshl_add_u32 v61, v1, 2, s10
    v_add_u32 v45, 2048, v223
    s_cmp_lg_u32 s3, 1
    s_cselect_b64 vcc, -1, 0
    v_cndmask_b32 v48, v48, v61, vcc
    s_cmp_eq_u32 s3, 3
    s_cselect_b64 vcc, -1, 0
    s_cselect_b64 s[0:1], 0xff, -1
    s_cselect_b32 s30, 0xf000f000, 0
    s_mov_b32 s31, s30
    v_cndmask_b32 v222, v222, v60, vcc
    v_cndmask_b32 v45, v45, v61, vcc
    v_lshrrev_b32 v61, 2, v1
    v_mul_u32_u24 v61, 176, v61
    v_and_b32 v62, 1, v1
    v_mul_u32_u24 v62, 6144, v62
    v_bfe_u32 v63, v1, 1, 1
    v_lshl_add_u32 v61, v63, 3, v61
    s_mul_i32 s10, s3, 48
    s_add_u32 s10, s10, 138816
    v_add3_u32 v46, v61, v62, s10
    v_mov_b32 v228, 0x3f803f80
    v_mov_b32 v229, v228
    v_mov_b32 v230, v228
    v_mov_b32 v231, v228
    v_mul_u32_u24 v211, 544, v2
    v_lshl_add_u32 v211, v3, 4, v211
    s_mul_i32 s10, s4, 34816
    v_add_u32 v211, s10, v211
    s_mul_i32 s14, s4, 3872
    s_add_u32 s14, s14, 131072
    s_add_u32 s10, s14, 16
    v_mul_u32_u24 v60, 68, v2
    v_lshl_add_u32 v60, v3, 4, v60
    v_add_u32 v212, s10, v60
    v_mul_u32_u24 v60, 36, v2
    v_lshl_add_u32 v60, v3, 4, v60
    v_add_u32 v60, 1104, v60
    s_lshl_b32 s10, s5, 3
    s_sub_u32 s10, 20, s10
    s_add_u32 s11, s5, 4
    v_lshl_add_u32 v61, v3, s11, v2
    v_mul_u32_u24 v61, s10, v61
    s_mul_i32 s10, s5, 1280
    s_add_u32 s10, s10, 1040
    v_add_u32 v61, s10, v61
    s_lshl_b32 s11, s5, 1
    s_sub_u32 s11, 2, s11
    v_cmp_gt_u32 vcc, s11, v3
    s_nop 1
    v_cndmask_b32 v60, v61, v60, vcc
    v_add_u32 v213, s14, v60
    s_mul_i32 s10, s4, 12544
    s_add_u32 s10, s10, 69632
    v_lshl_add_u32 v214, v0, 5, s10
    v_bfe_u32 v60, v1, 2, 2
    v_lshl_add_u32 v60, v3, 3, v60
    v_and_b32 v61, 3, v1
    s_lshl_b32 s10, s3, 6
    s_add_u32 s10, s10, 151104
    v_lshl_add_u32 v61, v61, 3, s10
    v_lshl_add_u32 v216, v60, 8, v61
    s_mul_i32 s10, s3, 4608
    s_add_u32 s10, s10, 104448
    v_and_b32 v60, 31, v1
    v_lshl_add_u32 v60, v60, 4, s10
    v_and_b32 v62, 1, v1
    v_bfe_u32 v61, v1, 1, 3
    v_mul_u32_u24 v61, 4160, v61
    v_lshl_add_u32 v61, v62, 4, v61
    v_add_u32 v61, 73728, v61
    v_mul_u32_u24 v62, 3872, v62
    v_add_u32 v62, 131072, v62
    v_cmp_gt_u32 vcc, 0xc0, v0
    s_nop 1
    v_cndmask_b32 v61, v62, v61, vcc
    v_cmp_gt_u32 vcc, 0x80, v0
    s_nop 1
    v_cndmask_b32 v217, v61, v60, vcc
    v_mov_b32 v56, 0
    v_mov_b32 v57, 0
    v_mov_b32 v58, 0
    v_mov_b32 v59, 0
    v_mov_b32 v108, 0
    v_mov_b32 v109, 0
    v_mov_b32 v110, 0
    v_mov_b32 v111, 0
    s_waitcnt lgkmcnt(0)
    s_add_u32 s52, s52, 0x9e3779b9
    v_mov_b32 v35, s52
    v_mov_b32 v39, s52
    v_mov_b32 v43, s52
    v_mov_b32 v42, 0
    v_mov_b32 v55, s52
    v_mov_b32 v227, s52
    s_lshl_b32 s14, s53, 16
    s_and_b32 s15, s53, s60
    s_cmp_ge_u32 s3, 2
    s_cselect_b32 s14, s15, s14
    s_mov_b32 s15, 0x3fb8aa3b
    v_mov_b32 v66, s14
    v_mul_f32 v67, s15, v66
    v_fma_f32 v68, v66, s15, -v67
    v_exp_f32 v67, v67
    v_fmac_f32 v68, 0x32a57060, v66
    v_mul_f32 v68, 0x3f317218, v68
    v_fma_f32 v67, v67, v68, v67
    v_and_b32 v47, 7, v1
    v_lshlrev_b32 v47, 5, v47
    s_mov_b32 m0, s99
    s_waitcnt vmcnt(18)
    v_lshlrev_b32 v24, 16, v24
    s_waitcnt vmcnt(17)
    v_lshlrev_b32 v25, 16, v25
    s_waitcnt vmcnt(16)
    v_lshlrev_b32 v26, 16, v26
    s_waitcnt vmcnt(15)
    v_lshlrev_b32 v27, 16, v27
    v_mul_f32 v232, s15, v24
    v_fma_f32 v233, v24, s15, -v232
    v_exp_f32 v232, v232
    v_fmac_f32 v233, 0x32a57060, v24
    v_mul_f32 v233, 0x3f317218, v233
    v_fma_f32 v232, v232, v233, v232
    v_cvt_pk_bf16_f32 v232, v232, v67
    v_and_b32 v234, s60, v232
    v_lshlrev_b32 v232, 16, v232
    v_mul_f32 v232, v232, v234
    v_mul_f32 v232, -s15, v232
    v_mul_f32 v233, v25, v234
    v_mul_f32 v233, 0.15915494, v233
    v_add_f32 v234, v234, v234
    v_mul_f32 v236, v26, v234
    v_mul_f32 v237, v27, v234
    v_fract_f32 v241, v233
    v_exp_f32 v240, v232
    v_cos_f32 v62, v241
    v_sin_f32 v63, v241
    s_nop 0
    v_pk_mul_f32 v[62:63], v[62:63], v[240:241] op_sel_hi:[1,0]
    v_mul_f32 v240, 0x41800000, v232
    v_mul_f32 v241, 0x41800000, v233
    v_fract_f32 v241, v241
    v_exp_f32 v240, v240
    v_cos_f32 v238, v241
    v_sin_f32 v239, v241
    s_nop 0
    v_pk_mul_f32 v[238:239], v[238:239], v[240:241] op_sel_hi:[1,0]
    v_mul_f32 v240, 0x43800000, v232
    v_mul_f32 v241, 0x43800000, v233
    v_fract_f32 v241, v241
    v_exp_f32 v240, v240
    v_cos_f32 v92, v241
    v_sin_f32 v93, v241
    s_nop 0
    v_pk_mul_f32 v[92:93], v[92:93], v[240:241] op_sel_hi:[1,0]
    v_mov_b32 v128, 0x3f80
    v_cvt_pk_bf16_f32 v129, v236, -v237
    v_cvt_pk_bf16_f32 v130, v62, v63
    v_cvt_pk_bf16_f32 v131, v92, v93
    v_pk_mul_f32 v[240:241], v[236:237], v[238:239] op_sel:[0,0] op_sel_hi:[0,1]
    v_pk_fma_f32 v[236:237], v[236:237], v[238:239], v[240:241] op_sel:[1,1,0] op_sel_hi:[1,0,1] neg_lo:[1,0,0]
    v_cvt_pk_bf16_f32 v132, v236, -v237
    v_pk_mul_f32 v[240:241], v[236:237], v[238:239] op_sel:[0,0] op_sel_hi:[0,1]
    v_pk_fma_f32 v[236:237], v[236:237], v[238:239], v[240:241] op_sel:[1,1,0] op_sel_hi:[1,0,1] neg_lo:[1,0,0]
    v_cvt_pk_bf16_f32 v133, v236, -v237
    v_pk_mul_f32 v[240:241], v[62:63], v[62:63] op_sel:[0,0] op_sel_hi:[0,1]
    v_pk_fma_f32 v[64:65], v[62:63], v[62:63], v[240:241] op_sel:[1,1,0] op_sel_hi:[1,0,1] neg_lo:[1,0,0]
    v_cvt_pk_bf16_f32 v134, v64, v65
    v_pk_mul_f32 v[240:241], v[92:93], v[92:93] op_sel:[0,0] op_sel_hi:[0,1]
    v_pk_fma_f32 v[94:95], v[92:93], v[92:93], v[240:241] op_sel:[1,1,0] op_sel_hi:[1,0,1] neg_lo:[1,0,0]
    v_cvt_pk_bf16_f32 v135, v94, v95
    v_pk_mul_f32 v[240:241], v[92:93], v[64:65] op_sel:[0,0] op_sel_hi:[0,1]
    v_pk_fma_f32 v[242:243], v[92:93], v[64:65], v[240:241] op_sel:[1,1,0] op_sel_hi:[1,0,1] neg_lo:[1,0,0]
    v_cvt_pk_bf16_f32 v136, v242, v243
    v_pk_mul_f32 v[240:241], v[236:237], v[238:239] op_sel:[0,0] op_sel_hi:[0,1]
    v_pk_fma_f32 v[236:237], v[236:237], v[238:239], v[240:241] op_sel:[1,1,0] op_sel_hi:[1,0,1] neg_lo:[1,0,0]
    v_cvt_pk_bf16_f32 v137, v236, -v237
    v_pk_mul_f32 v[240:241], v[64:65], v[62:63] op_sel:[0,0] op_sel_hi:[0,1]
    v_pk_fma_f32 v[66:67], v[64:65], v[62:63], v[240:241] op_sel:[1,1,0] op_sel_hi:[1,0,1] neg_lo:[1,0,0]
    v_cvt_pk_bf16_f32 v138, v66, v67
    v_pk_mul_f32 v[240:241], v[94:95], v[92:93] op_sel:[0,0] op_sel_hi:[0,1]
    v_pk_fma_f32 v[96:97], v[94:95], v[92:93], v[240:241] op_sel:[1,1,0] op_sel_hi:[1,0,1] neg_lo:[1,0,0]
    v_cvt_pk_bf16_f32 v139, v96, v97
    ds_write_addtid_b32 v129 offset:0
    ds_write_addtid_b32 v132 offset:544
    ds_write_addtid_b32 v133 offset:1088
    ds_write_addtid_b32 v137 offset:1632
    ds_write_addtid_b32 v128 offset:8704
    ds_write_addtid_b32 v130 offset:9248
    ds_write_addtid_b32 v134 offset:9792
    ds_write_addtid_b32 v138 offset:10336
    ds_write_addtid_b32 v131 offset:17408
    ds_write_addtid_b32 v136 offset:17952
    ds_write_addtid_b32 v135 offset:21760
    ds_write_addtid_b32 v139 offset:23936
    v_pk_mul_f32 v[240:241], v[236:237], v[238:239] op_sel:[0,0] op_sel_hi:[0,1]
    v_pk_fma_f32 v[236:237], v[236:237], v[238:239], v[240:241] op_sel:[1,1,0] op_sel_hi:[1,0,1] neg_lo:[1,0,0]
    v_cvt_pk_bf16_f32 v140, v236, -v237
    v_pk_mul_f32 v[240:241], v[66:67], v[62:63] op_sel:[0,0] op_sel_hi:[0,1]
    v_pk_fma_f32 v[68:69], v[66:67], v[62:63], v[240:241] op_sel:[1,1,0] op_sel_hi:[1,0,1] neg_lo:[1,0,0]
    v_cvt_pk_bf16_f32 v141, v68, v69
    v_pk_mul_f32 v[240:241], v[96:97], v[92:93] op_sel:[0,0] op_sel_hi:[0,1]
    v_pk_fma_f32 v[98:99], v[96:97], v[92:93], v[240:241] op_sel:[1,1,0] op_sel_hi:[1,0,1] neg_lo:[1,0,0]
    v_cvt_pk_bf16_f32 v142, v98, v99
    v_pk_mul_f32 v[240:241], v[92:93], v[68:69] op_sel:[0,0] op_sel_hi:[0,1]
    v_pk_fma_f32 v[242:243], v[92:93], v[68:69], v[240:241] op_sel:[1,1,0] op_sel_hi:[1,0,1] neg_lo:[1,0,0]
    v_cvt_pk_bf16_f32 v143, v242, v243
    v_pk_mul_f32 v[240:241], v[94:95], v[68:69] op_sel:[0,0] op_sel_hi:[0,1]
    v_pk_fma_f32 v[242:243], v[94:95], v[68:69], v[240:241] op_sel:[1,1,0] op_sel_hi:[1,0,1] neg_lo:[1,0,0]
    v_cvt_pk_bf16_f32 v144, v242, v243
    v_pk_mul_f32 v[240:241], v[96:97], v[68:69] op_sel:[0,0] op_sel_hi:[0,1]
    v_pk_fma_f32 v[242:243], v[96:97], v[68:69], v[240:241] op_sel:[1,1,0] op_sel_hi:[1,0,1] neg_lo:[1,0,0]
    v_cvt_pk_bf16_f32 v145, v242, v243
    v_pk_mul_f32 v[240:241], v[236:237], v[238:239] op_sel:[0,0] op_sel_hi:[0,1]
    v_pk_fma_f32 v[236:237], v[236:237], v[238:239], v[240:241] op_sel:[1,1,0] op_sel_hi:[1,0,1] neg_lo:[1,0,0]
    v_cvt_pk_bf16_f32 v146, v236, -v237
    v_pk_mul_f32 v[240:241], v[68:69], v[62:63] op_sel:[0,0] op_sel_hi:[0,1]
    v_pk_fma_f32 v[70:71], v[68:69], v[62:63], v[240:241] op_sel:[1,1,0] op_sel_hi:[1,0,1] neg_lo:[1,0,0]
    v_cvt_pk_bf16_f32 v147, v70, v71
    v_pk_mul_f32 v[240:241], v[98:99], v[92:93] op_sel:[0,0] op_sel_hi:[0,1]
    v_pk_fma_f32 v[100:101], v[98:99], v[92:93], v[240:241] op_sel:[1,1,0] op_sel_hi:[1,0,1] neg_lo:[1,0,0]
    v_cvt_pk_bf16_f32 v148, v100, v101
    v_pk_mul_f32 v[240:241], v[236:237], v[238:239] op_sel:[0,0] op_sel_hi:[0,1]
    v_pk_fma_f32 v[236:237], v[236:237], v[238:239], v[240:241] op_sel:[1,1,0] op_sel_hi:[1,0,1] neg_lo:[1,0,0]
    v_cvt_pk_bf16_f32 v149, v236, -v237
    v_pk_mul_f32 v[240:241], v[70:71], v[62:63] op_sel:[0,0] op_sel_hi:[0,1]
    v_pk_fma_f32 v[72:73], v[70:71], v[62:63], v[240:241] op_sel:[1,1,0] op_sel_hi:[1,0,1] neg_lo:[1,0,0]
    v_cvt_pk_bf16_f32 v150, v72, v73
    v_pk_mul_f32 v[240:241], v[100:101], v[92:93] op_sel:[0,0] op_sel_hi:[0,1]
    v_pk_fma_f32 v[102:103], v[100:101], v[92:93], v[240:241] op_sel:[1,1,0] op_sel_hi:[1,0,1] neg_lo:[1,0,0]
    v_cvt_pk_bf16_f32 v151, v102, v103
    v_pk_mul_f32 v[240:241], v[92:93], v[72:73] op_sel:[0,0] op_sel_hi:[0,1]
    v_pk_fma_f32 v[242:243], v[92:93], v[72:73], v[240:241] op_sel:[1,1,0] op_sel_hi:[1,0,1] neg_lo:[1,0,0]
    v_cvt_pk_bf16_f32 v152, v242, v243
    ds_write_addtid_b32 v140 offset:2176
    ds_write_addtid_b32 v146 offset:2720
    ds_write_addtid_b32 v149 offset:3264
    ds_write_addtid_b32 v141 offset:10880
    ds_write_addtid_b32 v147 offset:11424
    ds_write_addtid_b32 v150 offset:11968
    ds_write_addtid_b32 v143 offset:18496
    ds_write_addtid_b32 v152 offset:19040
    ds_write_addtid_b32 v144 offset:22304
    ds_write_addtid_b32 v145 offset:24480
    ds_write_addtid_b32 v142 offset:26112
    ds_write_addtid_b32 v148 offset:27200
    ds_write_addtid_b32 v151 offset:28288
    v_pk_mul_f32 v[240:241], v[236:237], v[238:239] op_sel:[0,0] op_sel_hi:[0,1]
    v_pk_fma_f32 v[236:237], v[236:237], v[238:239], v[240:241] op_sel:[1,1,0] op_sel_hi:[1,0,1] neg_lo:[1,0,0]
    v_cvt_pk_bf16_f32 v153, v236, -v237
    v_pk_mul_f32 v[240:241], v[72:73], v[62:63] op_sel:[0,0] op_sel_hi:[0,1]
    v_pk_fma_f32 v[74:75], v[72:73], v[62:63], v[240:241] op_sel:[1,1,0] op_sel_hi:[1,0,1] neg_lo:[1,0,0]
    v_cvt_pk_bf16_f32 v154, v74, v75
    v_pk_mul_f32 v[240:241], v[102:103], v[92:93] op_sel:[0,0] op_sel_hi:[0,1]
    v_pk_fma_f32 v[104:105], v[102:103], v[92:93], v[240:241] op_sel:[1,1,0] op_sel_hi:[1,0,1] neg_lo:[1,0,0]
    v_cvt_pk_bf16_f32 v155, v104, v105
    s_mov_b32 s10, 0x3f803f80
    s_waitcnt vmcnt(6)
    v_dot2_f32_bf16 v56, v8, s10, v56
    v_dot2_f32_bf16 v57, v8, v8, v57
    s_waitcnt vmcnt(5)
    v_dot2_f32_bf16 v58, v12, s10, v58
    v_dot2_f32_bf16 v59, v12, v12, v59
    v_dot2_f32_bf16 v56, v9, s10, v56
    v_dot2_f32_bf16 v57, v9, v9, v57
    v_dot2_f32_bf16 v58, v13, s10, v58
    v_dot2_f32_bf16 v59, v13, v13, v59
    v_dot2_f32_bf16 v56, v10, s10, v56
    v_dot2_f32_bf16 v57, v10, v10, v57
    v_dot2_f32_bf16 v58, v14, s10, v58
    v_dot2_f32_bf16 v59, v14, v14, v59
    v_dot2_f32_bf16 v56, v11, s10, v56
    v_dot2_f32_bf16 v57, v11, v11, v57
    v_dot2_f32_bf16 v58, v15, s10, v58
    v_dot2_f32_bf16 v59, v15, v15, v59
    s_nop 0
    v_permlane32_swap_b32 v56, v57
    s_nop 0
    v_permlane32_swap_b32 v58, v59
    v_add_f32 v56, v56, v57
    v_add_f32 v58, v58, v59
    s_nop 1
    v_permlane16_swap_b32 v56, v58
    v_add_f32 v56, v56, v58
    s_nop 1
    v_add_f32_dpp v56, v56, v56 row_ror:8 row_mask:0xf bank_mask:0xf
    s_nop 1
    v_add_f32_dpp v56, v56, v56 row_ror:4 row_mask:0xf bank_mask:0xf
    s_nop 1
    v_add_f32_dpp v56, v56, v56 row_ror:2 row_mask:0xf bank_mask:0xf
    s_nop 1
    v_add_f32_dpp v56, v56, v56 row_ror:1 row_mask:0xf bank_mask:0xf
    s_nop 1
    v_permlane32_swap_b32 v56, v57
    v_mul_f32 v56, 0x3b000000, v56
    v_mul_f32 v57, 0x3b000000, v57
    v_fma_f32 v57, -v56, v56, v57
    v_max_f32 v57, 0, v57
    v_cvt_pk_bf16_f32 v56, v56, v57
    v_and_b32 v57, s60, v56
    v_add_f32 v57, 0x3727c5ac, v57
    v_cvt_pk_bf16_f32 v58, v57, v57
    v_and_b32 v57, s60, v58
    v_sqrt_f32 v57, v57
    v_lshlrev_b32 v56, 16, v56
    v_cvt_pk_bf16_f32 v58, v57, v57
    v_and_b32 v57, s60, v58
    v_rcp_f32 v52, v57
    v_readlane_b32 s10, v56, 16
    v_lshrrev_b32 v54, 16, v56
    v_readlane_b32 s11, v52, 16
    v_or_b32 v54, s10, v54
    s_nop 0
    v_mov_b32 v53, s11
    s_lshl_b32 s10, s3, 4
    s_add_u32 s10, s10, 159296
    v_mov_b32 v56, s10
    v_lshlrev_b32 v57, 2, v2
    v_add_u32 v57, 159296, v57
    s_mov_b64 exec, 1
    ds_write_b128 v56, v[52:55]
    s_mov_b64 exec, -1
    v_pk_mul_f32 v[240:241], v[236:237], v[238:239] op_sel:[0,0] op_sel_hi:[0,1]
    v_pk_fma_f32 v[236:237], v[236:237], v[238:239], v[240:241] op_sel:[1,1,0] op_sel_hi:[1,0,1] neg_lo:[1,0,0]
    v_cvt_pk_bf16_f32 v156, v236, -v237
    v_pk_mul_f32 v[240:241], v[74:75], v[62:63] op_sel:[0,0] op_sel_hi:[0,1]
    v_pk_fma_f32 v[76:77], v[74:75], v[62:63], v[240:241] op_sel:[1,1,0] op_sel_hi:[1,0,1] neg_lo:[1,0,0]
    v_cvt_pk_bf16_f32 v157, v76, v77
    v_pk_mul_f32 v[240:241], v[104:105], v[92:93] op_sel:[0,0] op_sel_hi:[0,1]
    v_pk_fma_f32 v[106:107], v[104:105], v[92:93], v[240:241] op_sel:[1,1,0] op_sel_hi:[1,0,1] neg_lo:[1,0,0]
    v_cvt_pk_bf16_f32 v158, v106, v107
    v_pk_mul_f32 v[240:241], v[92:93], v[76:77] op_sel:[0,0] op_sel_hi:[0,1]
    v_pk_fma_f32 v[242:243], v[92:93], v[76:77], v[240:241] op_sel:[1,1,0] op_sel_hi:[1,0,1] neg_lo:[1,0,0]
    v_cvt_pk_bf16_f32 v159, v242, v243
    v_pk_mul_f32 v[240:241], v[94:95], v[76:77] op_sel:[0,0] op_sel_hi:[0,1]
    v_pk_fma_f32 v[242:243], v[94:95], v[76:77], v[240:241] op_sel:[1,1,0] op_sel_hi:[1,0,1] neg_lo:[1,0,0]
    v_cvt_pk_bf16_f32 v128, v242, v243
    v_pk_mul_f32 v[240:241], v[96:97], v[76:77] op_sel:[0,0] op_sel_hi:[0,1]
    v_pk_fma_f32 v[242:243], v[96:97], v[76:77], v[240:241] op_sel:[1,1,0] op_sel_hi:[1,0,1] neg_lo:[1,0,0]
    v_cvt_pk_bf16_f32 v129, v242, v243
    v_pk_mul_f32 v[240:241], v[236:237], v[238:239] op_sel:[0,0] op_sel_hi:[0,1]
    v_pk_fma_f32 v[236:237], v[236:237], v[238:239], v[240:241] op_sel:[1,1,0] op_sel_hi:[1,0,1] neg_lo:[1,0,0]
    v_cvt_pk_bf16_f32 v130, v236, -v237
    v_pk_mul_f32 v[240:241], v[76:77], v[62:63] op_sel:[0,0] op_sel_hi:[0,1]
    v_pk_fma_f32 v[78:79], v[76:77], v[62:63], v[240:241] op_sel:[1,1,0] op_sel_hi:[1,0,1] neg_lo:[1,0,0]
    v_cvt_pk_bf16_f32 v131, v78, v79
    v_pk_mul_f32 v[240:241], v[98:99], v[76:77] op_sel:[0,0] op_sel_hi:[0,1]
    v_pk_fma_f32 v[242:243], v[98:99], v[76:77], v[240:241] op_sel:[1,1,0] op_sel_hi:[1,0,1] neg_lo:[1,0,0]
    v_cvt_pk_bf16_f32 v132, v242, v243
    ds_write_addtid_b32 v153 offset:3808
    ds_write_addtid_b32 v156 offset:4352
    ds_write_addtid_b32 v130 offset:4896
    ds_write_addtid_b32 v154 offset:12512
    ds_write_addtid_b32 v157 offset:13056
    ds_write_addtid_b32 v131 offset:13600
    ds_write_addtid_b32 v159 offset:19584
    ds_write_addtid_b32 v128 offset:22848
    ds_write_addtid_b32 v129 offset:25024
    ds_write_addtid_b32 v132 offset:26656
    ds_write_addtid_b32 v155 offset:29376
    ds_write_addtid_b32 v158 offset:30464
    v_pk_mul_f32 v[240:241], v[236:237], v[238:239] op_sel:[0,0] op_sel_hi:[0,1]
    v_pk_fma_f32 v[236:237], v[236:237], v[238:239], v[240:241] op_sel:[1,1,0] op_sel_hi:[1,0,1] neg_lo:[1,0,0]
    v_cvt_pk_bf16_f32 v133, v236, -v237
    v_pk_mul_f32 v[240:241], v[78:79], v[62:63] op_sel:[0,0] op_sel_hi:[0,1]
    v_pk_fma_f32 v[80:81], v[78:79], v[62:63], v[240:241] op_sel:[1,1,0] op_sel_hi:[1,0,1] neg_lo:[1,0,0]
    v_cvt_pk_bf16_f32 v134, v80, v81
    v_pk_mul_f32 v[240:241], v[92:93], v[80:81] op_sel:[0,0] op_sel_hi:[0,1]
    v_pk_fma_f32 v[242:243], v[92:93], v[80:81], v[240:241] op_sel:[1,1,0] op_sel_hi:[1,0,1] neg_lo:[1,0,0]
    v_cvt_pk_bf16_f32 v135, v242, v243
    v_pk_mul_f32 v[240:241], v[100:101], v[76:77] op_sel:[0,0] op_sel_hi:[0,1]
    v_pk_fma_f32 v[242:243], v[100:101], v[76:77], v[240:241] op_sel:[1,1,0] op_sel_hi:[1,0,1] neg_lo:[1,0,0]
    v_cvt_pk_bf16_f32 v136, v242, v243
    s_waitcnt vmcnt(0)
    s_waitcnt lgkmcnt(0)
    s_barrier
    ds_read_b32 v56, v57
    ds_read_b64_tr_b16 v[112:113], v46 offset:0
    ds_read_b64_tr_b16 v[114:115], v46 offset:2816
    ds_read_b64_tr_b16 v[116:117], v46 offset:16
    ds_read_b64_tr_b16 v[118:119], v46 offset:2832
    ds_read_b64_tr_b16 v[120:121], v46 offset:32
    ds_read_b64_tr_b16 v[122:123], v46 offset:2848
    v_pk_mul_f32 v[240:241], v[236:237], v[238:239] op_sel:[0,0] op_sel_hi:[0,1]
    v_pk_fma_f32 v[236:237], v[236:237], v[238:239], v[240:241] op_sel:[1,1,0] op_sel_hi:[1,0,1] neg_lo:[1,0,0]
    v_cvt_pk_bf16_f32 v137, v236, -v237
    v_pk_mul_f32 v[240:241], v[80:81], v[62:63] op_sel:[0,0] op_sel_hi:[0,1]
    v_pk_fma_f32 v[82:83], v[80:81], v[62:63], v[240:241] op_sel:[1,1,0] op_sel_hi:[1,0,1] neg_lo:[1,0,0]
    v_cvt_pk_bf16_f32 v138, v82, v83
    v_pk_mul_f32 v[240:241], v[102:103], v[76:77] op_sel:[0,0] op_sel_hi:[0,1]
    v_pk_fma_f32 v[242:243], v[102:103], v[76:77], v[240:241] op_sel:[1,1,0] op_sel_hi:[1,0,1] neg_lo:[1,0,0]
    v_cvt_pk_bf16_f32 v139, v242, v243
    s_mov_b32 vcc_lo, 0xc3c3c3c3
    s_mov_b32 vcc_hi, 0xc3c3c3c3
    s_waitcnt lgkmcnt(5)
    v_cndmask_b32_dpp v244, v112, v112, vcc row_half_mirror row_mask:0xf bank_mask:0xf
    v_cndmask_b32_dpp v245, v113, v113, vcc row_half_mirror row_mask:0xf bank_mask:0xf
    s_waitcnt lgkmcnt(4)
    v_cndmask_b32_dpp v246, v114, v114, vcc row_half_mirror row_mask:0xf bank_mask:0xf
    v_cndmask_b32_dpp v247, v115, v115, vcc row_half_mirror row_mask:0xf bank_mask:0xf
    s_waitcnt lgkmcnt(3)
    v_cndmask_b32_dpp v248, v116, v116, vcc row_half_mirror row_mask:0xf bank_mask:0xf
    v_cndmask_b32_dpp v249, v117, v117, vcc row_half_mirror row_mask:0xf bank_mask:0xf
    s_waitcnt lgkmcnt(2)
    v_cndmask_b32_dpp v250, v118, v118, vcc row_half_mirror row_mask:0xf bank_mask:0xf
    v_cndmask_b32_dpp v251, v119, v119, vcc row_half_mirror row_mask:0xf bank_mask:0xf
    s_waitcnt lgkmcnt(1)
    v_cndmask_b32_dpp v252, v120, v120, vcc row_half_mirror row_mask:0xf bank_mask:0xf
    v_cndmask_b32_dpp v253, v121, v121, vcc row_half_mirror row_mask:0xf bank_mask:0xf
    s_waitcnt lgkmcnt(0)
    v_cndmask_b32_dpp v254, v122, v122, vcc row_half_mirror row_mask:0xf bank_mask:0xf
    v_cndmask_b32_dpp v255, v123, v123, vcc row_half_mirror row_mask:0xf bank_mask:0xf
    v_cndmask_b32 v248, v248, v228, s[30:31]
    v_cndmask_b32 v249, v249, v228, s[30:31]
    v_cndmask_b32 v250, v250, v228, s[30:31]
    v_cndmask_b32 v251, v251, v228, s[30:31]
    v_mfma_f32_16x16x32_bf16 v[112:115], v[228:231], v[244:247], 0
    s_nop 0
    v_mfma_f32_16x16x32_bf16 v[116:119], v[228:231], v[248:251], 0
    v_mfma_f32_16x16x32_bf16 v[120:123], v[228:231], v[252:255], 0
    s_mov_b64 exec, 0xffff
    global_store_dword v48, v56, s[42:43] sc1
    s_mov_b64 exec, -1
    global_store_dwordx4 v28, v[32:35], s[42:43] offset:0 sc1
    global_store_dwordx4 v28, v[36:39], s[42:43] offset:1024 sc1
    global_store_dwordx4 v28, v[40:43], s[42:43] offset:2048 sc1
    v_pk_mul_f32 v[240:241], v[236:237], v[238:239] op_sel:[0,0] op_sel_hi:[0,1]
    v_pk_fma_f32 v[236:237], v[236:237], v[238:239], v[240:241] op_sel:[1,1,0] op_sel_hi:[1,0,1] neg_lo:[1,0,0]
    v_cvt_pk_bf16_f32 v140, v236, -v237
    v_pk_mul_f32 v[240:241], v[82:83], v[62:63] op_sel:[0,0] op_sel_hi:[0,1]
    v_pk_fma_f32 v[84:85], v[82:83], v[62:63], v[240:241] op_sel:[1,1,0] op_sel_hi:[1,0,1] neg_lo:[1,0,0]
    v_cvt_pk_bf16_f32 v141, v84, v85
    v_pk_mul_f32 v[240:241], v[92:93], v[84:85] op_sel:[0,0] op_sel_hi:[0,1]
    v_pk_fma_f32 v[242:243], v[92:93], v[84:85], v[240:241] op_sel:[1,1,0] op_sel_hi:[1,0,1] neg_lo:[1,0,0]
    v_cvt_pk_bf16_f32 v142, v242, v243
    v_pk_mul_f32 v[240:241], v[94:95], v[84:85] op_sel:[0,0] op_sel_hi:[0,1]
    v_pk_fma_f32 v[242:243], v[94:95], v[84:85], v[240:241] op_sel:[1,1,0] op_sel_hi:[1,0,1] neg_lo:[1,0,0]
    v_cvt_pk_bf16_f32 v143, v242, v243
    v_pk_mul_f32 v[240:241], v[96:97], v[84:85] op_sel:[0,0] op_sel_hi:[0,1]
    v_pk_fma_f32 v[242:243], v[96:97], v[84:85], v[240:241] op_sel:[1,1,0] op_sel_hi:[1,0,1] neg_lo:[1,0,0]
    v_cvt_pk_bf16_f32 v144, v242, v243
    v_pk_mul_f32 v[240:241], v[104:105], v[76:77] op_sel:[0,0] op_sel_hi:[0,1]
    v_pk_fma_f32 v[242:243], v[104:105], v[76:77], v[240:241] op_sel:[1,1,0] op_sel_hi:[1,0,1] neg_lo:[1,0,0]
    v_cvt_pk_bf16_f32 v145, v242, v243
    ds_write_addtid_b32 v133 offset:5440
    ds_write_addtid_b32 v137 offset:5984
    ds_write_addtid_b32 v140 offset:6528
    ds_write_addtid_b32 v134 offset:14144
    ds_write_addtid_b32 v138 offset:14688
    ds_write_addtid_b32 v141 offset:15232
    ds_write_addtid_b32 v135 offset:20128
    ds_write_addtid_b32 v142 offset:20672
    ds_write_addtid_b32 v143 offset:23392
    ds_write_addtid_b32 v144 offset:25568
    ds_write_addtid_b32 v136 offset:27744
    ds_write_addtid_b32 v139 offset:28832
    ds_write_addtid_b32 v145 offset:29920
    v_cvt_pk_bf16_f32 v113, v112, v112
    v_lshlrev_b32 v114, 16, v113
    v_sub_f32 v114, v112, v114
    v_cvt_pk_bf16_f32 v113, v112, v114
    v_cvt_pk_bf16_f32 v117, v116, v116
    v_lshlrev_b32 v118, 16, v117
    v_sub_f32 v118, v116, v118
    v_cvt_pk_bf16_f32 v117, v116, v118
    v_cvt_pk_bf16_f32 v121, v120, v120
    v_lshlrev_b32 v122, 16, v121
    v_sub_f32 v122, v120, v122
    v_cvt_pk_bf16_f32 v121, v120, v122
    v_pk_mul_f32 v[240:241], v[236:237], v[238:239] op_sel:[0,0] op_sel_hi:[0,1]
    v_pk_fma_f32 v[236:237], v[236:237], v[238:239], v[240:241] op_sel:[1,1,0] op_sel_hi:[1,0,1] neg_lo:[1,0,0]
    v_cvt_pk_bf16_f32 v146, v236, -v237
    v_pk_mul_f32 v[240:241], v[84:85], v[62:63] op_sel:[0,0] op_sel_hi:[0,1]
    v_pk_fma_f32 v[86:87], v[84:85], v[62:63], v[240:241] op_sel:[1,1,0] op_sel_hi:[1,0,1] neg_lo:[1,0,0]
    v_cvt_pk_bf16_f32 v147, v86, v87
    v_pk_mul_f32 v[240:241], v[236:237], v[238:239] op_sel:[0,0] op_sel_hi:[0,1]
    v_pk_fma_f32 v[236:237], v[236:237], v[238:239], v[240:241] op_sel:[1,1,0] op_sel_hi:[1,0,1] neg_lo:[1,0,0]
    v_cvt_pk_bf16_f32 v148, v236, -v237
    v_pk_mul_f32 v[240:241], v[86:87], v[62:63] op_sel:[0,0] op_sel_hi:[0,1]
    v_pk_fma_f32 v[88:89], v[86:87], v[62:63], v[240:241] op_sel:[1,1,0] op_sel_hi:[1,0,1] neg_lo:[1,0,0]
    v_cvt_pk_bf16_f32 v149, v88, v89
    v_pk_mul_f32 v[240:241], v[92:93], v[88:89] op_sel:[0,0] op_sel_hi:[0,1]
    v_pk_fma_f32 v[242:243], v[92:93], v[88:89], v[240:241] op_sel:[1,1,0] op_sel_hi:[1,0,1] neg_lo:[1,0,0]
    v_cvt_pk_bf16_f32 v150, v242, v243
    v_pk_mul_f32 v[240:241], v[236:237], v[238:239] op_sel:[0,0] op_sel_hi:[0,1]
    v_pk_fma_f32 v[236:237], v[236:237], v[238:239], v[240:241] op_sel:[1,1,0] op_sel_hi:[1,0,1] neg_lo:[1,0,0]
    v_cvt_pk_bf16_f32 v151, v236, -v237
    v_pk_mul_f32 v[240:241], v[88:89], v[62:63] op_sel:[0,0] op_sel_hi:[0,1]
    v_pk_fma_f32 v[90:91], v[88:89], v[62:63], v[240:241] op_sel:[1,1,0] op_sel_hi:[1,0,1] neg_lo:[1,0,0]
    v_cvt_pk_bf16_f32 v152, v90, v91
    ds_write_addtid_b32 v146 offset:7072
    ds_write_addtid_b32 v148 offset:7616
    ds_write_addtid_b32 v151 offset:8160
    ds_write_addtid_b32 v147 offset:15776
    ds_write_addtid_b32 v149 offset:16320
    ds_write_addtid_b32 v152 offset:16864
    ds_write_addtid_b32 v150 offset:21216
    global_store_dwordx4 v220, v[244:247], s[42:43] sc1
    ds_write_b128 v217, v[108:111]
    s_waitcnt lgkmcnt(0)
    s_barrier
    s_lshl_b32 s10, s54, 16
    s_and_b32 s11, s54, s60
    s_cmp_ge_u32 s3, 2
    s_cselect_b32 s10, s11, s10
    v_writelane_b32 v108, s10, 0
    s_mul_i32 s14, s4, 3872
    s_add_u32 s14, s14, 131072
    s_bitcmp1_b32 s3, 0
    s_cbranch_scc1 L_km1
    ds_read_b128 v[64:67], v211 offset:0
    ds_read_b128 v[128:131], v211 offset:8704
    ds_read_b128 v[160:163], v211 offset:17408
    ds_read_b128 v[68:71], v211 offset:64
    ds_read_b128 v[132:135], v211 offset:8768
    ds_read_b128 v[164:167], v211 offset:17472
    ds_read_b128 v[72:75], v211 offset:128
    ds_read_b128 v[136:139], v211 offset:8832
    ds_read_b128 v[168:171], v211 offset:17536
    s_waitcnt lgkmcnt(7)
    v_mfma_f32_16x16x32_bf16 v[16:19], v[128:131], v[64:67], v[108:111]
    s_waitcnt lgkmcnt(6)
    ds_read_b128 v[76:79], v211 offset:192
    ds_read_b128 v[140:143], v211 offset:8896
    v_mul_u32_u24 v29, 12, v1
    v_sub_u32 v29, 3060, v29
    v_mfma_f32_16x16x32_bf16 v[20:23], v[160:163], v[64:67], 0
    s_waitcnt lgkmcnt(6)
    ds_read_b128 v[172:175], v211 offset:17600
    v_add_u32 v192, s14, v29
    v_mfma_f32_16x16x32_bf16 v[16:19], v[132:135], v[68:71], v[16:19]
    s_waitcnt lgkmcnt(6)
    ds_read_b128 v[80:83], v211 offset:256
    ds_read_b128 v[144:147], v211 offset:8960
    v_mfma_f32_16x16x32_bf16 v[20:23], v[164:167], v[68:71], v[20:23]
    s_waitcnt lgkmcnt(6)
    ds_read_b128 v[176:179], v211 offset:17664
    v_mfma_f32_16x16x32_bf16 v[16:19], v[136:139], v[72:75], v[16:19]
    s_waitcnt lgkmcnt(6)
    ds_read_b128 v[84:87], v211 offset:320
    ds_read_b128 v[148:151], v211 offset:9024
    global_store_dwordx4 v221, v[248:251], s[42:43] sc1
    v_mfma_f32_16x16x32_bf16 v[20:23], v[168:171], v[72:75], v[20:23]
    s_waitcnt lgkmcnt(6)
    ds_read_b128 v[180:183], v211 offset:17728
    v_mfma_f32_16x16x32_bf16 v[16:19], v[140:143], v[76:79], v[16:19]
    s_waitcnt lgkmcnt(6)
    ds_read_b128 v[88:91], v211 offset:384
    ds_read_b128 v[152:155], v211 offset:9088
    v_mfma_f32_16x16x32_bf16 v[20:23], v[172:175], v[76:79], v[20:23]
    s_waitcnt lgkmcnt(6)
    ds_read_b128 v[184:187], v211 offset:17792
    v_mfma_f32_16x16x32_bf16 v[16:19], v[144:147], v[80:83], v[16:19]
    s_waitcnt lgkmcnt(6)
    ds_read_b128 v[92:95], v211 offset:448
    ds_read_b128 v[156:159], v211 offset:9152
    v_mfma_f32_16x16x32_bf16 v[20:23], v[176:179], v[80:83], v[20:23]
    s_waitcnt lgkmcnt(6)
    ds_read_b128 v[188:191], v211 offset:17856
    v_mfma_f32_16x16x32_bf16 v[16:19], v[148:151], v[84:87], v[16:19]
    s_waitcnt lgkmcnt(6)
    v_mfma_f32_16x16x32_bf16 v[20:23], v[180:183], v[84:87], v[20:23]
    s_waitcnt lgkmcnt(4)
    v_mfma_f32_16x16x32_bf16 v[16:19], v[152:155], v[88:91], v[16:19]
    s_mov_b64 exec, s[0:1]
    global_store_dwordx4 v222, v[252:255], s[42:43] sc1
    s_mov_b64 exec, -1
    s_waitcnt lgkmcnt(3)
    v_mfma_f32_16x16x32_bf16 v[20:23], v[184:187], v[88:91], v[20:23]
    s_waitcnt lgkmcnt(1)
    v_mfma_f32_16x16x32_bf16 v[16:19], v[156:159], v[92:95], v[16:19]
    s_waitcnt lgkmcnt(0)
    v_mfma_f32_16x16x32_bf16 v[20:23], v[188:191], v[92:95], v[20:23]
    s_nop 5
    ds_write2_b32 v212, v16, v17 offset0:0 offset1:1
    ds_write2_b32 v212, v18, v19 offset0:2 offset1:3
    ds_write2_b32 v213, v20, v21 offset0:0 offset1:1
    ds_write2_b32 v213, v22, v23 offset0:2 offset1:3
    s_branch L_km2
L_km1:
    ds_read_b128 v[64:67], v211 offset:0
    ds_read_b128 v[128:131], v211 offset:26112
    ds_read_b128 v[68:71], v211 offset:64
    ds_read_b128 v[132:135], v211 offset:26176
    ds_read_b128 v[72:75], v211 offset:128
    ds_read_b128 v[136:139], v211 offset:26240
    ds_read_b128 v[76:79], v211 offset:192
    ds_read_b128 v[140:143], v211 offset:26304
    v_mov_b32 v24, 0x1c1c2424
    v_mov_b32 v25, 0x1818181c
    v_mov_b32 v26, 0x14141818
    v_mov_b32 v27, 0x10101014
    v_mov_b32 v28, 0x81010
    v_mul_u32_u24 v29, 20, v1
    v_sub_u32 v29, 2284, v29
    s_mov_b32 exec_lo, 0
    s_mov_b32 exec_hi, -1
    v_mov_b32 v24, 0x28282c34
    v_mov_b32 v25, 0x20202428
    v_mov_b32 v26, 0x18181c20
    v_mov_b32 v27, 0x10101418
    v_mov_b32 v28, 0x40810
    v_mul_u32_u24 v29, 36, v1
    v_sub_u32 v29, 2780, v29
    s_mov_b32 exec_lo, 0
    s_mov_b32 exec_hi, 4294901760
    v_mov_b32 v24, 0x4044484c
    v_mov_b32 v25, 0x3034383c
    v_mov_b32 v26, 0x2024282c
    v_mov_b32 v27, 0x1014181c
    v_mov_b32 v28, 0x408
    v_mul_u32_u24 v29, 68, v1
    v_sub_u32 v29, 4284, v29
    s_mov_b64 exec, -1
    s_mov_b32 s10, 0x40810
    s_mov_b32 s11, 0x408
    v_writelane_b32 v28, s10, 31
    v_writelane_b32 v28, s11, 47
    v_add_u32 v29, s14, v29
    s_waitcnt lgkmcnt(6)
    v_mfma_f32_16x16x32_bf16 v[16:19], v[128:131], v[64:67], 0
    s_waitcnt lgkmcnt(4)
    ds_read_b128 v[80:83], v211 offset:256
    ds_read_b128 v[144:147], v211 offset:26368
    v_add_u32_sdwa v192, v29, v24 dst_sel:DWORD dst_unused:UNUSED_PAD src0_sel:DWORD src1_sel:BYTE_0
    v_add_u32_sdwa v193, v29, v24 dst_sel:DWORD dst_unused:UNUSED_PAD src0_sel:DWORD src1_sel:BYTE_1
    v_mfma_f32_16x16x32_bf16 v[16:19], v[132:135], v[68:71], v[16:19]
    s_waitcnt lgkmcnt(4)
    ds_read_b128 v[84:87], v211 offset:320
    ds_read_b128 v[148:151], v211 offset:26432
    v_add_u32_sdwa v194, v29, v24 dst_sel:DWORD dst_unused:UNUSED_PAD src0_sel:DWORD src1_sel:BYTE_2
    v_add_u32_sdwa v195, v29, v24 dst_sel:DWORD dst_unused:UNUSED_PAD src0_sel:DWORD src1_sel:BYTE_3
    v_mfma_f32_16x16x32_bf16 v[16:19], v[136:139], v[72:75], v[16:19]
    s_waitcnt lgkmcnt(4)
    ds_read_b128 v[88:91], v211 offset:384
    ds_read_b128 v[152:155], v211 offset:26496
    global_store_dwordx4 v221, v[248:251], s[42:43] sc1
    v_mfma_f32_16x16x32_bf16 v[16:19], v[140:143], v[76:79], v[16:19]
    s_waitcnt lgkmcnt(4)
    ds_read_b128 v[92:95], v211 offset:448
    ds_read_b128 v[156:159], v211 offset:26560
    v_add_u32_sdwa v196, v29, v25 dst_sel:DWORD dst_unused:UNUSED_PAD src0_sel:DWORD src1_sel:BYTE_0
    v_add_u32_sdwa v197, v29, v25 dst_sel:DWORD dst_unused:UNUSED_PAD src0_sel:DWORD src1_sel:BYTE_1
    v_mfma_f32_16x16x32_bf16 v[16:19], v[144:147], v[80:83], v[16:19]
    s_waitcnt lgkmcnt(4)
    v_add_u32_sdwa v198, v29, v25 dst_sel:DWORD dst_unused:UNUSED_PAD src0_sel:DWORD src1_sel:BYTE_2
    v_add_u32_sdwa v199, v29, v25 dst_sel:DWORD dst_unused:UNUSED_PAD src0_sel:DWORD src1_sel:BYTE_3
    v_add_u32_sdwa v200, v29, v26 dst_sel:DWORD dst_unused:UNUSED_PAD src0_sel:DWORD src1_sel:BYTE_0
    v_add_u32_sdwa v201, v29, v26 dst_sel:DWORD dst_unused:UNUSED_PAD src0_sel:DWORD src1_sel:BYTE_1
    v_mfma_f32_16x16x32_bf16 v[16:19], v[148:151], v[84:87], v[16:19]
    s_waitcnt lgkmcnt(2)
    v_add_u32_sdwa v202, v29, v26 dst_sel:DWORD dst_unused:UNUSED_PAD src0_sel:DWORD src1_sel:BYTE_2
    v_add_u32_sdwa v203, v29, v26 dst_sel:DWORD dst_unused:UNUSED_PAD src0_sel:DWORD src1_sel:BYTE_3
    v_add_u32_sdwa v204, v29, v27 dst_sel:DWORD dst_unused:UNUSED_PAD src0_sel:DWORD src1_sel:BYTE_0
    v_add_u32_sdwa v205, v29, v27 dst_sel:DWORD dst_unused:UNUSED_PAD src0_sel:DWORD src1_sel:BYTE_1
    v_mfma_f32_16x16x32_bf16 v[16:19], v[152:155], v[88:91], v[16:19]
    s_mov_b64 exec, s[0:1]
    global_store_dwordx4 v222, v[252:255], s[42:43] sc1
    s_mov_b64 exec, -1
    v_add_u32_sdwa v206, v29, v27 dst_sel:DWORD dst_unused:UNUSED_PAD src0_sel:DWORD src1_sel:BYTE_2
    v_add_u32_sdwa v207, v29, v27 dst_sel:DWORD dst_unused:UNUSED_PAD src0_sel:DWORD src1_sel:BYTE_3
    s_waitcnt lgkmcnt(0)
    v_mfma_f32_16x16x32_bf16 v[16:19], v[156:159], v[92:95], v[16:19]
    v_add_u32_sdwa v208, v29, v28 dst_sel:DWORD dst_unused:UNUSED_PAD src0_sel:DWORD src1_sel:BYTE_0
    v_add_u32_sdwa v209, v29, v28 dst_sel:DWORD dst_unused:UNUSED_PAD src0_sel:DWORD src1_sel:BYTE_1
    v_add_u32_sdwa v210, v29, v28 dst_sel:DWORD dst_unused:UNUSED_PAD src0_sel:DWORD src1_sel:BYTE_2
    s_nop 4
    ds_write2_b32 v213, v16, v17 offset0:0 offset1:1
    ds_write2_b32 v213, v18, v19 offset0:48 offset1:49
L_km2:
    global_store_dwordx4 v218, a[240:243], s[42:43] sc1
    s_waitcnt lgkmcnt(0)
    s_barrier
    s_bitcmp1_b32 s3, 0
    s_cbranch_scc1 L_ex1
    ds_read_b32 v66, v192 offset:8
    ds_read_b32 v67, v192 offset:16
    ds_read_b32 v68, v192 offset:20
    ds_read_b32 v69, v192 offset:28
    s_mov_b32 vcc_lo, 0
    s_brev_b32 vcc_hi, 1
    s_waitcnt lgkmcnt(2)
    v_cndmask_b32 v72, v67, v66, vcc
    s_waitcnt lgkmcnt(0)
    v_cvt_pk_bf16_f32 v128, v69, v69
    v_cvt_pk_bf16_f32 v129, v69, v69
    v_cvt_pk_bf16_f32 v130, v68, v68
    v_cvt_pk_bf16_f32 v131, v68, v68
    v_cvt_pk_bf16_f32 v132, v68, v68
    v_cvt_pk_bf16_f32 v133, v68, v67
    v_cvt_pk_bf16_f32 v134, v67, v67
    v_cvt_pk_bf16_f32 v135, v67, v67
    v_cvt_pk_bf16_f32 v136, v69, v69
    v_cvt_pk_bf16_f32 v137, v69, v68
    v_cvt_pk_bf16_f32 v138, v68, v68
    v_cvt_pk_bf16_f32 v139, v68, v68
    v_cvt_pk_bf16_f32 v140, v68, v68
    v_cvt_pk_bf16_f32 v141, v67, v67
    v_cvt_pk_bf16_f32 v142, v67, v67
    v_cvt_pk_bf16_f32 v143, v67, v67
    v_cvt_pk_bf16_f32 v144, v69, v69
    v_cvt_pk_bf16_f32 v145, v68, v68
    v_cvt_pk_bf16_f32 v146, v68, v68
    v_cvt_pk_bf16_f32 v147, v68, v68
    v_cvt_pk_bf16_f32 v148, v68, v67
    v_cvt_pk_bf16_f32 v149, v67, v67
    v_cvt_pk_bf16_f32 v150, v67, v67
    v_cvt_pk_bf16_f32 v151, v67, v67
    v_cvt_pk_bf16_f32 v152, v69, v68
    v_cvt_pk_bf16_f32 v153, v68, v68
    v_cvt_pk_bf16_f32 v154, v68, v68
    v_cvt_pk_bf16_f32 v155, v68, v68
    v_cvt_pk_bf16_f32 v156, v67, v67
    v_cvt_pk_bf16_f32 v157, v67, v67
    v_cvt_pk_bf16_f32 v158, v67, v67
    v_cvt_pk_bf16_f32 v159, v67, v72
    s_branch L_ex2
L_ex1:
    ds_read_b32 v66, v192
    ds_read_b32 v67, v193
    ds_read_b32 v68, v194
    ds_read_b32 v69, v195
    ds_read_b32 v70, v196
    ds_read_b32 v71, v197
    ds_read_b32 v72, v198
    ds_read_b32 v73, v199
    ds_read_b32 v74, v200
    ds_read_b32 v75, v201
    ds_read_b32 v76, v202
    ds_read_b32 v77, v203
    ds_read_b32 v78, v204
    ds_read_b32 v79, v205
    ds_read_b32 v80, v206
    ds_read_b32 v81, v207
    ds_read_b32 v82, v208
    ds_read_b32 v83, v209
    ds_read_b32 v84, v210
    s_waitcnt lgkmcnt(15)
    v_cvt_pk_bf16_f32 v128, v66, v67
    v_cvt_pk_bf16_f32 v129, v68, v69
    s_waitcnt lgkmcnt(13)
    v_cvt_pk_bf16_f32 v130, v70, v71
    s_waitcnt lgkmcnt(11)
    v_cvt_pk_bf16_f32 v131, v72, v73
    s_waitcnt lgkmcnt(9)
    v_cvt_pk_bf16_f32 v132, v74, v75
    s_waitcnt lgkmcnt(7)
    v_cvt_pk_bf16_f32 v133, v76, v77
    s_waitcnt lgkmcnt(5)
    v_cvt_pk_bf16_f32 v134, v78, v79
    s_waitcnt lgkmcnt(3)
    v_cvt_pk_bf16_f32 v135, v80, v81
    v_cvt_pk_bf16_f32 v136, v67, v68
    v_cvt_pk_bf16_f32 v137, v69, v70
    v_cvt_pk_bf16_f32 v138, v71, v72
    v_cvt_pk_bf16_f32 v139, v73, v74
    v_cvt_pk_bf16_f32 v140, v75, v76
    v_cvt_pk_bf16_f32 v141, v77, v78
    v_cvt_pk_bf16_f32 v142, v79, v80
    s_waitcnt lgkmcnt(2)
    v_cvt_pk_bf16_f32 v143, v81, v82
    v_cvt_pk_bf16_f32 v144, v68, v69
    v_cvt_pk_bf16_f32 v145, v70, v71
    v_cvt_pk_bf16_f32 v146, v72, v73
    v_cvt_pk_bf16_f32 v147, v74, v75
    v_cvt_pk_bf16_f32 v148, v76, v77
    v_cvt_pk_bf16_f32 v149, v78, v79
    v_cvt_pk_bf16_f32 v150, v80, v81
    s_waitcnt lgkmcnt(1)
    v_cvt_pk_bf16_f32 v151, v82, v83
    v_cvt_pk_bf16_f32 v152, v69, v70
    v_cvt_pk_bf16_f32 v153, v71, v72
    v_cvt_pk_bf16_f32 v154, v73, v74
    v_cvt_pk_bf16_f32 v155, v75, v76
    v_cvt_pk_bf16_f32 v156, v77, v78
    v_cvt_pk_bf16_f32 v157, v79, v80
    v_cvt_pk_bf16_f32 v158, v81, v82
    s_waitcnt lgkmcnt(0)
    v_cvt_pk_bf16_f32 v159, v83, v84
L_ex2:
    s_mov_b64 exec, 0xfff0
    global_store_dwordx4 v7, a[240:243], s[42:43] sc1
    s_mov_b64 exec, 0xffff
    global_store_dword v223, v113, s[42:43] sc1
    global_store_dword v223, v117, s[42:43] offset:1024 sc1
    global_store_dword v45, v121, s[42:43] sc1
    s_mov_b64 exec, -1
    ds_write_b128 v214, v[128:131] offset:0
    ds_write_b128 v214, v[132:135] offset:16
    ds_write_b128 v214, v[136:139] offset:4160
    ds_write_b128 v214, v[140:143] offset:4176
    ds_write_b128 v214, v[144:147] offset:8320
    ds_write_b128 v214, v[148:151] offset:8336
    ds_write_b128 v214, v[152:155] offset:12480
    ds_write_b128 v214, v[156:159] offset:12496
    ds_read_b64_tr_b16 v[24:25], v216 offset:0
    ds_read_b64_tr_b16 v[26:27], v216 offset:1024
    ds_read_b64_tr_b16 v[28:29], v216 offset:32
    ds_read_b64_tr_b16 v[30:31], v216 offset:1056
    global_load_dwordx4 v[32:35], v4, s[42:43] offset:0 sc1
    global_load_dwordx4 v[36:39], v4, s[42:43] offset:1024 sc1
    global_load_dwordx4 v[40:43], v4, s[42:43] offset:2048 sc1
    global_load_dwordx4 v[48:51], v5, s[42:43] offset:0 sc1
    global_load_dwordx4 v[52:55], v5, s[42:43] offset:1024 sc1
    global_load_dwordx4 v[56:59], v5, s[42:43] offset:2048 sc1
    global_load_dwordx4 v[60:63], v5, s[42:43] offset:3072 sc1
    s_lshl_b32 s36, s13, 6
    s_add_u32 s36, s36, 262144
    s_add_u32 s37, s36, 32768
    s_lshl_b32 s10, s2, 2
    s_add_u32 s10, s10, s3
    s_lshl_b32 s10, s10, 7
    s_add_u32 s10, s10, 327680
    s_cmp_eq_u32 s3, 0
    s_cselect_b32 s36, s36, s10
    s_cselect_b32 s37, s37, s10
    v_lshl_add_u32 v92, v1, 2, s36
    v_mov_b32 v93, s52
    v_lshlrev_b32 v94, 6, v0
    v_add_u32 v94, 262144, v94
    s_waitcnt vmcnt(7)
    s_waitcnt lgkmcnt(0)
    s_barrier
    s_mov_b64 exec, 0xffff
    global_store_dword v92, v93, s[42:43] sc1
    s_mov_b64 exec, -1
    s_lshl_b32 s10, s13, 7
    s_add_u32 s10, s10, 5242880
    s_lshl_b32 s14, s13, 1
    s_and_b32 s14, s14, 4
    v_and_b32 v96, 7, v0
    v_xor_b32 v96, s14, v96
    v_lshl_add_u32 v96, v96, 4, s10
    v_lshrrev_b32 v97, 3, v0
    v_lshl_add_u32 v121, v97, 15, v96
    s_lshl_b32 s10, s2, 2
    s_add_u32 s10, s10, s3
    s_lshl_b32 s10, s10, 7
    s_add_u32 s10, s10, 327680
    v_lshl_add_u32 v96, v1, 4, s10
    s_lshr_b32 s10, s2, 2
    s_mul_i32 s11, s10, 745
    s_lshr_b32 s11, s11, 13
    s_and_b32 s15, s2, 3
    s_lshl_b32 s15, s15, 1
    s_add_u32 s15, s15, s4
    s_mul_i32 s15, s15, 44
    s_add_u32 s15, s15, s10
    s_lshl_b32 s15, s15, 12
    s_add_u32 s15, s15, 10485760
    s_lshl_b32 s61, s3, 1
    s_sub_u32 s61, s61, s11
    s_add_u32 s62, s61, 0
    s_and_b32 s62, s62, 3
    s_lshl_b32 s62, s62, 10
    s_add_u32 s62, s62, s15
    v_lshl_add_u32 v225, v1, 4, s62
    s_add_u32 s62, s61, 1
    s_and_b32 s62, s62, 3
    s_lshl_b32 s62, s62, 10
    s_add_u32 s62, s62, s15
    v_lshl_add_u32 v226, v1, 4, s62
    s_cmp_ge_u32 s2, 176
    s_cselect_b64 vcc, -1, 0
    s_cselect_b64 s[40:41], 0xff, -1
    v_cndmask_b32 v225, v225, v96, vcc
    v_cndmask_b32 v226, v226, v96, vcc
    s_mul_i32 s10, s55, 11
    s_mul_i32 s11, s3, 3
    s_add_u32 s10, s10, s11
    s_lshl_b32 s11, s10, 14
    s_add_u32 s11, s11, 7344128
    v_lshl_add_u32 v122, v1, 4, s11
    v_add_u32 v123, 0x4000, v122
    v_add_u32 v124, 0x8000, v122
    v_mov_b32 v127, s11
    s_cmp_eq_u32 s3, 3
    s_cselect_b64 vcc, -1, 0
    v_cndmask_b32 v124, v124, v127, vcc
    s_lshl_b32 s10, s10, 10
    s_add_u32 s10, s10, 65536
    v_lshl_add_u32 v125, v1, 2, s10
    s_lshl_b32 s10, s9, 2
    s_add_u32 s10, s10, s3
    s_mul_i32 s10, s10, 5632
    s_mul_i32 s11, s6, 720896
    s_add_u32 s10, s10, s11
    s_add_u32 s10, s10, 12584960
    v_lshl_add_u32 v126, v1, 4, s10
    s_mul_i32 s11, s4, 4608
    s_lshl_b32 s15, s5, 8
    s_add_u32 s11, s11, s15
    s_add_u32 s11, s11, 104480
    v_lshl_add_u32 v96, v3, 4, s11
    v_lshl_add_u32 v112, v2, 5, v96
    s_lshl_b32 s11, s3, 12
    s_add_u32 s11, s11, 131072
    v_bfe_u32 v96, v2, 1, 2
    v_xor_b32 v96, v96, v3
    v_xor_b32 v96, s4, v96
    v_lshl_add_u32 v96, v96, 4, s11
    v_lshl_add_u32 v113, v2, 6, v96
    v_lshrrev_b32 v96, 2, v0
    v_bfe_u32 v97, v0, 1, 1
    v_and_b32 v98, 1, v0
    v_bfe_u32 v99, v0, 3, 2
    v_lshlrev_b32 v100, 1, v98
    v_xor_b32 v100, v100, v99
    v_xor_b32 v100, v100, v97
    v_lshlrev_b32 v100, 4, v100
    v_lshl_add_u32 v100, v96, 6, v100
    v_lshl_add_u32 v100, v97, 13, v100
    v_add_u32 v114, 131072, v100
    v_xor_b32 v115, 16, v114
    v_lshl_add_u32 v96, v96, 1, v98
    v_lshlrev_b32 v96, 4, v96
    v_lshl_add_u32 v96, v97, 12, v96
    v_add_u32 v117, 113664, v96
    s_mul_i32 s10, s4, 16640
    s_add_u32 s10, s10, s15
    s_add_u32 s10, s10, 69632
    v_sub_u32 v96, 15, v2
    v_and_b32 v97, 3, v96
    v_mul_u32_u24 v97, 4160, v97
    v_and_b32 v96, 12, v96
    v_lshl_add_u32 v96, v96, 1, v97
    v_lshl_add_u32 v96, v3, 4, v96
    v_add_u32 v118, s10, v96
    v_lshlrev_b32 v119, 4, v0
    v_add_u32 v119, 104448, v119
    s_add_u32 s16, s42, 0
    s_addc_u32 s17, s43, 0
    s_add_u32 s18, s42, 180224
    s_addc_u32 s19, s43, 0
    s_add_u32 s20, s42, 360448
    s_addc_u32 s21, s43, 0
    s_add_u32 s22, s42, 540672
    s_addc_u32 s23, s43, 0
    s_mov_b32 s24, 0x100001
    s_mov_b32 s25, 0x10000100
    s_mov_b32 s26, 0x200002
    s_mov_b32 s27, 0x20000200
    s_mov_b32 s28, 0x400004
    s_mov_b32 s29, 0x40000400
    s_mov_b32 s30, 0x800008
    s_mov_b32 s31, 0x80000800
    ds_read_b64 v[128:129], v118 offset:3584
    ds_read_b64 v[130:131], v118 offset:3592
    ds_read_b64 v[144:145], v118 offset:3072
    ds_read_b64 v[146:147], v118 offset:3080
    ds_read_b64 v[160:161], v118 offset:2560
    ds_read_b64 v[162:163], v118 offset:2568
    ds_read_b64 v[176:177], v118 offset:2048
    ds_read_b64 v[178:179], v118 offset:2056
    ds_read_b64 v[132:133], v118 offset:3648
    ds_read_b64 v[134:135], v118 offset:3656
    ds_read_b64 v[148:149], v118 offset:3136
    ds_read_b64 v[150:151], v118 offset:3144
    ds_read_b64 v[164:165], v118 offset:2624
    ds_read_b64 v[166:167], v118 offset:2632
    ds_read_b64 v[180:181], v118 offset:2112
    ds_read_b64 v[182:183], v118 offset:2120
    ds_read_b64 v[136:137], v118 offset:3712
    ds_read_b64 v[138:139], v118 offset:3720
    ds_read_b64 v[152:153], v118 offset:3200
    ds_read_b64 v[154:155], v118 offset:3208
    ds_read_b64 v[168:169], v118 offset:2688
    ds_read_b64 v[170:171], v118 offset:2696
    ds_read_b64 v[184:185], v118 offset:2176
    ds_read_b64 v[186:187], v118 offset:2184
    ds_read_b64 v[140:141], v118 offset:3776
    ds_read_b64 v[142:143], v118 offset:3784
    ds_read_b64 v[156:157], v118 offset:3264
    ds_read_b64 v[158:159], v118 offset:3272
    ds_read_b64 v[172:173], v118 offset:2752
    ds_read_b64 v[174:175], v118 offset:2760
    ds_read_b64 v[188:189], v118 offset:2240
    ds_read_b64 v[190:191], v118 offset:2248
    s_mov_b32 s59, 0
L_sw1:
    s_waitcnt vmcnt(1)
    v_min3_u32 v64, v35, v39, v43
    v_max3_u32 v65, v35, v39, v43
    v_min3_u32 v64, v64, v51, v55
    v_max3_u32 v65, v65, v51, v55
    v_min3_u32 v64, v64, v59, v63
    v_max3_u32 v65, v65, v59, v63
    v_min_u32 v64, s52, v64
    v_max_u32 v65, s52, v65
    v_cmp_ne_u32 vcc, v64, v65
    s_cbranch_vccnz L_sw1r
L_sw1ok:
    v_mov_b32 v90, v225
    v_mov_b32 v91, v226
    v_mov_b32 v95, v219
    s_cmp_lg_u32 s3, 0
    s_cbranch_scc1 L_sl0a
    s_mov_b64 exec, s[40:41]
    global_store_dwordx4 v90, v[24:27], s[42:43] sc1
    global_store_dwordx4 v91, v[28:31], s[42:43] sc1
    s_mov_b64 exec, -1
L_sl0a:
    s_cmp_lg_u32 s3, 2
    s_cbranch_scc1 L_sl0b
    global_store_dwordx4 v95, a[240:243], s[42:43] sc1
L_sl0b:
    v_lshlrev_b32 v66, 16, v50
    v_and_b32 v67, s60, v50
    v_lshlrev_b32 v68, 16, v32
    v_and_b32 v69, s60, v32
    v_pk_add_f32 v[68:69], v[68:69], v[66:67] op_sel:[0,0] op_sel_hi:[1,0] neg_lo:[0,1] neg_hi:[0,1]
    v_pk_mul_f32 v[68:69], v[68:69], v[48:49] op_sel:[0,0] op_sel_hi:[1,0]
    v_lshlrev_b32 v70, 16, v33
    v_and_b32 v71, s60, v33
    v_pk_add_f32 v[70:71], v[70:71], v[66:67] op_sel:[0,1] op_sel_hi:[1,1] neg_lo:[0,1] neg_hi:[0,1]
    v_pk_mul_f32 v[70:71], v[70:71], v[48:49] op_sel:[0,1] op_sel_hi:[1,1]
    v_cvt_pk_bf16_f32 v72, v68, v70
    v_cvt_pk_bf16_f32 v76, v69, v71
    v_lshlrev_b32 v66, 16, v54
    v_and_b32 v67, s60, v54
    v_lshlrev_b32 v68, 16, v34
    v_and_b32 v69, s60, v34
    v_pk_add_f32 v[68:69], v[68:69], v[66:67] op_sel:[0,0] op_sel_hi:[1,0] neg_lo:[0,1] neg_hi:[0,1]
    v_pk_mul_f32 v[68:69], v[68:69], v[52:53] op_sel:[0,0] op_sel_hi:[1,0]
    v_lshlrev_b32 v70, 16, v36
    v_and_b32 v71, s60, v36
    v_pk_add_f32 v[70:71], v[70:71], v[66:67] op_sel:[0,1] op_sel_hi:[1,1] neg_lo:[0,1] neg_hi:[0,1]
    v_pk_mul_f32 v[70:71], v[70:71], v[52:53] op_sel:[0,1] op_sel_hi:[1,1]
    v_cvt_pk_bf16_f32 v73, v68, v70
    v_cvt_pk_bf16_f32 v77, v69, v71
    v_lshlrev_b32 v66, 16, v58
    v_and_b32 v67, s60, v58
    v_lshlrev_b32 v68, 16, v37
    v_and_b32 v69, s60, v37
    v_pk_add_f32 v[68:69], v[68:69], v[66:67] op_sel:[0,0] op_sel_hi:[1,0] neg_lo:[0,1] neg_hi:[0,1]
    v_pk_mul_f32 v[68:69], v[68:69], v[56:57] op_sel:[0,0] op_sel_hi:[1,0]
    v_lshlrev_b32 v70, 16, v38
    v_and_b32 v71, s60, v38
    v_pk_add_f32 v[70:71], v[70:71], v[66:67] op_sel:[0,1] op_sel_hi:[1,1] neg_lo:[0,1] neg_hi:[0,1]
    v_pk_mul_f32 v[70:71], v[70:71], v[56:57] op_sel:[0,1] op_sel_hi:[1,1]
    v_cvt_pk_bf16_f32 v74, v68, v70
    v_cvt_pk_bf16_f32 v78, v69, v71
    v_lshlrev_b32 v66, 16, v62
    v_and_b32 v67, s60, v62
    v_lshlrev_b32 v68, 16, v40
    v_and_b32 v69, s60, v40
    v_pk_add_f32 v[68:69], v[68:69], v[66:67] op_sel:[0,0] op_sel_hi:[1,0] neg_lo:[0,1] neg_hi:[0,1]
    v_pk_mul_f32 v[68:69], v[68:69], v[60:61] op_sel:[0,0] op_sel_hi:[1,0]
    v_lshlrev_b32 v70, 16, v41
    v_and_b32 v71, s60, v41
    v_pk_add_f32 v[70:71], v[70:71], v[66:67] op_sel:[0,1] op_sel_hi:[1,1] neg_lo:[0,1] neg_hi:[0,1]
    v_pk_mul_f32 v[70:71], v[70:71], v[60:61] op_sel:[0,1] op_sel_hi:[1,1]
    v_cvt_pk_bf16_f32 v75, v68, v70
    v_cvt_pk_bf16_f32 v79, v69, v71
    s_mov_b32 s10, 0x05040100
    s_mov_b32 s11, 0x07060302
    v_perm_b32 v80, v33, v32, s10
    v_perm_b32 v84, v33, v32, s11
    v_perm_b32 v81, v36, v34, s10
    v_perm_b32 v85, v36, v34, s11
    v_perm_b32 v82, v38, v37, s10
    v_perm_b32 v86, v38, v37, s11
    v_perm_b32 v83, v41, v40, s10
    v_perm_b32 v87, v41, v40, s11
    ds_write_b128 v119, v[72:75] offset:512
    ds_write_b128 v119, v[76:79] offset:5120
    ds_write_b128 v119, v[80:83] offset:9216
    ds_write_b128 v119, v[84:87] offset:13312
    s_cmp_lg_u32 s3, 1
    s_cbranch_scc1 L_sl1a
    s_mov_b64 exec, s[40:41]
    global_store_dwordx4 v90, v[24:27], s[42:43] sc1
    global_store_dwordx4 v91, v[28:31], s[42:43] sc1
    s_mov_b64 exec, -1
L_sl1a:
    s_cmp_lg_u32 s3, 3
    s_cbranch_scc1 L_sl1b
    global_store_dwordx4 v95, a[240:243], s[42:43] sc1
L_sl1b:
    global_store_dwordx4 v126, a[240:243], s[42:43] offset:-2048 sc1
    global_store_dwordx4 v126, a[240:243], s[42:43] offset:-1024 sc1
    global_store_dwordx4 v126, a[240:243], s[42:43] offset:0 sc1
    s_waitcnt lgkmcnt(0)
    s_barrier
    ds_read_b128 v[32:35], v112 offset:0
    ds_read_b128 v[36:39], v112 offset:512
    ds_read_b128 v[40:43], v112 offset:1024
    ds_read_b128 v[44:47], v112 offset:1536
    s_waitcnt lgkmcnt(3)
    v_mfma_f32_16x16x32_bf16 v[96:99], v[128:131], v[32:35], 0
    ds_read_b128 v[48:51], v112 offset:64
    v_mfma_f32_16x16x32_bf16 v[100:103], v[144:147], v[32:35], 0
    ds_read_b128 v[52:55], v112 offset:576
    v_mfma_f32_16x16x32_bf16 v[104:107], v[160:163], v[32:35], 0
    ds_read_b128 v[56:59], v112 offset:1088
    ds_read_b128 v[66:69], v117 offset:0
    v_mfma_f32_16x16x32_bf16 v[108:111], v[176:179], v[32:35], 0
    s_waitcnt lgkmcnt(6)
    ds_read_b128 v[60:63], v112 offset:1600
    v_mfma_f32_16x16x32_bf16 v[100:103], v[128:131], v[36:39], v[100:103]
    v_mfma_f32_16x16x32_bf16 v[104:107], v[144:147], v[36:39], v[104:107]
    v_mfma_f32_16x16x32_bf16 v[108:111], v[160:163], v[36:39], v[108:111]
    s_waitcnt lgkmcnt(6)
    v_mfma_f32_16x16x32_bf16 v[104:107], v[128:131], v[40:43], v[104:107]
    v_mfma_f32_16x16x32_bf16 v[108:111], v[144:147], v[40:43], v[108:111]
    s_waitcnt lgkmcnt(1)
    v_lshlrev_b32 v74, 16, v66
    v_and_b32 v75, s60, v66
    v_mfma_f32_16x16x32_bf16 v[108:111], v[128:131], v[44:47], v[108:111]
    v_lshlrev_b32 v76, 16, v67
    v_and_b32 v77, s60, v67
    v_mfma_f32_16x16x32_bf16 v[96:99], v[132:135], v[48:51], v[96:99]
    ds_read_b128 v[32:35], v112 offset:128
    global_store_dwordx4 v126, a[240:243], s[42:43] offset:1024 sc1
    v_mfma_f32_16x16x32_bf16 v[100:103], v[148:151], v[48:51], v[100:103]
    ds_read_b128 v[36:39], v112 offset:640
    v_lshlrev_b32 v78, 16, v68
    v_mfma_f32_16x16x32_bf16 v[104:107], v[164:167], v[48:51], v[104:107]
    ds_read_b128 v[40:43], v112 offset:1152
    v_and_b32 v79, s60, v68
    v_mfma_f32_16x16x32_bf16 v[108:111], v[180:183], v[48:51], v[108:111]
    ds_read_b128 v[44:47], v112 offset:1664
    v_lshlrev_b32 v80, 16, v69
    v_mfma_f32_16x16x32_bf16 v[100:103], v[132:135], v[52:55], v[100:103]
    v_and_b32 v81, s60, v69
    v_mfma_f32_16x16x32_bf16 v[104:107], v[148:151], v[52:55], v[104:107]
    v_mfma_f32_16x16x32_bf16 v[108:111], v[164:167], v[52:55], v[108:111]
    v_mfma_f32_16x16x32_bf16 v[104:107], v[132:135], v[56:59], v[104:107]
    v_mfma_f32_16x16x32_bf16 v[108:111], v[148:151], v[56:59], v[108:111]
    s_waitcnt lgkmcnt(4)
    v_mfma_f32_16x16x32_bf16 v[108:111], v[132:135], v[60:63], v[108:111]
    s_waitcnt lgkmcnt(3)
    v_mfma_f32_16x16x32_bf16 v[96:99], v[136:139], v[32:35], v[96:99]
    ds_read_b128 v[48:51], v112 offset:192
    v_mfma_f32_16x16x32_bf16 v[100:103], v[152:155], v[32:35], v[100:103]
    ds_read_b128 v[52:55], v112 offset:704
    v_mfma_f32_16x16x32_bf16 v[104:107], v[168:171], v[32:35], v[104:107]
    ds_read_b128 v[56:59], v112 offset:1216
    v_mfma_f32_16x16x32_bf16 v[108:111], v[184:187], v[32:35], v[108:111]
    s_waitcnt lgkmcnt(5)
    ds_read_b128 v[60:63], v112 offset:1728
    v_mfma_f32_16x16x32_bf16 v[100:103], v[136:139], v[36:39], v[100:103]
    global_load_dword v64, v94, s[42:43] sc1
    v_mfma_f32_16x16x32_bf16 v[104:107], v[152:155], v[36:39], v[104:107]
    v_mfma_f32_16x16x32_bf16 v[108:111], v[168:171], v[36:39], v[108:111]
    s_waitcnt lgkmcnt(5)
    v_mfma_f32_16x16x32_bf16 v[104:107], v[136:139], v[40:43], v[104:107]
    v_mfma_f32_16x16x32_bf16 v[108:111], v[152:155], v[40:43], v[108:111]
    s_waitcnt lgkmcnt(4)
    v_mfma_f32_16x16x32_bf16 v[108:111], v[136:139], v[44:47], v[108:111]
    s_waitcnt lgkmcnt(3)
    v_mfma_f32_16x16x32_bf16 v[108:111], v[188:191], v[48:51], v[108:111]
    s_waitcnt lgkmcnt(2)
    ds_read_b64 v[192:193], v118 offset:1536
    v_mfma_f32_16x16x32_bf16 v[108:111], v[172:175], v[52:55], v[108:111]
    s_waitcnt lgkmcnt(2)
    ds_read_b64 v[194:195], v118 offset:1544
    v_mfma_f32_16x16x32_bf16 v[108:111], v[156:159], v[56:59], v[108:111]
    s_waitcnt lgkmcnt(2)
    ds_read_b64 v[208:209], v118 offset:1024
    v_mfma_f32_16x16x32_bf16 v[108:111], v[140:143], v[60:63], v[108:111]
    ds_read_b64 v[210:211], v118 offset:1032
    v_mfma_f32_16x16x32_bf16 v[104:107], v[172:175], v[48:51], v[104:107]
    ds_read_b64 v[224:225], v118 offset:512
    v_mfma_f32_16x16x32_bf16 v[104:107], v[156:159], v[52:55], v[104:107]
    ds_read_b64 v[226:227], v118 offset:520
    v_mfma_f32_16x16x32_bf16 v[104:107], v[140:143], v[56:59], v[104:107]
    ds_read_b64 v[240:241], v118 offset:0
    s_nop 0
    ds_write_b128 v113, v[108:111] offset:3072
    v_mfma_f32_16x16x32_bf16 v[100:103], v[156:159], v[48:51], v[100:103]
    ds_read_b64 v[242:243], v118 offset:8
    v_mfma_f32_16x16x32_bf16 v[100:103], v[140:143], v[52:55], v[100:103]
    v_mfma_f32_16x16x32_bf16 v[96:99], v[140:143], v[48:51], v[96:99]
    s_nop 0
    ds_write_b128 v113, v[104:107] offset:2048
    s_nop 4
    ds_write_b128 v113, v[100:103] offset:1024
    ds_write_b128 v113, v[96:99] offset:0
    s_cmp_lg_u32 s3, 2
    s_cbranch_scc1 L_sl2a
    s_mov_b64 exec, s[40:41]
    global_store_dwordx4 v90, v[24:27], s[42:43] sc1
    global_store_dwordx4 v91, v[28:31], s[42:43] sc1
    s_mov_b64 exec, -1
L_sl2a:
    s_cmp_lg_u32 s3, 0
    s_cbranch_scc1 L_sl2b
    global_store_dwordx4 v95, a[240:243], s[42:43] sc1
L_sl2b:
    s_waitcnt lgkmcnt(0)
    s_barrier
    ds_read_b128 v[8:11], v114 offset:0
    ds_read_b128 v[16:19], v114 offset:4096
    ds_read_b128 v[12:15], v115 offset:0
    ds_read_b128 v[20:23], v115 offset:4096
    ds_read_b128 v[32:35], v112 offset:0
    ds_read_b128 v[36:39], v112 offset:512
    ds_read_b128 v[40:43], v112 offset:1024
    ds_read_b128 v[44:47], v112 offset:1536
    ds_read_b128 v[48:51], v112 offset:2048
    ds_read_b128 v[52:55], v112 offset:2560
    ds_read_b128 v[56:59], v112 offset:3072
    ds_read_b128 v[60:63], v112 offset:3584
    s_waitcnt lgkmcnt(11)
    v_pk_add_f32 v[8:9], v[8:9], v[74:75]
    v_pk_add_f32 v[10:11], v[10:11], v[76:77]
    s_waitcnt lgkmcnt(9)
    v_pk_add_f32 v[12:13], v[12:13], v[78:79]
    v_pk_add_f32 v[14:15], v[14:15], v[80:81]
    v_pk_add_f32 v[8:9], v[8:9], v[16:17]
    v_pk_add_f32 v[10:11], v[10:11], v[18:19]
    s_waitcnt lgkmcnt(8)
    v_pk_add_f32 v[12:13], v[12:13], v[20:21]
    v_pk_add_f32 v[14:15], v[14:15], v[22:23]
    v_cvt_pk_bf16_f32 v20, v8, v9
    v_cvt_pk_bf16_f32 v21, v10, v11
    v_cvt_pk_bf16_f32 v22, v12, v13
    v_cvt_pk_bf16_f32 v23, v14, v15
    global_store_dwordx4 v121, v[20:23], s[42:43] sc1
    s_cmp_lg_u32 s3, 3
    s_cbranch_scc1 L_sl3a
    s_mov_b64 exec, s[40:41]
    global_store_dwordx4 v90, v[24:27], s[42:43] sc1
    global_store_dwordx4 v91, v[28:31], s[42:43] sc1
    s_mov_b64 exec, -1
L_sl3a:
    s_cmp_lg_u32 s3, 1
    s_cbranch_scc1 L_sl3b
    global_store_dwordx4 v95, a[240:243], s[42:43] sc1
L_sl3b:
    global_store_dwordx4 v126, a[240:243], s[42:43] offset:2048 sc1
    global_store_dwordx4 v126, a[240:243], s[42:43] offset:2560 sc1
    s_waitcnt vmcnt(3)
    v_cmp_ne_u32 vcc, s52, v64
    s_cbranch_vccnz L_f2r
L_f2ok:
    s_barrier
    global_load_dwordx4 a[0:3], v122, s[42:43] offset:-4096 sc1
    global_load_dwordx4 a[4:7], v123, s[42:43] offset:-4096 sc1
    global_load_dwordx4 a[8:11], v124, s[42:43] offset:-4096 sc1
    global_load_dwordx4 a[12:15], v122, s[42:43] offset:-3072 sc1
    global_load_dwordx4 a[16:19], v123, s[42:43] offset:-3072 sc1
    global_load_dwordx4 a[20:23], v124, s[42:43] offset:-3072 sc1
    s_waitcnt lgkmcnt(7)
    v_mfma_f32_16x16x32_bf16 v[96:99], v[192:195], v[32:35], 0
    ds_read_b128 v[64:67], v112 offset:64
    global_load_dwordx4 a[24:27], v122, s[42:43] offset:-2048 sc1
    v_mfma_f32_16x16x32_bf16 v[100:103], v[208:211], v[32:35], 0
    ds_read_b64 v[196:197], v118 offset:1600
    v_mfma_f32_16x16x32_bf16 v[104:107], v[224:227], v[32:35], 0
    ds_read_b64 v[198:199], v118 offset:1608
    s_lshl_b32 s10, s56, 15
    v_mfma_f32_16x16x32_bf16 v[108:111], v[240:243], v[32:35], 0
    ds_read_b64 v[212:213], v118 offset:1088
    s_lshl_b32 s12, s3, 13
    s_waitcnt lgkmcnt(10)
    v_mfma_f32_16x16x32_bf16 v[96:99], v[176:179], v[36:39], v[96:99]
    ds_read_b64 v[214:215], v118 offset:1096
    s_add_u32 s10, s10, s12
    v_mfma_f32_16x16x32_bf16 v[100:103], v[192:195], v[36:39], v[100:103]
    ds_read_b64 v[228:229], v118 offset:576
    global_load_dwordx4 a[28:31], v123, s[42:43] offset:-2048 sc1
    v_mfma_f32_16x16x32_bf16 v[104:107], v[208:211], v[36:39], v[104:107]
    ds_read_b64 v[230:231], v118 offset:584
    s_add_u32 s10, s10, 5242880
    v_mfma_f32_16x16x32_bf16 v[108:111], v[224:227], v[36:39], v[108:111]
    s_waitcnt lgkmcnt(12)
    ds_read_b64 v[244:245], v118 offset:64
    v_lshl_add_u32 v4, v1, 4, s10
    v_mfma_f32_16x16x32_bf16 v[96:99], v[160:163], v[40:43], v[96:99]
    ds_read_b64 v[246:247], v118 offset:72
    v_bfe_u32 v127, v1, 3, 3
    v_mfma_f32_16x16x32_bf16 v[100:103], v[176:179], v[40:43], v[100:103]
    ds_read_b128 v[68:71], v112 offset:576
    v_lshlrev_b32 v5, 7, v127
    v_mfma_f32_16x16x32_bf16 v[104:107], v[192:195], v[40:43], v[104:107]
    ds_read_b128 v[72:75], v112 offset:1088
    global_load_dwordx4 a[32:35], v124, s[42:43] offset:-2048 sc1
    v_mfma_f32_16x16x32_bf16 v[108:111], v[208:211], v[40:43], v[108:111]
    s_waitcnt lgkmcnt(14)
    ds_read_b128 v[76:79], v112 offset:1600
    v_bfe_u32 v127, v1, 2, 1
    v_mfma_f32_16x16x32_bf16 v[96:99], v[144:147], v[44:47], v[96:99]
    ds_read_b128 v[80:83], v112 offset:2112
    v_lshl_add_u32 v5, v127, 5, v5
    v_mfma_f32_16x16x32_bf16 v[100:103], v[160:163], v[44:47], v[100:103]
    ds_read_b128 v[84:87], v112 offset:2624
    v_and_b32 v127, 3, v1
    v_mfma_f32_16x16x32_bf16 v[104:107], v[176:179], v[44:47], v[104:107]
    ds_read_b128 v[88:91], v112 offset:3136
    v_lshl_add_u32 v5, v127, 3, v5
    v_mfma_f32_16x16x32_bf16 v[108:111], v[192:195], v[44:47], v[108:111]
    ds_read_b128 v[92:95], v112 offset:3648
    global_load_dwordx4 a[36:39], v122, s[42:43] offset:-1024 sc1
    v_mfma_f32_16x16x32_bf16 v[96:99], v[128:131], v[48:51], v[96:99]
    v_and_b32 v127, 1, v3
    v_lshl_add_u32 v5, v127, 6, v5
    v_mfma_f32_16x16x32_bf16 v[100:103], v[144:147], v[48:51], v[100:103]
    v_xor_b32 v6, 64, v5
    s_lshr_b32 s10, s56, 1
    v_mfma_f32_16x16x32_bf16 v[104:107], v[160:163], v[48:51], v[104:107]
    s_mul_i32 s10, s10, 720896
    s_and_b32 s11, s56, 1
    s_mul_i32 s11, s11, 90112
    v_mfma_f32_16x16x32_bf16 v[108:111], v[176:179], v[48:51], v[108:111]
    s_add_u32 s10, s10, s11
    s_mul_i32 s11, s55, 2816
    s_add_u32 s10, s10, s11
    s_waitcnt lgkmcnt(15)
    v_mfma_f32_16x16x32_bf16 v[100:103], v[128:131], v[52:55], v[100:103]
    global_load_dwordx4 a[40:43], v123, s[42:43] offset:-1024 sc1
    s_mul_i32 s11, s3, 768
    v_mfma_f32_16x16x32_bf16 v[104:107], v[144:147], v[52:55], v[104:107]
    s_add_u32 s10, s10, s11
    s_add_u32 s10, s10, 12582912
    v_mul_u32_u24 v9, 45056, v127
    v_mfma_f32_16x16x32_bf16 v[108:111], v[160:163], v[52:55], v[108:111]
    v_lshrrev_b32 v127, 1, v3
    v_lshl_add_u32 v9, v127, 8, v9
    v_mfma_f32_16x16x32_bf16 v[104:107], v[128:131], v[56:59], v[104:107]
    v_lshl_add_u32 v9, v2, 4, v9
    v_add_u32 v9, s10, v9
    v_mfma_f32_16x16x32_bf16 v[108:111], v[144:147], v[56:59], v[108:111]
    s_lshl_b32 s10, s57, 2
    s_add_u32 s10, s10, s3
    s_mul_i32 s10, s10, 45056
    v_mfma_f32_16x16x32_bf16 v[108:111], v[128:131], v[60:63], v[108:111]
    global_load_dwordx4 a[44:47], v124, s[42:43] offset:-1024 sc1
    s_add_u32 s10, s10, 10489856
    s_waitcnt lgkmcnt(13)
    v_mfma_f32_16x16x32_bf16 v[96:99], v[196:199], v[64:67], v[96:99]
    s_waitcnt lgkmcnt(11)
    ds_read_b128 v[32:35], v112 offset:128
    v_lshl_add_u32 v10, v1, 4, s10
    v_mfma_f32_16x16x32_bf16 v[100:103], v[212:215], v[64:67], v[100:103]
    ds_read_b64 v[200:201], v118 offset:1664
    s_mov_b64 s[62:63], 0
    s_waitcnt lgkmcnt(11)
    v_mfma_f32_16x16x32_bf16 v[104:107], v[228:231], v[64:67], v[104:107]
    s_waitcnt lgkmcnt(9)
    ds_read_b64 v[202:203], v118 offset:1672
    v_lshlrev_b32 v7, 5, v2
    v_mfma_f32_16x16x32_bf16 v[108:111], v[244:247], v[64:67], v[108:111]
    s_waitcnt lgkmcnt(9)
    ds_read_b64 v[216:217], v118 offset:1152
    v_add_u32 v7, 147456, v7
    v_mfma_f32_16x16x32_bf16 v[96:99], v[180:183], v[68:71], v[96:99]
    ds_read_b64 v[218:219], v118 offset:1160
    global_load_dwordx4 a[48:51], v122, s[42:43] offset:0 sc1
    v_mfma_f32_16x16x32_bf16 v[100:103], v[196:199], v[68:71], v[100:103]
    ds_read_b64 v[232:233], v118 offset:640
    v_and_b32 v8, 31, v1
    v_mfma_f32_16x16x32_bf16 v[104:107], v[212:215], v[68:71], v[104:107]
    ds_read_b64 v[234:235], v118 offset:648
    v_lshlrev_b32 v8, 5, v8
    v_mfma_f32_16x16x32_bf16 v[108:111], v[228:231], v[68:71], v[108:111]
    s_waitcnt lgkmcnt(12)
    ds_read_b64 v[248:249], v118 offset:128
    v_add_u32 v8, 147456, v8
    v_mfma_f32_16x16x32_bf16 v[96:99], v[164:167], v[72:75], v[96:99]
    ds_read_b64 v[250:251], v118 offset:136
    s_lshr_b32 s10, s9, 3
    v_mfma_f32_16x16x32_bf16 v[100:103], v[180:183], v[72:75], v[100:103]
    ds_read_b128 v[36:39], v112 offset:640
    global_load_dwordx4 a[52:55], v123, s[42:43] offset:0 sc1
    v_mfma_f32_16x16x32_bf16 v[104:107], v[196:199], v[72:75], v[104:107]
    ds_read_b128 v[40:43], v112 offset:1152
    s_mul_i32 s10, s10, 45056
    v_lshl_add_u32 v29, v1, 2, s37
    v_mov_b32 v30, s52
    s_waitcnt vmcnt(14)
    v_mfma_f32_16x16x32_bf16 v[108:111], v[212:215], v[72:75], v[108:111]
    ds_read_b128 v[44:47], v112 offset:1664
    s_mul_i32 s11, s6, 720896
    s_barrier
    s_mov_b64 exec, 0xffff
    global_store_dword v29, v30, s[42:43] sc1
    s_mov_b64 exec, -1
    s_waitcnt lgkmcnt(15)
    v_mfma_f32_16x16x32_bf16 v[96:99], v[148:151], v[76:79], v[96:99]
    ds_read_b128 v[48:51], v112 offset:2176
    s_add_u32 s10, s10, s11
    v_mfma_f32_16x16x32_bf16 v[100:103], v[164:167], v[76:79], v[100:103]
    ds_read_b128 v[52:55], v112 offset:2688
    s_mul_i32 s11, s3, 11264
    v_mfma_f32_16x16x32_bf16 v[104:107], v[180:183], v[76:79], v[104:107]
    ds_read_b128 v[56:59], v112 offset:3200
    global_load_dwordx4 a[56:59], v124, s[42:43] offset:0 sc1
    v_mfma_f32_16x16x32_bf16 v[108:111], v[196:199], v[76:79], v[108:111]
    ds_read_b128 v[60:63], v112 offset:3712
    s_add_u32 s10, s10, s11
    v_mfma_f32_16x16x32_bf16 v[96:99], v[132:135], v[80:83], v[96:99]
    s_add_u32 s10, s10, 12587008
    v_lshl_add_u32 v11, v1, 4, s10
    v_add_u32 v12, 0x2000, v11
    v_mfma_f32_16x16x32_bf16 v[100:103], v[148:151], v[80:83], v[100:103]
    s_lshl_b32 s15, s98, 3
    s_add_u32 s15, s15, s57
    s_lshl_b32 s15, s15, 2
    v_mfma_f32_16x16x32_bf16 v[104:107], v[164:167], v[80:83], v[104:107]
    s_add_u32 s15, s15, s3
    s_lshl_b32 s15, s15, 10
    s_add_u32 s15, s15, 5242880
    v_mfma_f32_16x16x32_bf16 v[108:111], v[180:183], v[80:83], v[108:111]
    global_load_dwordx4 a[60:63], v122, s[42:43] offset:1024 sc1
    s_lshl_b32 s14, s3, 12
    s_waitcnt lgkmcnt(15)
    v_mfma_f32_16x16x32_bf16 v[100:103], v[132:135], v[84:87], v[100:103]
    s_add_u32 s14, s14, 131072
    s_lshl_b32 s11, s58, 6
    v_xor_b32 v13, s11, v5
    v_mfma_f32_16x16x32_bf16 v[104:107], v[148:151], v[84:87], v[104:107]
    v_add_u32 v13, s14, v13
    s_lshl_b32 s10, s3, 12
    v_mfma_f32_16x16x32_bf16 v[108:111], v[164:167], v[84:87], v[108:111]
    v_and_b32 v127, 7, v2
    v_xor_b32 v127, v127, v3
    v_mfma_f32_16x16x32_bf16 v[104:107], v[132:135], v[88:91], v[104:107]
    v_lshlrev_b32 v127, 4, v127
    v_lshl_add_u32 v127, v2, 8, v127
    v_mfma_f32_16x16x32_bf16 v[108:111], v[148:151], v[88:91], v[108:111]
    global_load_dwordx4 a[64:67], v123, s[42:43] offset:1024 sc1
    v_add_u32 v127, s10, v127
    v_mfma_f32_16x16x32_bf16 v[108:111], v[132:135], v[92:95], v[108:111]
    s_add_u32 s10, s3, 0
    s_and_b32 s10, s10, 3
    s_lshl_b32 s10, s10, 6
    s_waitcnt lgkmcnt(13)
    v_mfma_f32_16x16x32_bf16 v[96:99], v[200:203], v[32:35], v[96:99]
    s_waitcnt lgkmcnt(11)
    ds_read_b128 v[64:67], v112 offset:192
    v_xor_b32 v16, s10, v127
    v_mfma_f32_16x16x32_bf16 v[100:103], v[216:219], v[32:35], v[100:103]
    ds_read_b64 v[204:205], v118 offset:1728
    s_add_u32 s10, s3, 1
    s_waitcnt lgkmcnt(11)
    v_mfma_f32_16x16x32_bf16 v[104:107], v[232:235], v[32:35], v[104:107]
    ds_read_b64 v[206:207], v118 offset:1736
    s_and_b32 s10, s10, 3
    s_waitcnt lgkmcnt(10)
    v_mfma_f32_16x16x32_bf16 v[108:111], v[248:251], v[32:35], v[108:111]
    s_waitcnt lgkmcnt(9)
    ds_read_b64 v[220:221], v118 offset:1216
    global_load_dwordx4 a[68:71], v124, s[42:43] offset:1024 sc1
    v_mfma_f32_16x16x32_bf16 v[96:99], v[184:187], v[36:39], v[96:99]
    ds_read_b64 v[222:223], v118 offset:1224
    s_lshl_b32 s10, s10, 6
    v_mfma_f32_16x16x32_bf16 v[100:103], v[200:203], v[36:39], v[100:103]
    ds_read_b64 v[236:237], v118 offset:704
    v_xor_b32 v17, s10, v127
    v_mfma_f32_16x16x32_bf16 v[104:107], v[216:219], v[36:39], v[104:107]
    ds_read_b64 v[238:239], v118 offset:712
    s_add_u32 s10, s3, 2
    v_mfma_f32_16x16x32_bf16 v[108:111], v[232:235], v[36:39], v[108:111]
    ds_read_b64 v[252:253], v118 offset:192
    s_and_b32 s10, s10, 3
    s_waitcnt lgkmcnt(13)
    v_mfma_f32_16x16x32_bf16 v[96:99], v[168:171], v[40:43], v[96:99]
    ds_read_b64 v[254:255], v118 offset:200
    global_load_dwordx4 a[72:75], v122, s[42:43] offset:2048 sc1
    v_mfma_f32_16x16x32_bf16 v[100:103], v[184:187], v[40:43], v[100:103]
    ds_read_b128 v[68:71], v112 offset:704
    s_lshl_b32 s10, s10, 6
    v_mfma_f32_16x16x32_bf16 v[104:107], v[200:203], v[40:43], v[104:107]
    ds_read_b128 v[72:75], v112 offset:1216
    v_xor_b32 v18, s10, v127
    v_mfma_f32_16x16x32_bf16 v[108:111], v[216:219], v[40:43], v[108:111]
    ds_read_b128 v[76:79], v112 offset:1728
    s_add_u32 s10, s3, 3
    s_waitcnt lgkmcnt(15)
    v_mfma_f32_16x16x32_bf16 v[96:99], v[152:155], v[44:47], v[96:99]
    ds_read_b128 v[80:83], v112 offset:2240
    s_and_b32 s10, s10, 3
    v_mfma_f32_16x16x32_bf16 v[100:103], v[168:171], v[44:47], v[100:103]
    ds_read_b128 v[84:87], v112 offset:2752
    global_load_dwordx4 a[76:79], v123, s[42:43] offset:2048 sc1
    v_mfma_f32_16x16x32_bf16 v[104:107], v[184:187], v[44:47], v[104:107]
    ds_read_b128 v[88:91], v112 offset:3264
    s_lshl_b32 s10, s10, 6
    v_mfma_f32_16x16x32_bf16 v[108:111], v[200:203], v[44:47], v[108:111]
    ds_read_b128 v[92:95], v112 offset:3776
    v_xor_b32 v19, s10, v127
    v_mfma_f32_16x16x32_bf16 v[96:99], v[136:139], v[48:51], v[96:99]
    s_add_u32 m0, s12, 0
    s_nop 0
    global_load_lds_dwordx4 v4, s[42:43] offset:0 sc1
    v_lshrrev_b32 v127, 4, v0
    v_mfma_f32_16x16x32_bf16 v[100:103], v[152:155], v[48:51], v[100:103]
    global_load_lds_dwordx4 v4, s[42:43] offset:1024 sc1
    v_and_b32 v14, 7, v127
    v_mfma_f32_16x16x32_bf16 v[104:107], v[168:171], v[48:51], v[104:107]
    global_load_lds_dwordx4 v4, s[42:43] offset:2048 sc1
    global_load_dwordx4 a[80:83], v124, s[42:43] offset:2048 sc1
    v_mfma_f32_16x16x32_bf16 v[108:111], v[184:187], v[48:51], v[108:111]
    s_waitcnt lgkmcnt(15)
    global_load_lds_dwordx4 v4, s[42:43] offset:3072 sc1
    v_add_u32 v4, 4096, v4
    v_mfma_f32_16x16x32_bf16 v[100:103], v[136:139], v[52:55], v[100:103]
    s_add_u32 m0, s12, 4096
    s_nop 0
    global_load_lds_dwordx4 v4, s[42:43] offset:0 sc1
    v_xor_b32 v14, v14, v2
    v_mfma_f32_16x16x32_bf16 v[104:107], v[152:155], v[52:55], v[104:107]
    global_load_lds_dwordx4 v4, s[42:43] offset:1024 sc1
    v_lshlrev_b32 v14, 4, v14
    v_mfma_f32_16x16x32_bf16 v[108:111], v[168:171], v[52:55], v[108:111]
    global_load_lds_dwordx4 v4, s[42:43] offset:2048 sc1
    v_lshl_add_u32 v14, v127, 8, v14
    v_mfma_f32_16x16x32_bf16 v[104:107], v[136:139], v[56:59], v[104:107]
    global_load_lds_dwordx4 v4, s[42:43] offset:3072 sc1
    global_load_dwordx4 a[84:87], v122, s[42:43] offset:3072 sc1
    v_mfma_f32_16x16x32_bf16 v[108:111], v[152:155], v[56:59], v[108:111]
    s_lshl_b32 s10, s98, 15
    s_lshl_b32 s11, s58, 14
    s_add_u32 s10, s10, s11
    v_mfma_f32_16x16x32_bf16 v[108:111], v[136:139], v[60:63], v[108:111]
    s_lshl_b32 s11, s57, 7
    s_add_u32 s10, s10, s11
    v_add_u32 v4, 520192, v4
    s_waitcnt lgkmcnt(7)
    v_mfma_f32_16x16x32_bf16 v[108:111], v[252:255], v[64:67], v[108:111]
    s_waitcnt lgkmcnt(6)
    v_lshlrev_b32 v127, 10, v127
    v_lshl_add_u32 v127, v2, 3, v127
    v_mfma_f32_16x16x32_bf16 v[108:111], v[236:239], v[68:71], v[108:111]
    s_waitcnt lgkmcnt(5)
    v_add_u32 v15, s10, v127
    v_add_u32 v121, 0x100000, v121
    v_mfma_f32_16x16x32_bf16 v[108:111], v[220:223], v[72:75], v[108:111]
    global_load_dwordx4 a[88:91], v123, s[42:43] offset:3072 sc1
    s_mov_b32 s61, 0
    s_waitcnt lgkmcnt(4)
    v_mfma_f32_16x16x32_bf16 v[108:111], v[204:207], v[76:79], v[108:111]
    s_waitcnt lgkmcnt(3)
    ds_read_b128 v[48:51], v117 offset:2048
    v_mfma_f32_16x16x32_bf16 v[108:111], v[188:191], v[80:83], v[108:111]
    s_waitcnt lgkmcnt(3)
    v_mfma_f32_16x16x32_bf16 v[108:111], v[172:175], v[84:87], v[108:111]
    s_waitcnt lgkmcnt(2)
    v_mfma_f32_16x16x32_bf16 v[108:111], v[156:159], v[88:91], v[108:111]
    s_waitcnt lgkmcnt(1)
    v_mfma_f32_16x16x32_bf16 v[108:111], v[140:143], v[92:95], v[108:111]
    global_load_dwordx4 a[92:95], v124, s[42:43] offset:3072 sc1
    v_add_u32 v122, 0x2000, v122
    v_mfma_f32_16x16x32_bf16 v[104:107], v[236:239], v[64:67], v[104:107]
    v_add_u32 v123, 0x2000, v123
    v_add_u32 v124, 0x2000, v124
    v_mfma_f32_16x16x32_bf16 v[104:107], v[220:223], v[68:71], v[104:107]
    s_waitcnt lgkmcnt(0)
    v_lshlrev_b32 v56, 16, v48
    v_and_b32 v57, s60, v48
    v_mfma_f32_16x16x32_bf16 v[104:107], v[204:207], v[72:75], v[104:107]
    v_lshlrev_b32 v58, 16, v49
    v_and_b32 v59, s60, v49
    v_mfma_f32_16x16x32_bf16 v[104:107], v[188:191], v[76:79], v[104:107]
    v_lshlrev_b32 v60, 16, v50
    v_and_b32 v61, s60, v50
    v_mfma_f32_16x16x32_bf16 v[104:107], v[172:175], v[80:83], v[104:107]
    ds_write_b128 v113, v[108:111] offset:3072
    global_load_dwordx4 a[96:99], v122, s[42:43] offset:-4096 sc1
    v_mfma_f32_16x16x32_bf16 v[104:107], v[156:159], v[84:87], v[104:107]
    v_lshlrev_b32 v62, 16, v51
    v_and_b32 v63, s60, v51
    v_mfma_f32_16x16x32_bf16 v[104:107], v[140:143], v[88:91], v[104:107]
    v_mfma_f32_16x16x32_bf16 v[100:103], v[220:223], v[64:67], v[100:103]
    v_mfma_f32_16x16x32_bf16 v[100:103], v[204:207], v[68:71], v[100:103]
    v_mfma_f32_16x16x32_bf16 v[100:103], v[188:191], v[72:75], v[100:103]
    global_load_dwordx4 a[100:103], v123, s[42:43] offset:-4096 sc1
    v_mfma_f32_16x16x32_bf16 v[100:103], v[172:175], v[76:79], v[100:103]
    v_mfma_f32_16x16x32_bf16 v[100:103], v[156:159], v[80:83], v[100:103]
    s_nop 1
    ds_write_b128 v113, v[104:107] offset:2048
    v_mfma_f32_16x16x32_bf16 v[100:103], v[140:143], v[84:87], v[100:103]
    v_mfma_f32_16x16x32_bf16 v[96:99], v[204:207], v[64:67], v[96:99]
    v_mfma_f32_16x16x32_bf16 v[96:99], v[188:191], v[68:71], v[96:99]
    global_load_dwordx4 a[104:107], v124, s[42:43] offset:-4096 sc1
    v_mfma_f32_16x16x32_bf16 v[96:99], v[172:175], v[72:75], v[96:99]
    v_mfma_f32_16x16x32_bf16 v[96:99], v[156:159], v[76:79], v[96:99]
    v_mfma_f32_16x16x32_bf16 v[96:99], v[140:143], v[80:83], v[96:99]
    s_nop 1
    ds_write_b128 v113, v[100:103] offset:1024
    s_nop 4
    ds_write_b128 v113, v[96:99] offset:0
    global_load_dwordx4 a[108:111], v122, s[42:43] offset:-3072 sc1
    global_load_dwordx4 a[112:115], v123, s[42:43] offset:-3072 sc1
    global_load_dwordx4 a[116:119], v124, s[42:43] offset:-3072 sc1
    global_load_dwordx4 a[120:123], v122, s[42:43] offset:-2048 sc1
    v_lshlrev_b32 v104, 6, v0
    v_add_u32 v104, 294912, v104
    s_mov_b32 s59, 0
L_h0:
    v_lshl_add_u32 v127, v2, 2, s12
    v_lshl_add_u32 v127, v1, 7, v127
    s_waitcnt vmcnt(10)
    ds_read2_b32 v[128:129], v127 offset0:0 offset1:16
    s_waitcnt lgkmcnt(0)
    v_max_u32 v128, v128, v129
    v_cmp_eq_u32 vcc, -1, v128
    s_cbranch_vccnz L_h0r
L_h0ok:
    s_barrier
    global_load_dword v105, v104, s[42:43] sc1
    s_cmp_eq_u32 s3, 3
    s_cbranch_scc1 L_g1w3
    ds_read_b64_tr_b16 v[80:81], v5 offset:0
    ds_read_b64_tr_b16 v[82:83], v5 offset:1024
    ds_read_b64_tr_b16 v[84:85], v6 offset:0
    ds_read_b64_tr_b16 v[86:87], v6 offset:1024
    ds_read_b64_tr_b16 v[88:89], v5 offset:2048
    ds_read_b64_tr_b16 v[90:91], v5 offset:3072
    ds_read_b64_tr_b16 v[92:93], v6 offset:2048
    ds_read_b64_tr_b16 v[94:95], v6 offset:3072
    s_waitcnt lgkmcnt(6)
    v_mfma_f32_16x16x32_bf16 v[32:35], a[0:3], v[80:83], 0
    ds_read_b64_tr_b16 v[96:97], v5 offset:4096
    ds_read_b64_tr_b16 v[98:99], v5 offset:5120
    ds_read_b128 v[240:243], v114 offset:0
    v_mfma_f32_16x16x32_bf16 v[40:43], a[4:7], v[80:83], 0
    global_load_dwordx4 a[124:127], v123, s[42:43] offset:-2048 sc1
    ds_read_b128 v[248:251], v114 offset:4096
    ds_read_b128 v[244:247], v115 offset:0
    v_mfma_f32_16x16x32_bf16 v[48:51], a[8:11], v[80:83], 0
    s_waitcnt lgkmcnt(9)
    ds_read_b128 v[252:255], v115 offset:4096
    v_mfma_f32_16x16x32_bf16 v[36:39], a[0:3], v[84:87], 0
    ds_read_b64_tr_b16 v[100:101], v6 offset:4096
    ds_read_b64_tr_b16 v[102:103], v6 offset:5120
    v_mfma_f32_16x16x32_bf16 v[44:47], a[4:7], v[84:87], 0
    global_load_dwordx4 a[128:131], v124, s[42:43] offset:-2048 sc1
    v_mfma_f32_16x16x32_bf16 v[52:55], a[8:11], v[84:87], 0
    s_waitcnt lgkmcnt(10)
    v_mfma_f32_16x16x32_bf16 v[32:35], a[12:15], v[88:91], v[32:35]
    ds_read_b64_tr_b16 v[80:81], v5 offset:6144
    ds_read_b64_tr_b16 v[82:83], v5 offset:7168
    v_mfma_f32_16x16x32_bf16 v[40:43], a[16:19], v[88:91], v[40:43]
    global_load_dwordx4 a[132:135], v122, s[42:43] offset:-1024 sc1
    s_waitcnt lgkmcnt(7)
    v_add_f32 v240, v240, v56
    v_add_f32 v241, v241, v57
    v_mfma_f32_16x16x32_bf16 v[48:51], a[20:23], v[88:91], v[48:51]
    v_add_f32 v242, v242, v58
    v_add_f32 v243, v243, v59
    s_waitcnt lgkmcnt(5)
    v_add_f32 v244, v244, v60
    v_mfma_f32_16x16x32_bf16 v[36:39], a[12:15], v[92:95], v[36:39]
    ds_read_b64_tr_b16 v[84:85], v6 offset:6144
    ds_read_b64_tr_b16 v[86:87], v6 offset:7168
    v_add_f32 v245, v245, v61
    v_mfma_f32_16x16x32_bf16 v[44:47], a[16:19], v[92:95], v[44:47]
    global_load_dwordx4 a[136:139], v123, s[42:43] offset:-1024 sc1
    v_add_f32 v246, v246, v62
    v_add_f32 v247, v247, v63
    v_mfma_f32_16x16x32_bf16 v[52:55], a[20:23], v[92:95], v[52:55]
    v_add_f32 v240, v240, v248
    v_add_f32 v241, v241, v249
    v_add_f32 v242, v242, v250
    v_mfma_f32_16x16x32_bf16 v[32:35], a[24:27], v[96:99], v[32:35]
    ds_read_b64_tr_b16 v[88:89], v5 offset:8192
    ds_read_b64_tr_b16 v[90:91], v5 offset:9216
    v_add_f32 v243, v243, v251
    v_mfma_f32_16x16x32_bf16 v[40:43], a[28:31], v[96:99], v[40:43]
    global_load_dwordx4 a[140:143], v124, s[42:43] offset:-1024 sc1
    s_waitcnt lgkmcnt(8)
    v_add_f32 v244, v244, v252
    v_add_f32 v245, v245, v253
    v_mfma_f32_16x16x32_bf16 v[48:51], a[32:35], v[96:99], v[48:51]
    s_waitcnt lgkmcnt(6)
    v_add_f32 v246, v246, v254
    v_add_f32 v247, v247, v255
    v_cvt_pk_bf16_f32 v252, v240, v241
    v_mfma_f32_16x16x32_bf16 v[36:39], a[24:27], v[100:103], v[36:39]
    ds_read_b64_tr_b16 v[92:93], v6 offset:8192
    ds_read_b64_tr_b16 v[94:95], v6 offset:9216
    v_cvt_pk_bf16_f32 v253, v242, v243
    v_mfma_f32_16x16x32_bf16 v[44:47], a[28:31], v[100:103], v[44:47]
    global_load_dwordx4 a[144:147], v122, s[42:43] offset:0 sc1
    v_cvt_pk_bf16_f32 v254, v244, v245
    v_cvt_pk_bf16_f32 v255, v246, v247
    v_mfma_f32_16x16x32_bf16 v[52:55], a[32:35], v[100:103], v[52:55]
    s_cmp_lg_u32 s61, 0
    s_cbranch_scc1 L_noba
    global_store_dwordx4 v121, v[252:255], s[42:43] sc1
L_noba:
    s_waitcnt lgkmcnt(6)
    v_mfma_f32_16x16x32_bf16 v[32:35], a[36:39], v[80:83], v[32:35]
    ds_read_b64_tr_b16 v[96:97], v5 offset:10240
    ds_read_b64_tr_b16 v[98:99], v5 offset:11264
    v_mfma_f32_16x16x32_bf16 v[40:43], a[40:43], v[80:83], v[40:43]
    global_load_dwordx4 a[148:151], v123, s[42:43] offset:0 sc1
    v_mfma_f32_16x16x32_bf16 v[48:51], a[44:47], v[80:83], v[48:51]
    s_waitcnt lgkmcnt(6)
    v_mfma_f32_16x16x32_bf16 v[36:39], a[36:39], v[84:87], v[36:39]
    ds_read_b64_tr_b16 v[100:101], v6 offset:10240
    ds_read_b64_tr_b16 v[102:103], v6 offset:11264
    v_mfma_f32_16x16x32_bf16 v[44:47], a[40:43], v[84:87], v[44:47]
    global_load_dwordx4 a[152:155], v124, s[42:43] offset:0 sc1
    v_mfma_f32_16x16x32_bf16 v[52:55], a[44:47], v[84:87], v[52:55]
    s_waitcnt lgkmcnt(6)
    v_mfma_f32_16x16x32_bf16 v[32:35], a[48:51], v[88:91], v[32:35]
    ds_read_b64_tr_b16 v[80:81], v5 offset:12288
    ds_read_b64_tr_b16 v[82:83], v5 offset:13312
    v_mfma_f32_16x16x32_bf16 v[40:43], a[52:55], v[88:91], v[40:43]
    global_load_dwordx4 a[156:159], v122, s[42:43] offset:1024 sc1
    v_mfma_f32_16x16x32_bf16 v[48:51], a[56:59], v[88:91], v[48:51]
    s_waitcnt lgkmcnt(6)
    v_mfma_f32_16x16x32_bf16 v[36:39], a[48:51], v[92:95], v[36:39]
    ds_read_b64_tr_b16 v[84:85], v6 offset:12288
    ds_read_b64_tr_b16 v[86:87], v6 offset:13312
    v_mfma_f32_16x16x32_bf16 v[44:47], a[52:55], v[92:95], v[44:47]
    global_load_dwordx4 a[160:163], v123, s[42:43] offset:1024 sc1
    v_mfma_f32_16x16x32_bf16 v[52:55], a[56:59], v[92:95], v[52:55]
    s_waitcnt lgkmcnt(6)
    v_mfma_f32_16x16x32_bf16 v[32:35], a[60:63], v[96:99], v[32:35]
    ds_read_b64_tr_b16 v[88:89], v5 offset:14336
    ds_read_b64_tr_b16 v[90:91], v5 offset:15360
    v_mfma_f32_16x16x32_bf16 v[40:43], a[64:67], v[96:99], v[40:43]
    global_load_dwordx4 a[164:167], v124, s[42:43] offset:1024 sc1
    v_mfma_f32_16x16x32_bf16 v[48:51], a[68:71], v[96:99], v[48:51]
    s_waitcnt lgkmcnt(6)
    v_mfma_f32_16x16x32_bf16 v[36:39], a[60:63], v[100:103], v[36:39]
    ds_read_b64_tr_b16 v[92:93], v6 offset:14336
    ds_read_b64_tr_b16 v[94:95], v6 offset:15360
    v_mfma_f32_16x16x32_bf16 v[44:47], a[64:67], v[100:103], v[44:47]
    global_load_dwordx4 a[168:171], v122, s[42:43] offset:2048 sc1
    v_mfma_f32_16x16x32_bf16 v[52:55], a[68:71], v[100:103], v[52:55]
    s_waitcnt lgkmcnt(6)
    v_mfma_f32_16x16x32_bf16 v[32:35], a[72:75], v[80:83], v[32:35]
    ds_read_b64_tr_b16 v[96:97], v5 offset:16384
    ds_read_b64_tr_b16 v[98:99], v5 offset:17408
    v_mfma_f32_16x16x32_bf16 v[40:43], a[76:79], v[80:83], v[40:43]
    global_load_dwordx4 a[172:175], v123, s[42:43] offset:2048 sc1
    v_mfma_f32_16x16x32_bf16 v[48:51], a[80:83], v[80:83], v[48:51]
    s_waitcnt lgkmcnt(6)
    v_mfma_f32_16x16x32_bf16 v[36:39], a[72:75], v[84:87], v[36:39]
    ds_read_b64_tr_b16 v[100:101], v6 offset:16384
    ds_read_b64_tr_b16 v[102:103], v6 offset:17408
    v_mfma_f32_16x16x32_bf16 v[44:47], a[76:79], v[84:87], v[44:47]
    global_load_dwordx4 a[176:179], v124, s[42:43] offset:2048 sc1
    global_load_dword v20, v125, s[42:43] offset:0 sc1
    v_mfma_f32_16x16x32_bf16 v[52:55], a[80:83], v[84:87], v[52:55]
    s_waitcnt vmcnt(25) lgkmcnt(6)
    global_load_dword v21, v125, s[42:43] offset:256 sc1
    v_mfma_f32_16x16x32_bf16 v[32:35], a[84:87], v[88:91], v[32:35]
    s_waitcnt vmcnt(25)
    ds_read_b64_tr_b16 v[80:81], v5 offset:18432
    ds_read_b64_tr_b16 v[82:83], v5 offset:19456
    v_mfma_f32_16x16x32_bf16 v[40:43], a[88:91], v[88:91], v[40:43]
    s_waitcnt vmcnt(24)
    global_load_dwordx4 a[180:183], v122, s[42:43] offset:3072 sc1
    global_load_dword v22, v125, s[42:43] offset:512 sc1
    v_mfma_f32_16x16x32_bf16 v[48:51], a[92:95], v[88:91], v[48:51]
    s_waitcnt lgkmcnt(6)
    global_load_dword v23, v125, s[42:43] offset:768 sc1
    v_mfma_f32_16x16x32_bf16 v[36:39], a[84:87], v[92:95], v[36:39]
    ds_read_b64_tr_b16 v[84:85], v6 offset:18432
    ds_read_b64_tr_b16 v[86:87], v6 offset:19456
    v_mfma_f32_16x16x32_bf16 v[44:47], a[88:91], v[92:95], v[44:47]
    global_load_dwordx4 a[184:187], v123, s[42:43] offset:3072 sc1
    global_load_dword v24, v125, s[42:43] offset:1024 sc1
    v_mfma_f32_16x16x32_bf16 v[52:55], a[92:95], v[92:95], v[52:55]
    s_waitcnt vmcnt(28) lgkmcnt(6)
    global_load_dword v25, v125, s[42:43] offset:1280 sc1
    v_mfma_f32_16x16x32_bf16 v[32:35], a[96:99], v[96:99], v[32:35]
    s_waitcnt vmcnt(28)
    ds_read_b64_tr_b16 v[88:89], v5 offset:20480
    ds_read_b64_tr_b16 v[90:91], v5 offset:21504
    v_mfma_f32_16x16x32_bf16 v[40:43], a[100:103], v[96:99], v[40:43]
    global_load_dwordx4 a[188:191], v124, s[42:43] offset:3072 sc1
    s_add_u32 m0, s12, 32768
    s_waitcnt vmcnt(28)
    v_mfma_f32_16x16x32_bf16 v[48:51], a[104:107], v[96:99], v[48:51]
    s_waitcnt lgkmcnt(6)
    global_load_dword v26, v125, s[42:43] offset:1536 sc1
    v_mfma_f32_16x16x32_bf16 v[36:39], a[96:99], v[100:103], v[36:39]
    ds_read_b64_tr_b16 v[92:93], v6 offset:20480
    ds_read_b64_tr_b16 v[94:95], v6 offset:21504
    v_mfma_f32_16x16x32_bf16 v[44:47], a[100:103], v[100:103], v[44:47]
    global_load_lds_dwordx4 v4, s[42:43] offset:0 sc1
    global_load_dword v27, v125, s[42:43] offset:1792 sc1
    v_mfma_f32_16x16x32_bf16 v[52:55], a[104:107], v[100:103], v[52:55]
    s_waitcnt vmcnt(30) lgkmcnt(6)
    global_load_dword v28, v125, s[42:43] offset:2048 sc1
    v_mfma_f32_16x16x32_bf16 v[32:35], a[108:111], v[80:83], v[32:35]
    s_waitcnt vmcnt(30)
    ds_read_b64_tr_b16 v[96:97], v5 offset:22528
    ds_read_b64_tr_b16 v[98:99], v5 offset:23552
    v_mfma_f32_16x16x32_bf16 v[40:43], a[112:115], v[80:83], v[40:43]
    s_waitcnt vmcnt(29)
    global_load_lds_dwordx4 v4, s[42:43] offset:1024 sc1
    global_load_dword v29, v125, s[42:43] offset:2304 sc1
    v_mfma_f32_16x16x32_bf16 v[48:51], a[116:119], v[80:83], v[48:51]
    s_waitcnt lgkmcnt(6)
    global_load_dword v30, v125, s[42:43] offset:2560 sc1
    v_mfma_f32_16x16x32_bf16 v[36:39], a[108:111], v[84:87], v[36:39]
    ds_read_b64_tr_b16 v[100:101], v6 offset:22528
    ds_read_b64_tr_b16 v[102:103], v6 offset:23552
    v_mfma_f32_16x16x32_bf16 v[44:47], a[112:115], v[84:87], v[44:47]
    global_load_lds_dwordx4 v4, s[42:43] offset:2048 sc1
    global_load_dword v31, v125, s[42:43] offset:2816 sc1
    v_mfma_f32_16x16x32_bf16 v[52:55], a[116:119], v[84:87], v[52:55]
    s_waitcnt vmcnt(33) lgkmcnt(6)
    v_mfma_f32_16x16x32_bf16 v[32:35], a[120:123], v[88:91], v[32:35]
    s_waitcnt vmcnt(31)
    ds_read_b64_tr_b16 v[80:81], v5 offset:24576
    ds_read_b64_tr_b16 v[82:83], v5 offset:25600
    v_mfma_f32_16x16x32_bf16 v[40:43], a[124:127], v[88:91], v[40:43]
    s_waitcnt vmcnt(30)
    global_load_lds_dwordx4 v4, s[42:43] offset:3072 sc1
    v_add_u32 v4, 4096, v4
    v_mfma_f32_16x16x32_bf16 v[48:51], a[128:131], v[88:91], v[48:51]
    s_add_u32 m0, s12, 36864
    s_waitcnt lgkmcnt(6)
    v_mfma_f32_16x16x32_bf16 v[36:39], a[120:123], v[92:95], v[36:39]
    ds_read_b64_tr_b16 v[84:85], v6 offset:24576
    ds_read_b64_tr_b16 v[86:87], v6 offset:25600
    v_mfma_f32_16x16x32_bf16 v[44:47], a[124:127], v[92:95], v[44:47]
    global_load_lds_dwordx4 v4, s[42:43] offset:0 sc1
    v_mfma_f32_16x16x32_bf16 v[52:55], a[128:131], v[92:95], v[52:55]
    s_waitcnt vmcnt(31) lgkmcnt(6)
    v_mfma_f32_16x16x32_bf16 v[32:35], a[132:135], v[96:99], v[32:35]
    s_waitcnt vmcnt(30)
    ds_read_b64_tr_b16 v[88:89], v5 offset:26624
    ds_read_b64_tr_b16 v[90:91], v5 offset:27648
    v_mfma_f32_16x16x32_bf16 v[40:43], a[136:139], v[96:99], v[40:43]
    s_waitcnt vmcnt(29)
    global_load_lds_dwordx4 v4, s[42:43] offset:1024 sc1
    v_mfma_f32_16x16x32_bf16 v[48:51], a[140:143], v[96:99], v[48:51]
    s_waitcnt lgkmcnt(6)
    v_mfma_f32_16x16x32_bf16 v[36:39], a[132:135], v[100:103], v[36:39]
    ds_read_b64_tr_b16 v[92:93], v6 offset:26624
    ds_read_b64_tr_b16 v[94:95], v6 offset:27648
    v_mfma_f32_16x16x32_bf16 v[44:47], a[136:139], v[100:103], v[44:47]
    global_load_lds_dwordx4 v4, s[42:43] offset:2048 sc1
    v_mfma_f32_16x16x32_bf16 v[52:55], a[140:143], v[100:103], v[52:55]
    s_waitcnt vmcnt(30) lgkmcnt(6)
    v_mfma_f32_16x16x32_bf16 v[32:35], a[144:147], v[80:83], v[32:35]
    s_waitcnt vmcnt(29)
    ds_read_b64_tr_b16 v[96:97], v5 offset:28672
    ds_read_b64_tr_b16 v[98:99], v5 offset:29696
    v_mfma_f32_16x16x32_bf16 v[40:43], a[148:151], v[80:83], v[40:43]
    s_waitcnt vmcnt(28)
    global_load_lds_dwordx4 v4, s[42:43] offset:3072 sc1
    v_add_u32 v4, 520192, v4
    v_cmp_ne_u32 vcc, s52, v105
    v_mfma_f32_16x16x32_bf16 v[48:51], a[152:155], v[80:83], v[48:51]
    s_cbranch_vccnz L_flra
L_floka:
    s_barrier
    global_load_dwordx4 a[192:195], v10, s[42:43] offset:-4096 sc1
    s_waitcnt lgkmcnt(6)
    v_mfma_f32_16x16x32_bf16 v[36:39], a[144:147], v[84:87], v[36:39]
    ds_read_b64_tr_b16 v[100:101], v6 offset:28672
    ds_read_b64_tr_b16 v[102:103], v6 offset:29696
    v_mfma_f32_16x16x32_bf16 v[44:47], a[148:151], v[84:87], v[44:47]
    v_mfma_f32_16x16x32_bf16 v[52:55], a[152:155], v[84:87], v[52:55]
    s_waitcnt vmcnt(29) lgkmcnt(6)
    v_mfma_f32_16x16x32_bf16 v[32:35], a[156:159], v[88:91], v[32:35]
    s_waitcnt vmcnt(28)
    ds_read_b64_tr_b16 v[80:81], v5 offset:30720
    ds_read_b64_tr_b16 v[82:83], v5 offset:31744
    v_mfma_f32_16x16x32_bf16 v[40:43], a[160:163], v[88:91], v[40:43]
    s_waitcnt vmcnt(27)
    global_load_dwordx4 a[196:199], v10, s[42:43] offset:-3072 sc1
    v_mfma_f32_16x16x32_bf16 v[48:51], a[164:167], v[88:91], v[48:51]
    s_waitcnt lgkmcnt(6)
    v_mfma_f32_16x16x32_bf16 v[36:39], a[156:159], v[92:95], v[36:39]
    ds_read_b64_tr_b16 v[84:85], v6 offset:30720
    ds_read_b64_tr_b16 v[86:87], v6 offset:31744
    v_mfma_f32_16x16x32_bf16 v[44:47], a[160:163], v[92:95], v[44:47]
    v_mfma_f32_16x16x32_bf16 v[52:55], a[164:167], v[92:95], v[52:55]
    s_waitcnt vmcnt(2)
    s_barrier
    v_add_u32 v5, 0x8000, v5
    v_add_u32 v6, 0x8000, v6
    s_waitcnt lgkmcnt(6)
    v_mfma_f32_16x16x32_bf16 v[32:35], a[168:171], v[96:99], v[32:35]
    ds_read_b64_tr_b16 v[88:89], v5 offset:0
    ds_read_b64_tr_b16 v[90:91], v5 offset:1024
    v_mfma_f32_16x16x32_bf16 v[40:43], a[172:175], v[96:99], v[40:43]
    global_load_dwordx4 a[200:203], v10, s[42:43] offset:-2048 sc1
    v_mfma_f32_16x16x32_bf16 v[48:51], a[176:179], v[96:99], v[48:51]
    s_waitcnt lgkmcnt(6)
    v_mfma_f32_16x16x32_bf16 v[36:39], a[168:171], v[100:103], v[36:39]
    ds_read_b64_tr_b16 v[92:93], v6 offset:0
    ds_read_b64_tr_b16 v[94:95], v6 offset:1024
    v_mfma_f32_16x16x32_bf16 v[44:47], a[172:175], v[100:103], v[44:47]
    v_mfma_f32_16x16x32_bf16 v[52:55], a[176:179], v[100:103], v[52:55]
    s_waitcnt lgkmcnt(6)
    v_mfma_f32_16x16x32_bf16 v[32:35], a[180:183], v[80:83], v[32:35]
    ds_read_b64_tr_b16 v[96:97], v5 offset:2048
    ds_read_b64_tr_b16 v[98:99], v5 offset:3072
    v_mfma_f32_16x16x32_bf16 v[40:43], a[184:187], v[80:83], v[40:43]
    global_load_dwordx4 a[204:207], v10, s[42:43] offset:-1024 sc1
    v_mfma_f32_16x16x32_bf16 v[48:51], a[188:191], v[80:83], v[48:51]
    s_waitcnt lgkmcnt(6)
    v_mfma_f32_16x16x32_bf16 v[36:39], a[180:183], v[84:87], v[36:39]
    ds_read_b64_tr_b16 v[100:101], v6 offset:2048
    ds_read_b64_tr_b16 v[102:103], v6 offset:3072
    v_mfma_f32_16x16x32_bf16 v[44:47], a[184:187], v[84:87], v[44:47]
    v_mfma_f32_16x16x32_bf16 v[52:55], a[188:191], v[84:87], v[52:55]
    s_add_u32 s10, s2, s3
    s_cmp_lg_u32 s10, 0
    s_cbranch_scc0 L_bump
L_bumped:
    s_waitcnt lgkmcnt(6)
    v_mfma_f32_16x16x32_bf16 v[56:59], a[0:3], v[88:91], 0
    ds_read_b64_tr_b16 v[80:81], v5 offset:4096
    ds_read_b64_tr_b16 v[82:83], v5 offset:5120
    v_mfma_f32_16x16x32_bf16 v[64:67], a[4:7], v[88:91], 0
    s_add_u32 m0, s12, 65536
    s_nop 0
    global_load_lds_dwordx4 v4, s[42:43] offset:0 sc1
    v_mfma_f32_16x16x32_bf16 v[72:75], a[8:11], v[88:91], 0
    s_waitcnt lgkmcnt(6)
    v_mfma_f32_16x16x32_bf16 v[60:63], a[0:3], v[92:95], 0
    ds_read_b64_tr_b16 v[84:85], v6 offset:4096
    ds_read_b64_tr_b16 v[86:87], v6 offset:5120
    v_mfma_f32_16x16x32_bf16 v[68:71], a[4:7], v[92:95], 0
    global_load_lds_dwordx4 v4, s[42:43] offset:1024 sc1
    s_barrier
    v_mfma_f32_16x16x32_bf16 v[76:79], a[8:11], v[92:95], 0
    s_waitcnt lgkmcnt(6)
    ds_read_b128 v[104:107], v7 offset:0
    ds_read_b128 v[112:115], v7 offset:512
    v_mfma_f32_16x16x32_bf16 v[56:59], a[12:15], v[96:99], v[56:59]
    ds_read_b64_tr_b16 v[88:89], v5 offset:6144
    ds_read_b64_tr_b16 v[90:91], v5 offset:7168
    v_mfma_f32_16x16x32_bf16 v[64:67], a[16:19], v[96:99], v[64:67]
    global_load_lds_dwordx4 v4, s[42:43] offset:2048 sc1
    ds_read_b128 v[108:111], v7 offset:16
    v_mfma_f32_16x16x32_bf16 v[72:75], a[20:23], v[96:99], v[72:75]
    s_waitcnt lgkmcnt(9)
    ds_read_b128 v[116:119], v7 offset:528
    v_mfma_f32_16x16x32_bf16 v[60:63], a[12:15], v[100:103], v[60:63]
    ds_read_b64_tr_b16 v[92:93], v6 offset:6144
    ds_read_b64_tr_b16 v[94:95], v6 offset:7168
    v_mfma_f32_16x16x32_bf16 v[68:71], a[16:19], v[100:103], v[68:71]
    global_load_lds_dwordx4 v4, s[42:43] offset:3072 sc1
    v_add_u32 v4, 4096, v4
    v_mfma_f32_16x16x32_bf16 v[76:79], a[20:23], v[100:103], v[76:79]
    s_add_u32 m0, s12, 69632
    s_waitcnt lgkmcnt(10)
    v_mfma_f32_16x16x32_bf16 v[56:59], a[24:27], v[80:83], v[56:59]
    s_waitcnt lgkmcnt(7)
    ds_read_b64_tr_b16 v[96:97], v5 offset:8192
    ds_read_b64_tr_b16 v[98:99], v5 offset:9216
    v_mfma_f32_16x16x32_bf16 v[32:35], v[20:23], v[104:107], v[32:35]
    s_waitcnt lgkmcnt(8)
    v_mfma_f32_16x16x32_bf16 v[36:39], v[20:23], v[112:115], v[36:39]
    global_load_lds_dwordx4 v4, s[42:43] offset:0 sc1
    v_mfma_f32_16x16x32_bf16 v[64:67], a[28:31], v[80:83], v[64:67]
    v_mfma_f32_16x16x32_bf16 v[72:75], a[32:35], v[80:83], v[72:75]
    global_load_lds_dwordx4 v4, s[42:43] offset:1024 sc1
    s_waitcnt lgkmcnt(4)
    v_cmp_u_f32 vcc, v108, v116
    v_mfma_f32_16x16x32_bf16 v[60:63], a[24:27], v[84:87], v[60:63]
    ds_read_b64_tr_b16 v[100:101], v6 offset:8192
    ds_read_b64_tr_b16 v[102:103], v6 offset:9216
    v_mfma_f32_16x16x32_bf16 v[68:71], a[28:31], v[84:87], v[68:71]
    global_load_lds_dwordx4 v4, s[42:43] offset:2048 sc1
    s_or_b64 s[62:63], s[62:63], vcc
    v_mfma_f32_16x16x32_bf16 v[76:79], a[32:35], v[84:87], v[76:79]
    v_mul_f32 v111, v32, v32
    v_mul_f32 v119, v33, v33
    v_mfma_f32_16x16x32_bf16 v[56:59], a[36:39], v[88:91], v[56:59]
    ds_read_b64_tr_b16 v[80:81], v5 offset:10240
    ds_read_b64_tr_b16 v[82:83], v5 offset:11264
    v_mfma_f32_16x16x32_bf16 v[64:67], a[40:43], v[88:91], v[64:67]
    global_load_lds_dwordx4 v4, s[42:43] offset:3072 sc1
    v_add_u32 v4, 520192, v4
    v_mfma_f32_16x16x32_bf16 v[72:75], a[44:47], v[88:91], v[72:75]
    s_waitcnt lgkmcnt(6)
    global_load_dwordx4 a[208:211], v10, s[42:43] offset:0 sc1
    v_fma_f32 v111, v111, v109, v108
    v_mfma_f32_16x16x32_bf16 v[60:63], a[36:39], v[92:95], v[60:63]
    ds_read_b64_tr_b16 v[84:85], v6 offset:10240
    ds_read_b64_tr_b16 v[86:87], v6 offset:11264
    v_mfma_f32_16x16x32_bf16 v[68:71], a[40:43], v[92:95], v[68:71]
    v_fma_f32 v119, v119, v109, v108
    v_mul_f32 v111, v32, v111
    v_mfma_f32_16x16x32_bf16 v[76:79], a[44:47], v[92:95], v[76:79]
    s_waitcnt lgkmcnt(6)
    v_mul_f32 v119, v33, v119
    v_exp_f32 v111, v111
    v_mfma_f32_16x16x32_bf16 v[56:59], a[48:51], v[96:99], v[56:59]
    ds_read_b64_tr_b16 v[88:89], v5 offset:12288
    ds_read_b64_tr_b16 v[90:91], v5 offset:13312
    v_mfma_f32_16x16x32_bf16 v[64:67], a[52:55], v[96:99], v[64:67]
    global_load_dwordx4 a[212:215], v10, s[42:43] offset:1024 sc1
    v_exp_f32 v119, v119
    v_mfma_f32_16x16x32_bf16 v[72:75], a[56:59], v[96:99], v[72:75]
    s_waitcnt lgkmcnt(6)
    v_mul_f32 v35, v32, v35
    v_mul_f32 v34, v33, v34
    v_mfma_f32_16x16x32_bf16 v[60:63], a[48:51], v[100:103], v[60:63]
    ds_read_b64_tr_b16 v[92:93], v6 offset:12288
    ds_read_b64_tr_b16 v[94:95], v6 offset:13312
    v_mfma_f32_16x16x32_bf16 v[68:71], a[52:55], v[100:103], v[68:71]
    v_fma_f32 v111, v111, v110, v110
    v_fma_f32 v119, v119, v110, v110
    v_mfma_f32_16x16x32_bf16 v[76:79], a[56:59], v[100:103], v[76:79]
    s_waitcnt lgkmcnt(6)
    v_rcp_f32 v111, v111
    v_mfma_f32_16x16x32_bf16 v[56:59], a[60:63], v[80:83], v[56:59]
    ds_read_b64_tr_b16 v[96:97], v5 offset:14336
    ds_read_b64_tr_b16 v[98:99], v5 offset:15360
    v_mfma_f32_16x16x32_bf16 v[64:67], a[64:67], v[80:83], v[64:67]
    global_load_dwordx4 a[216:219], v10, s[42:43] offset:2048 sc1
    v_rcp_f32 v119, v119
    v_mfma_f32_16x16x32_bf16 v[72:75], a[68:71], v[80:83], v[72:75]
    s_waitcnt lgkmcnt(6)
    v_mul_f32 v111, v35, v111
    v_mul_f32 v119, v34, v119
    v_mfma_f32_16x16x32_bf16 v[60:63], a[60:63], v[84:87], v[60:63]
    ds_read_b64_tr_b16 v[100:101], v6 offset:14336
    ds_read_b64_tr_b16 v[102:103], v6 offset:15360
    v_mfma_f32_16x16x32_bf16 v[68:71], a[64:67], v[84:87], v[68:71]
    v_cvt_pk_bf16_f32 v120, v111, v119
    v_mfma_f32_16x16x32_bf16 v[40:43], v[24:27], v[104:107], v[40:43]
    v_mfma_f32_16x16x32_bf16 v[44:47], v[24:27], v[112:115], v[44:47]
    v_mul_f32 v111, v36, v36
    v_mul_f32 v119, v37, v37
    v_mfma_f32_16x16x32_bf16 v[76:79], a[68:71], v[84:87], v[76:79]
    s_waitcnt lgkmcnt(6)
    v_fma_f32 v111, v111, v117, v116
    v_fma_f32 v119, v119, v117, v116
    v_mfma_f32_16x16x32_bf16 v[56:59], a[72:75], v[88:91], v[56:59]
    ds_read_b64_tr_b16 v[80:81], v5 offset:16384
    ds_read_b64_tr_b16 v[82:83], v5 offset:17408
    v_mfma_f32_16x16x32_bf16 v[64:67], a[76:79], v[88:91], v[64:67]
    global_load_dwordx4 a[220:223], v10, s[42:43] offset:3072 sc1
    v_add_u32 v10, 0x2000, v10
    v_mfma_f32_16x16x32_bf16 v[72:75], a[80:83], v[88:91], v[72:75]
    s_waitcnt lgkmcnt(6)
    v_mul_f32 v111, v36, v111
    v_mul_f32 v119, v37, v119
    v_mfma_f32_16x16x32_bf16 v[60:63], a[72:75], v[92:95], v[60:63]
    ds_read_b64_tr_b16 v[84:85], v6 offset:16384
    ds_read_b64_tr_b16 v[86:87], v6 offset:17408
    v_mfma_f32_16x16x32_bf16 v[68:71], a[76:79], v[92:95], v[68:71]
    v_exp_f32 v111, v111
    v_mfma_f32_16x16x32_bf16 v[76:79], a[80:83], v[92:95], v[76:79]
    s_waitcnt lgkmcnt(6)
    v_exp_f32 v119, v119
    v_mfma_f32_16x16x32_bf16 v[56:59], a[84:87], v[96:99], v[56:59]
    ds_read_b64_tr_b16 v[88:89], v5 offset:18432
    ds_read_b64_tr_b16 v[90:91], v5 offset:19456
    v_mfma_f32_16x16x32_bf16 v[64:67], a[88:91], v[96:99], v[64:67]
    global_load_dwordx4 a[224:227], v10, s[42:43] offset:-4096 sc1
    v_mul_f32 v39, v36, v39
    v_mfma_f32_16x16x32_bf16 v[72:75], a[92:95], v[96:99], v[72:75]
    s_waitcnt lgkmcnt(6)
    v_mul_f32 v38, v37, v38
    v_fma_f32 v111, v111, v118, v118
    v_mfma_f32_16x16x32_bf16 v[60:63], a[84:87], v[100:103], v[60:63]
    ds_read_b64_tr_b16 v[92:93], v6 offset:18432
    ds_read_b64_tr_b16 v[94:95], v6 offset:19456
    v_mfma_f32_16x16x32_bf16 v[68:71], a[88:91], v[100:103], v[68:71]
    v_fma_f32 v119, v119, v118, v118
    v_rcp_f32 v111, v111
    v_mfma_f32_16x16x32_bf16 v[76:79], a[92:95], v[100:103], v[76:79]
    s_waitcnt lgkmcnt(6)
    v_rcp_f32 v119, v119
    v_mfma_f32_16x16x32_bf16 v[56:59], a[96:99], v[80:83], v[56:59]
    ds_read_b64_tr_b16 v[96:97], v5 offset:20480
    ds_read_b64_tr_b16 v[98:99], v5 offset:21504
    v_mfma_f32_16x16x32_bf16 v[64:67], a[100:103], v[80:83], v[64:67]
    global_load_dwordx4 a[228:231], v10, s[42:43] offset:-3072 sc1
    v_mul_f32 v111, v39, v111
    v_mfma_f32_16x16x32_bf16 v[72:75], a[104:107], v[80:83], v[72:75]
    s_waitcnt lgkmcnt(6)
    v_mul_f32 v119, v38, v119
    v_cvt_pk_bf16_f32 v121, v111, v119
    v_mfma_f32_16x16x32_bf16 v[60:63], a[96:99], v[84:87], v[60:63]
    ds_read_b64_tr_b16 v[100:101], v6 offset:20480
    ds_read_b64_tr_b16 v[102:103], v6 offset:21504
    v_mfma_f32_16x16x32_bf16 v[68:71], a[100:103], v[84:87], v[68:71]
    v_mul_f32 v111, v40, v40
    v_mul_f32 v119, v41, v41
    v_mfma_f32_16x16x32_bf16 v[76:79], a[104:107], v[84:87], v[76:79]
    s_waitcnt lgkmcnt(6)
    v_fma_f32 v111, v111, v109, v108
    v_fma_f32 v119, v119, v109, v108
    v_mfma_f32_16x16x32_bf16 v[56:59], a[108:111], v[88:91], v[56:59]
    ds_read_b64_tr_b16 v[80:81], v5 offset:22528
    ds_read_b64_tr_b16 v[82:83], v5 offset:23552
    v_mfma_f32_16x16x32_bf16 v[64:67], a[112:115], v[88:91], v[64:67]
    global_load_dwordx4 a[232:235], v10, s[42:43] offset:-2048 sc1
    v_mul_f32 v111, v40, v111
    v_mfma_f32_16x16x32_bf16 v[72:75], a[116:119], v[88:91], v[72:75]
    s_waitcnt lgkmcnt(6)
    v_mul_f32 v119, v41, v119
    v_exp_f32 v111, v111
    v_mfma_f32_16x16x32_bf16 v[60:63], a[108:111], v[92:95], v[60:63]
    ds_read_b64_tr_b16 v[84:85], v6 offset:22528
    ds_read_b64_tr_b16 v[86:87], v6 offset:23552
    v_mfma_f32_16x16x32_bf16 v[68:71], a[112:115], v[92:95], v[68:71]
    v_exp_f32 v119, v119
    v_mfma_f32_16x16x32_bf16 v[76:79], a[116:119], v[92:95], v[76:79]
    s_waitcnt lgkmcnt(6)
    v_mul_f32 v43, v40, v43
    v_mul_f32 v42, v41, v42
    v_mfma_f32_16x16x32_bf16 v[56:59], a[120:123], v[96:99], v[56:59]
    ds_read_b64_tr_b16 v[88:89], v5 offset:24576
    ds_read_b64_tr_b16 v[90:91], v5 offset:25600
    v_mfma_f32_16x16x32_bf16 v[64:67], a[124:127], v[96:99], v[64:67]
    global_load_dwordx4 a[236:239], v10, s[42:43] offset:-1024 sc1
    v_fma_f32 v111, v111, v110, v110
    v_mfma_f32_16x16x32_bf16 v[72:75], a[128:131], v[96:99], v[72:75]
    s_waitcnt lgkmcnt(6)
    v_fma_f32 v119, v119, v110, v110
    v_rcp_f32 v111, v111
    v_mfma_f32_16x16x32_bf16 v[60:63], a[120:123], v[100:103], v[60:63]
    ds_read_b64_tr_b16 v[92:93], v6 offset:24576
    ds_read_b64_tr_b16 v[94:95], v6 offset:25600
    v_mfma_f32_16x16x32_bf16 v[68:71], a[124:127], v[100:103], v[68:71]
    v_rcp_f32 v119, v119
    v_mfma_f32_16x16x32_bf16 v[76:79], a[128:131], v[100:103], v[76:79]
    s_waitcnt lgkmcnt(6)
    v_mul_f32 v111, v43, v111
    v_mul_f32 v119, v42, v119
    v_mfma_f32_16x16x32_bf16 v[56:59], a[132:135], v[80:83], v[56:59]
    ds_read_b64_tr_b16 v[96:97], v5 offset:26624
    ds_read_b64_tr_b16 v[98:99], v5 offset:27648
    v_lshl_add_u32 v253, v2, 2, s12
    v_mfma_f32_16x16x32_bf16 v[64:67], a[136:139], v[80:83], v[64:67]
    global_load_dwordx4 v[128:131], v10, s[42:43] offset:0 sc1
    v_cvt_pk_bf16_f32 v122, v111, v119
    v_lshl_add_u32 v253, v1, 7, v253
    v_mfma_f32_16x16x32_bf16 v[72:75], a[140:143], v[80:83], v[72:75]
    v_permlane16_swap_b32 v120, v121
    v_add_u32 v253, 0x10000, v253
    v_mfma_f32_16x16x32_bf16 v[48:51], v[28:31], v[104:107], v[48:51]
    v_mfma_f32_16x16x32_bf16 v[52:55], v[28:31], v[112:115], v[52:55]
    s_waitcnt vmcnt(9)
    ds_read2_b32 v[254:255], v253 offset0:0 offset1:16
    v_mul_f32 v111, v44, v44
    s_waitcnt lgkmcnt(7)
    v_mfma_f32_16x16x32_bf16 v[60:63], a[132:135], v[84:87], v[60:63]
    ds_read_b64_tr_b16 v[100:101], v6 offset:26624
    ds_read_b64_tr_b16 v[102:103], v6 offset:27648
    v_mfma_f32_16x16x32_bf16 v[68:71], a[136:139], v[84:87], v[68:71]
    v_mul_f32 v119, v45, v45
    v_fma_f32 v111, v111, v117, v116
    v_mfma_f32_16x16x32_bf16 v[76:79], a[140:143], v[84:87], v[76:79]
    s_waitcnt lgkmcnt(7)
    v_fma_f32 v119, v119, v117, v116
    v_mul_f32 v111, v44, v111
    v_mfma_f32_16x16x32_bf16 v[56:59], a[144:147], v[88:91], v[56:59]
    ds_read_b64_tr_b16 v[80:81], v5 offset:28672
    ds_read_b64_tr_b16 v[82:83], v5 offset:29696
    v_mfma_f32_16x16x32_bf16 v[64:67], a[148:151], v[88:91], v[64:67]
    global_load_dwordx4 v[132:135], v10, s[42:43] offset:1024 sc1
    v_mul_f32 v119, v45, v119
    s_waitcnt lgkmcnt(4)
    v_max_u32 v255, v254, v255
    v_mfma_f32_16x16x32_bf16 v[72:75], a[152:155], v[88:91], v[72:75]
    v_exp_f32 v111, v111
    v_cmp_eq_u32 vcc, -1, v255
    v_mfma_f32_16x16x32_bf16 v[60:63], a[144:147], v[92:95], v[60:63]
    ds_read_b64_tr_b16 v[84:85], v6 offset:28672
    ds_read_b64_tr_b16 v[86:87], v6 offset:29696
    s_cbranch_vccnz L_h2ra
L_h2oka:
    v_mfma_f32_16x16x32_bf16 v[68:71], a[148:151], v[92:95], v[68:71]
    v_exp_f32 v119, v119
    v_mfma_f32_16x16x32_bf16 v[76:79], a[152:155], v[92:95], v[76:79]
    v_mul_f32 v47, v44, v47
    v_mul_f32 v46, v45, v46
    v_mfma_f32_16x16x32_bf16 v[56:59], a[156:159], v[96:99], v[56:59]
    ds_read_b64_tr_b16 v[88:89], v5 offset:30720
    ds_read_b64_tr_b16 v[90:91], v5 offset:31744
    v_mfma_f32_16x16x32_bf16 v[64:67], a[160:163], v[96:99], v[64:67]
    global_load_dwordx4 v[136:139], v10, s[42:43] offset:2048 sc1
    v_fma_f32 v111, v111, v118, v118
    v_mfma_f32_16x16x32_bf16 v[72:75], a[164:167], v[96:99], v[72:75]
    s_waitcnt lgkmcnt(6)
    v_fma_f32 v119, v119, v118, v118
    v_rcp_f32 v111, v111
    v_mfma_f32_16x16x32_bf16 v[60:63], a[156:159], v[100:103], v[60:63]
    ds_read_b64_tr_b16 v[92:93], v6 offset:30720
    ds_read_b64_tr_b16 v[94:95], v6 offset:31744
    v_mfma_f32_16x16x32_bf16 v[68:71], a[160:163], v[100:103], v[68:71]
    v_rcp_f32 v119, v119
    v_mfma_f32_16x16x32_bf16 v[76:79], a[164:167], v[100:103], v[76:79]
    s_barrier
    v_add_u32 v5, 0x8000, v5
    v_add_u32 v6, 0x8000, v6
    s_waitcnt lgkmcnt(6)
    v_mfma_f32_16x16x32_bf16 v[56:59], a[168:171], v[80:83], v[56:59]
    ds_read_b64_tr_b16 v[96:97], v5 offset:0
    ds_read_b64_tr_b16 v[98:99], v5 offset:1024
    v_mfma_f32_16x16x32_bf16 v[64:67], a[172:175], v[80:83], v[64:67]
    global_load_dwordx4 v[140:143], v10, s[42:43] offset:3072 sc1
    v_add_u32 v10, 0x2000, v10
    v_mfma_f32_16x16x32_bf16 v[72:75], a[176:179], v[80:83], v[72:75]
    s_waitcnt lgkmcnt(6)
    v_mul_f32 v111, v47, v111
    v_mul_f32 v119, v46, v119
    v_mfma_f32_16x16x32_bf16 v[60:63], a[168:171], v[84:87], v[60:63]
    ds_read_b64_tr_b16 v[100:101], v6 offset:0
    ds_read_b64_tr_b16 v[102:103], v6 offset:1024
    v_mfma_f32_16x16x32_bf16 v[68:71], a[172:175], v[84:87], v[68:71]
    v_cvt_pk_bf16_f32 v123, v111, v119
    v_mul_f32 v111, v48, v48
    v_mfma_f32_16x16x32_bf16 v[76:79], a[176:179], v[84:87], v[76:79]
    s_waitcnt lgkmcnt(6)
    v_mul_f32 v119, v49, v49
    v_fma_f32 v111, v111, v109, v108
    v_mfma_f32_16x16x32_bf16 v[56:59], a[180:183], v[88:91], v[56:59]
    ds_read_b64_tr_b16 v[80:81], v5 offset:2048
    ds_read_b64_tr_b16 v[82:83], v5 offset:3072
    v_mfma_f32_16x16x32_bf16 v[64:67], a[184:187], v[88:91], v[64:67]
    global_load_dwordx4 v[144:147], v10, s[42:43] offset:-4096 sc1
    v_fma_f32 v119, v119, v109, v108
    v_mfma_f32_16x16x32_bf16 v[72:75], a[188:191], v[88:91], v[72:75]
    s_waitcnt lgkmcnt(6)
    v_mul_f32 v111, v48, v111
    v_mul_f32 v119, v49, v119
    v_mfma_f32_16x16x32_bf16 v[60:63], a[180:183], v[92:95], v[60:63]
    ds_read_b64_tr_b16 v[84:85], v6 offset:2048
    ds_read_b64_tr_b16 v[86:87], v6 offset:3072
    v_mfma_f32_16x16x32_bf16 v[68:71], a[184:187], v[92:95], v[68:71]
    v_exp_f32 v111, v111
    v_mfma_f32_16x16x32_bf16 v[76:79], a[188:191], v[92:95], v[76:79]
    v_exp_f32 v119, v119
    v_mul_f32 v51, v48, v51
    v_mul_f32 v50, v49, v50
    v_fma_f32 v111, v111, v110, v110
    v_fma_f32 v119, v119, v110, v110
    v_rcp_f32 v111, v111
    v_rcp_f32 v119, v119
    v_mul_f32 v111, v51, v111
    v_mul_f32 v119, v50, v119
    v_cvt_pk_bf16_f32 v124, v111, v119
    v_permlane16_swap_b32 v122, v123
    global_store_dwordx4 v9, v[120:123], s[42:43] sc1
    v_mul_f32 v111, v52, v52
    v_mul_f32 v119, v53, v53
    v_fma_f32 v111, v111, v117, v116
    v_fma_f32 v119, v119, v117, v116
    v_mul_f32 v111, v52, v111
    v_mul_f32 v119, v53, v119
    v_exp_f32 v111, v111
    v_exp_f32 v119, v119
    v_mul_f32 v55, v52, v55
    v_mul_f32 v54, v53, v54
    v_fma_f32 v111, v111, v118, v118
    v_fma_f32 v119, v119, v118, v118
    v_rcp_f32 v111, v111
    v_rcp_f32 v119, v119
    v_mul_f32 v111, v55, v111
    v_mul_f32 v119, v54, v119
    v_cvt_pk_bf16_f32 v125, v111, v119
    s_nop 1
    v_permlane16_swap_b32 v124, v125
    s_nop 1
    v_permlane32_swap_b32 v124, v126
    v_permlane32_swap_b32 v125, v127
    s_mov_b32 exec_hi, 0
    global_store_dwordx4 v9, v[124:127], s[42:43] offset:512 sc1
    s_mov_b32 exec_hi, -1
    v_add_u32 v9, 180224, v9
    s_waitcnt lgkmcnt(6)
    v_mfma_f32_16x16x32_bf16 v[32:35], a[0:3], v[96:99], 0
    ds_read_b64_tr_b16 v[88:89], v5 offset:4096
    ds_read_b64_tr_b16 v[90:91], v5 offset:5120
    v_mfma_f32_16x16x32_bf16 v[40:43], a[4:7], v[96:99], 0
    s_add_u32 m0, s12, 98304
    s_nop 0
    global_load_lds_dwordx4 v4, s[42:43] offset:0 sc1
    v_mfma_f32_16x16x32_bf16 v[48:51], a[8:11], v[96:99], 0
    s_waitcnt lgkmcnt(6)
    v_mfma_f32_16x16x32_bf16 v[36:39], a[0:3], v[100:103], 0
    ds_read_b64_tr_b16 v[92:93], v6 offset:4096
    ds_read_b64_tr_b16 v[94:95], v6 offset:5120
    v_mfma_f32_16x16x32_bf16 v[44:47], a[4:7], v[100:103], 0
    global_load_lds_dwordx4 v4, s[42:43] offset:1024 sc1
    s_barrier
    v_mfma_f32_16x16x32_bf16 v[52:55], a[8:11], v[100:103], 0
    s_waitcnt lgkmcnt(6)
    ds_read_b128 v[104:107], v7 offset:1024
    ds_read_b128 v[112:115], v7 offset:1536
    v_mfma_f32_16x16x32_bf16 v[32:35], a[12:15], v[80:83], v[32:35]
    ds_read_b64_tr_b16 v[96:97], v5 offset:6144
    ds_read_b64_tr_b16 v[98:99], v5 offset:7168
    v_mfma_f32_16x16x32_bf16 v[40:43], a[16:19], v[80:83], v[40:43]
    global_load_lds_dwordx4 v4, s[42:43] offset:2048 sc1
    ds_read_b128 v[108:111], v7 offset:1040
    v_mfma_f32_16x16x32_bf16 v[48:51], a[20:23], v[80:83], v[48:51]
    s_waitcnt lgkmcnt(9)
    ds_read_b128 v[116:119], v7 offset:1552
    v_mfma_f32_16x16x32_bf16 v[36:39], a[12:15], v[84:87], v[36:39]
    ds_read_b64_tr_b16 v[100:101], v6 offset:6144
    ds_read_b64_tr_b16 v[102:103], v6 offset:7168
    v_mfma_f32_16x16x32_bf16 v[44:47], a[16:19], v[84:87], v[44:47]
    global_load_lds_dwordx4 v4, s[42:43] offset:3072 sc1
    v_add_u32 v4, 4096, v4
    v_mfma_f32_16x16x32_bf16 v[52:55], a[20:23], v[84:87], v[52:55]
    s_add_u32 m0, s12, 102400
    s_waitcnt lgkmcnt(10)
    v_mfma_f32_16x16x32_bf16 v[32:35], a[24:27], v[88:91], v[32:35]
    s_waitcnt lgkmcnt(7)
    ds_read_b64_tr_b16 v[80:81], v5 offset:8192
    ds_read_b64_tr_b16 v[82:83], v5 offset:9216
    v_mfma_f32_16x16x32_bf16 v[56:59], v[20:23], v[104:107], v[56:59]
    s_waitcnt lgkmcnt(8)
    v_mfma_f32_16x16x32_bf16 v[60:63], v[20:23], v[112:115], v[60:63]
    global_load_lds_dwordx4 v4, s[42:43] offset:0 sc1
    v_mfma_f32_16x16x32_bf16 v[40:43], a[28:31], v[88:91], v[40:43]
    v_mfma_f32_16x16x32_bf16 v[48:51], a[32:35], v[88:91], v[48:51]
    global_load_lds_dwordx4 v4, s[42:43] offset:1024 sc1
    s_waitcnt lgkmcnt(4)
    v_cmp_u_f32 vcc, v108, v116
    v_mfma_f32_16x16x32_bf16 v[36:39], a[24:27], v[92:95], v[36:39]
    ds_read_b64_tr_b16 v[84:85], v6 offset:8192
    ds_read_b64_tr_b16 v[86:87], v6 offset:9216
    v_mfma_f32_16x16x32_bf16 v[44:47], a[28:31], v[92:95], v[44:47]
    global_load_lds_dwordx4 v4, s[42:43] offset:2048 sc1
    s_or_b64 s[62:63], s[62:63], vcc
    v_mfma_f32_16x16x32_bf16 v[52:55], a[32:35], v[92:95], v[52:55]
    v_mul_f32 v111, v56, v56
    v_mul_f32 v119, v57, v57
    v_mfma_f32_16x16x32_bf16 v[32:35], a[36:39], v[96:99], v[32:35]
    ds_read_b64_tr_b16 v[88:89], v5 offset:10240
    ds_read_b64_tr_b16 v[90:91], v5 offset:11264
    v_mfma_f32_16x16x32_bf16 v[40:43], a[40:43], v[96:99], v[40:43]
    global_load_lds_dwordx4 v4, s[42:43] offset:3072 sc1
    v_add_u32 v4, 520192, v4
    v_mfma_f32_16x16x32_bf16 v[48:51], a[44:47], v[96:99], v[48:51]
    s_waitcnt lgkmcnt(6)
    global_load_dwordx4 v[148:151], v10, s[42:43] offset:-3072 sc1
    v_fma_f32 v111, v111, v109, v108
    v_mfma_f32_16x16x32_bf16 v[36:39], a[36:39], v[100:103], v[36:39]
    ds_read_b64_tr_b16 v[92:93], v6 offset:10240
    ds_read_b64_tr_b16 v[94:95], v6 offset:11264
    v_mfma_f32_16x16x32_bf16 v[44:47], a[40:43], v[100:103], v[44:47]
    v_fma_f32 v119, v119, v109, v108
    v_mul_f32 v111, v56, v111
    v_mfma_f32_16x16x32_bf16 v[52:55], a[44:47], v[100:103], v[52:55]
    s_waitcnt lgkmcnt(6)
    v_mul_f32 v119, v57, v119
    v_exp_f32 v111, v111
    v_mfma_f32_16x16x32_bf16 v[32:35], a[48:51], v[80:83], v[32:35]
    ds_read_b64_tr_b16 v[96:97], v5 offset:12288
    ds_read_b64_tr_b16 v[98:99], v5 offset:13312
    v_mfma_f32_16x16x32_bf16 v[40:43], a[52:55], v[80:83], v[40:43]
    global_load_dwordx4 v[152:155], v10, s[42:43] offset:-2048 sc1
    v_exp_f32 v119, v119
    v_mfma_f32_16x16x32_bf16 v[48:51], a[56:59], v[80:83], v[48:51]
    s_waitcnt lgkmcnt(6)
    v_mul_f32 v59, v56, v59
    v_mul_f32 v58, v57, v58
    v_mfma_f32_16x16x32_bf16 v[36:39], a[48:51], v[84:87], v[36:39]
    ds_read_b64_tr_b16 v[100:101], v6 offset:12288
    ds_read_b64_tr_b16 v[102:103], v6 offset:13312
    v_mfma_f32_16x16x32_bf16 v[44:47], a[52:55], v[84:87], v[44:47]
    v_fma_f32 v111, v111, v110, v110
    v_fma_f32 v119, v119, v110, v110
    v_mfma_f32_16x16x32_bf16 v[52:55], a[56:59], v[84:87], v[52:55]
    s_waitcnt lgkmcnt(6)
    v_rcp_f32 v111, v111
    v_mfma_f32_16x16x32_bf16 v[32:35], a[60:63], v[88:91], v[32:35]
    ds_read_b64_tr_b16 v[80:81], v5 offset:14336
    ds_read_b64_tr_b16 v[82:83], v5 offset:15360
    v_mfma_f32_16x16x32_bf16 v[40:43], a[64:67], v[88:91], v[40:43]
    global_load_dwordx4 v[156:159], v10, s[42:43] offset:-1024 sc1
    v_rcp_f32 v119, v119
    v_mfma_f32_16x16x32_bf16 v[48:51], a[68:71], v[88:91], v[48:51]
    s_waitcnt lgkmcnt(6)
    v_mul_f32 v111, v59, v111
    v_mul_f32 v119, v58, v119
    v_mfma_f32_16x16x32_bf16 v[36:39], a[60:63], v[92:95], v[36:39]
    ds_read_b64_tr_b16 v[84:85], v6 offset:14336
    ds_read_b64_tr_b16 v[86:87], v6 offset:15360
    v_mfma_f32_16x16x32_bf16 v[44:47], a[64:67], v[92:95], v[44:47]
    v_cvt_pk_bf16_f32 v120, v111, v119
    v_mfma_f32_16x16x32_bf16 v[64:67], v[24:27], v[104:107], v[64:67]
    v_mfma_f32_16x16x32_bf16 v[68:71], v[24:27], v[112:115], v[68:71]
    v_mul_f32 v111, v60, v60
    v_mul_f32 v119, v61, v61
    v_mfma_f32_16x16x32_bf16 v[52:55], a[68:71], v[92:95], v[52:55]
    s_waitcnt lgkmcnt(6)
    v_fma_f32 v111, v111, v117, v116
    v_fma_f32 v119, v119, v117, v116
    v_mfma_f32_16x16x32_bf16 v[32:35], a[72:75], v[96:99], v[32:35]
    ds_read_b64_tr_b16 v[88:89], v5 offset:16384
    ds_read_b64_tr_b16 v[90:91], v5 offset:17408
    v_mfma_f32_16x16x32_bf16 v[40:43], a[76:79], v[96:99], v[40:43]
    global_load_dwordx4 v[160:163], v10, s[42:43] offset:0 sc1
    v_mul_f32 v111, v60, v111
    v_mfma_f32_16x16x32_bf16 v[48:51], a[80:83], v[96:99], v[48:51]
    s_waitcnt lgkmcnt(6)
    v_mul_f32 v119, v61, v119
    v_exp_f32 v111, v111
    v_mfma_f32_16x16x32_bf16 v[36:39], a[72:75], v[100:103], v[36:39]
    ds_read_b64_tr_b16 v[92:93], v6 offset:16384
    ds_read_b64_tr_b16 v[94:95], v6 offset:17408
    v_mfma_f32_16x16x32_bf16 v[44:47], a[76:79], v[100:103], v[44:47]
    v_exp_f32 v119, v119
    v_mfma_f32_16x16x32_bf16 v[52:55], a[80:83], v[100:103], v[52:55]
    s_waitcnt lgkmcnt(6)
    v_mul_f32 v63, v60, v63
    v_mul_f32 v62, v61, v62
    v_mfma_f32_16x16x32_bf16 v[32:35], a[84:87], v[80:83], v[32:35]
    ds_read_b64_tr_b16 v[96:97], v5 offset:18432
    ds_read_b64_tr_b16 v[98:99], v5 offset:19456
    v_mfma_f32_16x16x32_bf16 v[40:43], a[88:91], v[80:83], v[40:43]
    global_load_dwordx4 v[164:167], v10, s[42:43] offset:1024 sc1
    v_fma_f32 v111, v111, v118, v118
    v_mfma_f32_16x16x32_bf16 v[48:51], a[92:95], v[80:83], v[48:51]
    s_waitcnt lgkmcnt(6)
    v_fma_f32 v119, v119, v118, v118
    v_rcp_f32 v111, v111
    v_mfma_f32_16x16x32_bf16 v[36:39], a[84:87], v[84:87], v[36:39]
    ds_read_b64_tr_b16 v[100:101], v6 offset:18432
    ds_read_b64_tr_b16 v[102:103], v6 offset:19456
    v_mfma_f32_16x16x32_bf16 v[44:47], a[88:91], v[84:87], v[44:47]
    v_rcp_f32 v119, v119
    v_mfma_f32_16x16x32_bf16 v[52:55], a[92:95], v[84:87], v[52:55]
    s_waitcnt lgkmcnt(6)
    v_mul_f32 v111, v63, v111
    v_mul_f32 v119, v62, v119
    v_mfma_f32_16x16x32_bf16 v[32:35], a[96:99], v[88:91], v[32:35]
    ds_read_b64_tr_b16 v[80:81], v5 offset:20480
    ds_read_b64_tr_b16 v[82:83], v5 offset:21504
    v_mfma_f32_16x16x32_bf16 v[40:43], a[100:103], v[88:91], v[40:43]
    global_load_dwordx4 v[168:171], v10, s[42:43] offset:2048 sc1
    v_cvt_pk_bf16_f32 v121, v111, v119
    v_mfma_f32_16x16x32_bf16 v[48:51], a[104:107], v[88:91], v[48:51]
    s_waitcnt lgkmcnt(6)
    v_mul_f32 v111, v64, v64
    v_mul_f32 v119, v65, v65
    v_mfma_f32_16x16x32_bf16 v[36:39], a[96:99], v[92:95], v[36:39]
    ds_read_b64_tr_b16 v[84:85], v6 offset:20480
    ds_read_b64_tr_b16 v[86:87], v6 offset:21504
    v_mfma_f32_16x16x32_bf16 v[44:47], a[100:103], v[92:95], v[44:47]
    v_fma_f32 v111, v111, v109, v108
    v_fma_f32 v119, v119, v109, v108
    v_mfma_f32_16x16x32_bf16 v[52:55], a[104:107], v[92:95], v[52:55]
    s_waitcnt lgkmcnt(6)
    v_mul_f32 v111, v64, v111
    v_mul_f32 v119, v65, v119
    v_mfma_f32_16x16x32_bf16 v[32:35], a[108:111], v[96:99], v[32:35]
    ds_read_b64_tr_b16 v[88:89], v5 offset:22528
    ds_read_b64_tr_b16 v[90:91], v5 offset:23552
    v_mfma_f32_16x16x32_bf16 v[40:43], a[112:115], v[96:99], v[40:43]
    global_load_dwordx4 v[172:175], v10, s[42:43] offset:3072 sc1
    v_add_u32 v10, 0x2000, v10
    v_mfma_f32_16x16x32_bf16 v[48:51], a[116:119], v[96:99], v[48:51]
    s_waitcnt lgkmcnt(6)
    v_exp_f32 v111, v111
    v_mfma_f32_16x16x32_bf16 v[36:39], a[108:111], v[100:103], v[36:39]
    ds_read_b64_tr_b16 v[92:93], v6 offset:22528
    ds_read_b64_tr_b16 v[94:95], v6 offset:23552
    v_mfma_f32_16x16x32_bf16 v[44:47], a[112:115], v[100:103], v[44:47]
    v_exp_f32 v119, v119
    v_mfma_f32_16x16x32_bf16 v[52:55], a[116:119], v[100:103], v[52:55]
    s_waitcnt lgkmcnt(6)
    v_mul_f32 v67, v64, v67
    v_mul_f32 v66, v65, v66
    v_mfma_f32_16x16x32_bf16 v[32:35], a[120:123], v[80:83], v[32:35]
    ds_read_b64_tr_b16 v[96:97], v5 offset:24576
    ds_read_b64_tr_b16 v[98:99], v5 offset:25600
    v_mfma_f32_16x16x32_bf16 v[40:43], a[124:127], v[80:83], v[40:43]
    global_load_dwordx4 v[176:179], v10, s[42:43] offset:-4096 sc1
    v_fma_f32 v111, v111, v110, v110
    v_mfma_f32_16x16x32_bf16 v[48:51], a[128:131], v[80:83], v[48:51]
    s_waitcnt lgkmcnt(6)
    v_fma_f32 v119, v119, v110, v110
    v_rcp_f32 v111, v111
    v_mfma_f32_16x16x32_bf16 v[36:39], a[120:123], v[84:87], v[36:39]
    ds_read_b64_tr_b16 v[100:101], v6 offset:24576
    ds_read_b64_tr_b16 v[102:103], v6 offset:25600
    v_mfma_f32_16x16x32_bf16 v[44:47], a[124:127], v[84:87], v[44:47]
    v_rcp_f32 v119, v119
    v_mfma_f32_16x16x32_bf16 v[52:55], a[128:131], v[84:87], v[52:55]
    s_waitcnt lgkmcnt(6)
    v_mul_f32 v111, v67, v111
    v_mul_f32 v119, v66, v119
    v_mfma_f32_16x16x32_bf16 v[32:35], a[132:135], v[88:91], v[32:35]
    ds_read_b64_tr_b16 v[80:81], v5 offset:26624
    ds_read_b64_tr_b16 v[82:83], v5 offset:27648
    v_mfma_f32_16x16x32_bf16 v[40:43], a[136:139], v[88:91], v[40:43]
    global_load_dwordx4 v[180:183], v10, s[42:43] offset:-3072 sc1
    v_cvt_pk_bf16_f32 v122, v111, v119
    v_mfma_f32_16x16x32_bf16 v[48:51], a[140:143], v[88:91], v[48:51]
    v_permlane16_swap_b32 v120, v121
    v_mfma_f32_16x16x32_bf16 v[72:75], v[28:31], v[104:107], v[72:75]
    v_mfma_f32_16x16x32_bf16 v[76:79], v[28:31], v[112:115], v[76:79]
    s_waitcnt lgkmcnt(6)
    v_mul_f32 v111, v68, v68
    v_mul_f32 v119, v69, v69
    v_mfma_f32_16x16x32_bf16 v[36:39], a[132:135], v[92:95], v[36:39]
    ds_read_b64_tr_b16 v[84:85], v6 offset:26624
    ds_read_b64_tr_b16 v[86:87], v6 offset:27648
    v_mfma_f32_16x16x32_bf16 v[44:47], a[136:139], v[92:95], v[44:47]
    v_fma_f32 v111, v111, v117, v116
    v_fma_f32 v119, v119, v117, v116
    v_mfma_f32_16x16x32_bf16 v[52:55], a[140:143], v[92:95], v[52:55]
    s_waitcnt lgkmcnt(6)
    v_mul_f32 v111, v68, v111
    v_mul_f32 v119, v69, v119
    v_mfma_f32_16x16x32_bf16 v[32:35], a[144:147], v[96:99], v[32:35]
    ds_read_b64_tr_b16 v[88:89], v5 offset:28672
    ds_read_b64_tr_b16 v[90:91], v5 offset:29696
    v_mfma_f32_16x16x32_bf16 v[40:43], a[148:151], v[96:99], v[40:43]
    global_load_dwordx4 v[184:187], v10, s[42:43] offset:-2048 sc1
    v_exp_f32 v111, v111
    v_mfma_f32_16x16x32_bf16 v[48:51], a[152:155], v[96:99], v[48:51]
    s_waitcnt lgkmcnt(6)
    v_exp_f32 v119, v119
    v_mfma_f32_16x16x32_bf16 v[36:39], a[144:147], v[100:103], v[36:39]
    ds_read_b64_tr_b16 v[92:93], v6 offset:28672
    ds_read_b64_tr_b16 v[94:95], v6 offset:29696
    v_mfma_f32_16x16x32_bf16 v[44:47], a[148:151], v[100:103], v[44:47]
    v_mul_f32 v71, v68, v71
    v_mul_f32 v70, v69, v70
    v_mfma_f32_16x16x32_bf16 v[52:55], a[152:155], v[100:103], v[52:55]
    s_waitcnt lgkmcnt(6)
    v_fma_f32 v111, v111, v118, v118
    v_fma_f32 v119, v119, v118, v118
    v_mfma_f32_16x16x32_bf16 v[32:35], a[156:159], v[80:83], v[32:35]
    ds_read_b64_tr_b16 v[96:97], v5 offset:30720
    ds_read_b64_tr_b16 v[98:99], v5 offset:31744
    v_mfma_f32_16x16x32_bf16 v[40:43], a[160:163], v[80:83], v[40:43]
    global_load_dwordx4 v[188:191], v10, s[42:43] offset:-1024 sc1
    v_rcp_f32 v111, v111
    v_mfma_f32_16x16x32_bf16 v[48:51], a[164:167], v[80:83], v[48:51]
    s_waitcnt lgkmcnt(6)
    v_rcp_f32 v119, v119
    v_mfma_f32_16x16x32_bf16 v[36:39], a[156:159], v[84:87], v[36:39]
    ds_read_b64_tr_b16 v[100:101], v6 offset:30720
    ds_read_b64_tr_b16 v[102:103], v6 offset:31744
    v_mfma_f32_16x16x32_bf16 v[44:47], a[160:163], v[84:87], v[44:47]
    v_mul_f32 v111, v71, v111
    v_mul_f32 v119, v70, v119
    v_mfma_f32_16x16x32_bf16 v[52:55], a[164:167], v[84:87], v[52:55]
    s_waitcnt vmcnt(11)
    s_barrier
    v_add_u32 v5, 0x8000, v5
    v_add_u32 v6, 0x8000, v6
    s_waitcnt lgkmcnt(6)
    v_mfma_f32_16x16x32_bf16 v[32:35], a[168:171], v[88:91], v[32:35]
    ds_read_b64_tr_b16 v[80:81], v5 offset:0
    ds_read_b64_tr_b16 v[82:83], v5 offset:1024
    v_mfma_f32_16x16x32_bf16 v[40:43], a[172:175], v[88:91], v[40:43]
    global_load_dwordx4 v[192:195], v10, s[42:43] offset:0 sc1
    v_cvt_pk_bf16_f32 v123, v111, v119
    v_mfma_f32_16x16x32_bf16 v[48:51], a[176:179], v[88:91], v[48:51]
    s_waitcnt lgkmcnt(6)
    v_mul_f32 v111, v72, v72
    v_mul_f32 v119, v73, v73
    v_mfma_f32_16x16x32_bf16 v[36:39], a[168:171], v[92:95], v[36:39]
    ds_read_b64_tr_b16 v[84:85], v6 offset:0
    ds_read_b64_tr_b16 v[86:87], v6 offset:1024
    v_mfma_f32_16x16x32_bf16 v[44:47], a[172:175], v[92:95], v[44:47]
    v_fma_f32 v111, v111, v109, v108
    v_fma_f32 v119, v119, v109, v108
    v_mfma_f32_16x16x32_bf16 v[52:55], a[176:179], v[92:95], v[52:55]
    s_waitcnt lgkmcnt(6)
    v_mul_f32 v111, v72, v111
    v_mul_f32 v119, v73, v119
    v_mfma_f32_16x16x32_bf16 v[32:35], a[180:183], v[96:99], v[32:35]
    ds_read_b64_tr_b16 v[88:89], v5 offset:2048
    ds_read_b64_tr_b16 v[90:91], v5 offset:3072
    v_mfma_f32_16x16x32_bf16 v[40:43], a[184:187], v[96:99], v[40:43]
    global_load_dwordx4 v[196:199], v10, s[42:43] offset:1024 sc1
    v_exp_f32 v111, v111
    v_mfma_f32_16x16x32_bf16 v[48:51], a[188:191], v[96:99], v[48:51]
    s_waitcnt lgkmcnt(6)
    v_exp_f32 v119, v119
    v_mfma_f32_16x16x32_bf16 v[36:39], a[180:183], v[100:103], v[36:39]
    ds_read_b64_tr_b16 v[92:93], v6 offset:2048
    ds_read_b64_tr_b16 v[94:95], v6 offset:3072
    v_mfma_f32_16x16x32_bf16 v[44:47], a[184:187], v[100:103], v[44:47]
    v_mul_f32 v75, v72, v75
    v_mul_f32 v74, v73, v74
    v_mfma_f32_16x16x32_bf16 v[52:55], a[188:191], v[100:103], v[52:55]
    v_fma_f32 v111, v111, v110, v110
    v_fma_f32 v119, v119, v110, v110
    v_rcp_f32 v111, v111
    v_rcp_f32 v119, v119
    v_mul_f32 v111, v75, v111
    v_mul_f32 v119, v74, v119
    v_cvt_pk_bf16_f32 v124, v111, v119
    v_permlane16_swap_b32 v122, v123
    global_store_dwordx4 v9, v[120:123], s[42:43] sc1
    v_mul_f32 v111, v76, v76
    v_mul_f32 v119, v77, v77
    v_fma_f32 v111, v111, v117, v116
    v_fma_f32 v119, v119, v117, v116
    v_mul_f32 v111, v76, v111
    v_mul_f32 v119, v77, v119
    v_exp_f32 v111, v111
    v_exp_f32 v119, v119
    v_mul_f32 v79, v76, v79
    v_mul_f32 v78, v77, v78
    v_fma_f32 v111, v111, v118, v118
    v_fma_f32 v119, v119, v118, v118
    v_rcp_f32 v111, v111
    v_rcp_f32 v119, v119
    v_mul_f32 v111, v79, v111
    v_mul_f32 v119, v78, v119
    v_cvt_pk_bf16_f32 v125, v111, v119
    s_nop 1
    v_permlane16_swap_b32 v124, v125
    s_nop 1
    v_permlane32_swap_b32 v124, v126
    v_permlane32_swap_b32 v125, v127
    s_mov_b32 exec_hi, 0
    global_store_dwordx4 v9, v[124:127], s[42:43] offset:512 sc1
    s_mov_b32 exec_hi, -1
    v_add_u32 v9, 180224, v9
    s_waitcnt lgkmcnt(6)
    v_mfma_f32_16x16x32_bf16 v[56:59], a[0:3], v[80:83], 0
    ds_read_b64_tr_b16 v[96:97], v5 offset:4096
    ds_read_b64_tr_b16 v[98:99], v5 offset:5120
    v_mfma_f32_16x16x32_bf16 v[64:67], a[4:7], v[80:83], 0
    v_lshl_add_u32 v4, v1, 4, s15
    s_add_u32 m0, s14, 0
    v_mfma_f32_16x16x32_bf16 v[72:75], a[8:11], v[80:83], 0
    s_waitcnt lgkmcnt(6)
    global_load_lds_dwordx4 v4, s[42:43] sc1
    v_add_u32 v4, 0x80000, v4
    v_mfma_f32_16x16x32_bf16 v[60:63], a[0:3], v[84:87], 0
    ds_read_b64_tr_b16 v[100:101], v6 offset:4096
    ds_read_b64_tr_b16 v[102:103], v6 offset:5120
    v_mfma_f32_16x16x32_bf16 v[68:71], a[4:7], v[84:87], 0
    s_add_u32 m0, s14, 1024
    s_nop 0
    global_load_lds_dwordx4 v4, s[42:43] sc1
    s_barrier
    v_mfma_f32_16x16x32_bf16 v[76:79], a[8:11], v[84:87], 0
    s_waitcnt lgkmcnt(6)
    ds_read_b128 v[104:107], v7 offset:0
    ds_read_b128 v[112:115], v7 offset:512
    v_mfma_f32_16x16x32_bf16 v[56:59], a[12:15], v[88:91], v[56:59]
    ds_read_b64_tr_b16 v[80:81], v5 offset:6144
    ds_read_b64_tr_b16 v[82:83], v5 offset:7168
    v_mfma_f32_16x16x32_bf16 v[64:67], a[16:19], v[88:91], v[64:67]
    ds_read_b128 v[108:111], v7 offset:16
    ds_read_b128 v[116:119], v7 offset:528
    v_mfma_f32_16x16x32_bf16 v[72:75], a[20:23], v[88:91], v[72:75]
    v_add_u32 v4, 0x80000, v4
    s_add_u32 m0, s14, 2048
    s_waitcnt lgkmcnt(10)
    v_mfma_f32_16x16x32_bf16 v[60:63], a[12:15], v[92:95], v[60:63]
    ds_read_b64_tr_b16 v[84:85], v6 offset:6144
    ds_read_b64_tr_b16 v[86:87], v6 offset:7168
    v_mfma_f32_16x16x32_bf16 v[68:71], a[16:19], v[92:95], v[68:71]
    global_load_lds_dwordx4 v4, s[42:43] sc1
    v_add_u32 v4, 0x80000, v4
    v_mfma_f32_16x16x32_bf16 v[76:79], a[20:23], v[92:95], v[76:79]
    s_add_u32 m0, s14, 3072
    s_waitcnt lgkmcnt(7)
    v_mfma_f32_16x16x32_bf16 v[32:35], v[20:23], v[104:107], v[32:35]
    s_waitcnt lgkmcnt(6)
    v_mfma_f32_16x16x32_bf16 v[36:39], v[20:23], v[112:115], v[36:39]
    v_mfma_f32_16x16x32_bf16 v[56:59], a[24:27], v[96:99], v[56:59]
    ds_read_b64_tr_b16 v[88:89], v5 offset:8192
    ds_read_b64_tr_b16 v[90:91], v5 offset:9216
    v_mfma_f32_16x16x32_bf16 v[64:67], a[28:31], v[96:99], v[64:67]
    global_load_lds_dwordx4 v4, s[42:43] sc1
    global_load_dwordx4 v[200:203], v10, s[42:43] offset:2048 sc1
    v_mfma_f32_16x16x32_bf16 v[72:75], a[32:35], v[96:99], v[72:75]
    s_waitcnt lgkmcnt(4)
    v_cmp_u_f32 vcc, v108, v116
    s_or_b64 s[62:63], s[62:63], vcc
    v_mfma_f32_16x16x32_bf16 v[60:63], a[24:27], v[100:103], v[60:63]
    ds_read_b64_tr_b16 v[92:93], v6 offset:8192
    ds_read_b64_tr_b16 v[94:95], v6 offset:9216
    v_mfma_f32_16x16x32_bf16 v[68:71], a[28:31], v[100:103], v[68:71]
    v_mul_f32 v111, v32, v32
    v_mul_f32 v119, v33, v33
    v_mfma_f32_16x16x32_bf16 v[76:79], a[32:35], v[100:103], v[76:79]
    v_fma_f32 v111, v111, v109, v108
    v_fma_f32 v119, v119, v109, v108
    v_mfma_f32_16x16x32_bf16 v[56:59], a[36:39], v[80:83], v[56:59]
    ds_read_b64_tr_b16 v[96:97], v5 offset:10240
    ds_read_b64_tr_b16 v[98:99], v5 offset:11264
    v_mfma_f32_16x16x32_bf16 v[64:67], a[40:43], v[80:83], v[64:67]
    global_load_dwordx4 v[204:207], v10, s[42:43] offset:3072 sc1
    v_add_u32 v10, 0x2000, v10
    v_mfma_f32_16x16x32_bf16 v[72:75], a[44:47], v[80:83], v[72:75]
    s_waitcnt lgkmcnt(6)
    v_mul_f32 v111, v32, v111
    v_mul_f32 v119, v33, v119
    v_mfma_f32_16x16x32_bf16 v[60:63], a[36:39], v[84:87], v[60:63]
    ds_read_b64_tr_b16 v[100:101], v6 offset:10240
    ds_read_b64_tr_b16 v[102:103], v6 offset:11264
    v_mfma_f32_16x16x32_bf16 v[68:71], a[40:43], v[84:87], v[68:71]
    v_exp_f32 v111, v111
    v_mfma_f32_16x16x32_bf16 v[76:79], a[44:47], v[84:87], v[76:79]
    s_waitcnt lgkmcnt(6)
    v_exp_f32 v119, v119
    v_mfma_f32_16x16x32_bf16 v[56:59], a[48:51], v[88:91], v[56:59]
    ds_read_b64_tr_b16 v[80:81], v5 offset:12288
    ds_read_b64_tr_b16 v[82:83], v5 offset:13312
    v_mfma_f32_16x16x32_bf16 v[64:67], a[52:55], v[88:91], v[64:67]
    global_load_dwordx4 v[208:211], v10, s[42:43] offset:-4096 sc1
    global_load_dwordx4 a[0:3], v11, s[16:17] offset:-4096 sc1
    v_mfma_f32_16x16x32_bf16 v[72:75], a[56:59], v[88:91], v[72:75]
    s_waitcnt lgkmcnt(6)
    v_mul_f32 v35, v32, v35
    v_mul_f32 v34, v33, v34
    v_mfma_f32_16x16x32_bf16 v[60:63], a[48:51], v[92:95], v[60:63]
    ds_read_b64_tr_b16 v[84:85], v6 offset:12288
    ds_read_b64_tr_b16 v[86:87], v6 offset:13312
    v_mfma_f32_16x16x32_bf16 v[68:71], a[52:55], v[92:95], v[68:71]
    v_fma_f32 v111, v111, v110, v110
    v_fma_f32 v119, v119, v110, v110
    v_mfma_f32_16x16x32_bf16 v[76:79], a[56:59], v[92:95], v[76:79]
    s_waitcnt lgkmcnt(6)
    global_load_dwordx4 a[4:7], v11, s[16:17] offset:-3072 sc1
    v_rcp_f32 v111, v111
    v_mfma_f32_16x16x32_bf16 v[56:59], a[60:63], v[96:99], v[56:59]
    ds_read_b64_tr_b16 v[88:89], v5 offset:14336
    ds_read_b64_tr_b16 v[90:91], v5 offset:15360
    v_mfma_f32_16x16x32_bf16 v[64:67], a[64:67], v[96:99], v[64:67]
    global_load_dwordx4 v[212:215], v10, s[42:43] offset:-3072 sc1
    v_rcp_f32 v119, v119
    v_mfma_f32_16x16x32_bf16 v[72:75], a[68:71], v[96:99], v[72:75]
    s_waitcnt lgkmcnt(6)
    v_mul_f32 v111, v35, v111
    v_mul_f32 v119, v34, v119
    v_mfma_f32_16x16x32_bf16 v[60:63], a[60:63], v[100:103], v[60:63]
    ds_read_b64_tr_b16 v[92:93], v6 offset:14336
    ds_read_b64_tr_b16 v[94:95], v6 offset:15360
    v_mfma_f32_16x16x32_bf16 v[68:71], a[64:67], v[100:103], v[68:71]
    global_load_dwordx4 a[12:15], v11, s[16:17] offset:-2048 sc1
    v_cvt_pk_bf16_f32 v120, v111, v119
    v_mfma_f32_16x16x32_bf16 v[40:43], v[24:27], v[104:107], v[40:43]
    v_mfma_f32_16x16x32_bf16 v[44:47], v[24:27], v[112:115], v[44:47]
    v_mul_f32 v111, v36, v36
    v_mul_f32 v119, v37, v37
    v_mfma_f32_16x16x32_bf16 v[76:79], a[68:71], v[100:103], v[76:79]
    s_waitcnt lgkmcnt(6)
    v_fma_f32 v111, v111, v117, v116
    v_fma_f32 v119, v119, v117, v116
    v_mfma_f32_16x16x32_bf16 v[56:59], a[72:75], v[80:83], v[56:59]
    ds_read_b64_tr_b16 v[96:97], v5 offset:16384
    ds_read_b64_tr_b16 v[98:99], v5 offset:17408
    v_mfma_f32_16x16x32_bf16 v[64:67], a[76:79], v[80:83], v[64:67]
    global_load_dwordx4 v[216:219], v10, s[42:43] offset:-2048 sc1
    v_mul_f32 v111, v36, v111
    v_mfma_f32_16x16x32_bf16 v[72:75], a[80:83], v[80:83], v[72:75]
    s_waitcnt lgkmcnt(6)
    global_load_dwordx4 a[16:19], v11, s[16:17] offset:-1024 sc1
    v_mul_f32 v119, v37, v119
    v_mfma_f32_16x16x32_bf16 v[60:63], a[72:75], v[84:87], v[60:63]
    ds_read_b64_tr_b16 v[100:101], v6 offset:16384
    ds_read_b64_tr_b16 v[102:103], v6 offset:17408
    v_mfma_f32_16x16x32_bf16 v[68:71], a[76:79], v[84:87], v[68:71]
    v_exp_f32 v111, v111
    v_mfma_f32_16x16x32_bf16 v[76:79], a[80:83], v[84:87], v[76:79]
    s_waitcnt lgkmcnt(6)
    v_exp_f32 v119, v119
    v_mfma_f32_16x16x32_bf16 v[56:59], a[84:87], v[88:91], v[56:59]
    ds_read_b64_tr_b16 v[80:81], v5 offset:18432
    ds_read_b64_tr_b16 v[82:83], v5 offset:19456
    v_mfma_f32_16x16x32_bf16 v[64:67], a[88:91], v[88:91], v[64:67]
    global_load_dwordx4 v[220:223], v10, s[42:43] offset:-1024 sc1
    global_load_dwordx4 a[24:27], v11, s[16:17] offset:0 sc1
    v_mfma_f32_16x16x32_bf16 v[72:75], a[92:95], v[88:91], v[72:75]
    s_waitcnt lgkmcnt(6)
    v_mul_f32 v39, v36, v39
    v_mul_f32 v38, v37, v38
    v_mfma_f32_16x16x32_bf16 v[60:63], a[84:87], v[92:95], v[60:63]
    ds_read_b64_tr_b16 v[84:85], v6 offset:18432
    ds_read_b64_tr_b16 v[86:87], v6 offset:19456
    v_mfma_f32_16x16x32_bf16 v[68:71], a[88:91], v[92:95], v[68:71]
    v_fma_f32 v111, v111, v118, v118
    v_fma_f32 v119, v119, v118, v118
    v_mfma_f32_16x16x32_bf16 v[76:79], a[92:95], v[92:95], v[76:79]
    s_waitcnt lgkmcnt(6)
    global_load_dwordx4 a[28:31], v11, s[16:17] offset:1024 sc1
    v_rcp_f32 v111, v111
    v_mfma_f32_16x16x32_bf16 v[56:59], a[96:99], v[96:99], v[56:59]
    ds_read_b64_tr_b16 v[88:89], v5 offset:20480
    ds_read_b64_tr_b16 v[90:91], v5 offset:21504
    v_mfma_f32_16x16x32_bf16 v[64:67], a[100:103], v[96:99], v[64:67]
    global_load_dwordx4 v[224:227], v10, s[42:43] offset:0 sc1
    v_rcp_f32 v119, v119
    v_mfma_f32_16x16x32_bf16 v[72:75], a[104:107], v[96:99], v[72:75]
    s_waitcnt lgkmcnt(6)
    v_mul_f32 v111, v39, v111
    v_mul_f32 v119, v38, v119
    v_mfma_f32_16x16x32_bf16 v[60:63], a[96:99], v[100:103], v[60:63]
    ds_read_b64_tr_b16 v[92:93], v6 offset:20480
    ds_read_b64_tr_b16 v[94:95], v6 offset:21504
    v_mfma_f32_16x16x32_bf16 v[68:71], a[100:103], v[100:103], v[68:71]
    global_load_dwordx4 a[36:39], v11, s[16:17] offset:2048 sc1
    v_cvt_pk_bf16_f32 v121, v111, v119
    v_mfma_f32_16x16x32_bf16 v[76:79], a[104:107], v[100:103], v[76:79]
    s_waitcnt lgkmcnt(6)
    v_mul_f32 v111, v40, v40
    v_mul_f32 v119, v41, v41
    v_mfma_f32_16x16x32_bf16 v[56:59], a[108:111], v[80:83], v[56:59]
    ds_read_b64_tr_b16 v[96:97], v5 offset:22528
    ds_read_b64_tr_b16 v[98:99], v5 offset:23552
    v_mfma_f32_16x16x32_bf16 v[64:67], a[112:115], v[80:83], v[64:67]
    global_load_dwordx4 v[228:231], v10, s[42:43] offset:1024 sc1
    v_fma_f32 v111, v111, v109, v108
    v_mfma_f32_16x16x32_bf16 v[72:75], a[116:119], v[80:83], v[72:75]
    s_waitcnt lgkmcnt(6)
    global_load_dwordx4 a[40:43], v11, s[16:17] offset:3072 sc1
    v_fma_f32 v119, v119, v109, v108
    v_mfma_f32_16x16x32_bf16 v[60:63], a[108:111], v[84:87], v[60:63]
    ds_read_b64_tr_b16 v[100:101], v6 offset:22528
    ds_read_b64_tr_b16 v[102:103], v6 offset:23552
    v_mfma_f32_16x16x32_bf16 v[68:71], a[112:115], v[84:87], v[68:71]
    v_mul_f32 v111, v40, v111
    v_mul_f32 v119, v41, v119
    v_mfma_f32_16x16x32_bf16 v[76:79], a[116:119], v[84:87], v[76:79]
    s_waitcnt lgkmcnt(6)
    v_exp_f32 v111, v111
    v_mfma_f32_16x16x32_bf16 v[56:59], a[120:123], v[88:91], v[56:59]
    ds_read_b64_tr_b16 v[80:81], v5 offset:24576
    ds_read_b64_tr_b16 v[82:83], v5 offset:25600
    v_mfma_f32_16x16x32_bf16 v[64:67], a[124:127], v[88:91], v[64:67]
    global_load_dwordx4 v[232:235], v10, s[42:43] offset:2048 sc1
    v_exp_f32 v119, v119
    v_mfma_f32_16x16x32_bf16 v[72:75], a[128:131], v[88:91], v[72:75]
    s_waitcnt lgkmcnt(6)
    v_mul_f32 v43, v40, v43
    v_mul_f32 v42, v41, v42
    v_mfma_f32_16x16x32_bf16 v[60:63], a[120:123], v[92:95], v[60:63]
    ds_read_b64_tr_b16 v[84:85], v6 offset:24576
    ds_read_b64_tr_b16 v[86:87], v6 offset:25600
    v_mfma_f32_16x16x32_bf16 v[68:71], a[124:127], v[92:95], v[68:71]
    global_load_dwordx4 a[48:51], v11, s[18:19] offset:-4096 sc1
    v_fma_f32 v111, v111, v110, v110
    v_mfma_f32_16x16x32_bf16 v[76:79], a[128:131], v[92:95], v[76:79]
    s_waitcnt lgkmcnt(6)
    v_fma_f32 v119, v119, v110, v110
    v_rcp_f32 v111, v111
    v_mfma_f32_16x16x32_bf16 v[56:59], a[132:135], v[96:99], v[56:59]
    ds_read_b64_tr_b16 v[88:89], v5 offset:26624
    ds_read_b64_tr_b16 v[90:91], v5 offset:27648
    v_mfma_f32_16x16x32_bf16 v[64:67], a[136:139], v[96:99], v[64:67]
    global_load_dwordx4 v[236:239], v10, s[42:43] offset:3072 sc1
    v_add_u32 v10, 0x2000, v10
    v_mfma_f32_16x16x32_bf16 v[72:75], a[140:143], v[96:99], v[72:75]
    s_waitcnt lgkmcnt(6)
    global_load_dwordx4 a[52:55], v11, s[18:19] offset:-3072 sc1
    v_rcp_f32 v119, v119
    v_mfma_f32_16x16x32_bf16 v[60:63], a[132:135], v[100:103], v[60:63]
    ds_read_b64_tr_b16 v[92:93], v6 offset:26624
    ds_read_b64_tr_b16 v[94:95], v6 offset:27648
    v_mfma_f32_16x16x32_bf16 v[68:71], a[136:139], v[100:103], v[68:71]
    v_mul_f32 v111, v43, v111
    v_mul_f32 v119, v42, v119
    v_mfma_f32_16x16x32_bf16 v[76:79], a[140:143], v[100:103], v[76:79]
    v_cvt_pk_bf16_f32 v122, v111, v119
    v_permlane16_swap_b32 v120, v121
    v_mfma_f32_16x16x32_bf16 v[48:51], v[28:31], v[104:107], v[48:51]
    v_mfma_f32_16x16x32_bf16 v[52:55], v[28:31], v[112:115], v[52:55]
    s_waitcnt lgkmcnt(6)
    v_mul_f32 v111, v44, v44
    v_mul_f32 v119, v45, v45
    v_mfma_f32_16x16x32_bf16 v[56:59], a[144:147], v[80:83], v[56:59]
    ds_read_b64_tr_b16 v[96:97], v5 offset:28672
    ds_read_b64_tr_b16 v[98:99], v5 offset:29696
    v_mfma_f32_16x16x32_bf16 v[64:67], a[148:151], v[80:83], v[64:67]
    global_load_dwordx4 a[60:63], v11, s[18:19] offset:-2048 sc1
    v_fma_f32 v111, v111, v117, v116
    v_mfma_f32_16x16x32_bf16 v[72:75], a[152:155], v[80:83], v[72:75]
    s_waitcnt lgkmcnt(6)
    v_fma_f32 v119, v119, v117, v116
    v_mul_f32 v111, v44, v111
    v_mfma_f32_16x16x32_bf16 v[60:63], a[144:147], v[84:87], v[60:63]
    ds_read_b64_tr_b16 v[100:101], v6 offset:28672
    ds_read_b64_tr_b16 v[102:103], v6 offset:29696
    v_mfma_f32_16x16x32_bf16 v[68:71], a[148:151], v[84:87], v[68:71]
    v_mul_f32 v119, v45, v119
    v_exp_f32 v111, v111
    v_mfma_f32_16x16x32_bf16 v[76:79], a[152:155], v[84:87], v[76:79]
    s_waitcnt lgkmcnt(6)
    global_load_dwordx4 a[64:67], v11, s[18:19] offset:-1024 sc1
    v_exp_f32 v119, v119
    v_mfma_f32_16x16x32_bf16 v[56:59], a[156:159], v[88:91], v[56:59]
    ds_read_b64_tr_b16 v[80:81], v5 offset:30720
    ds_read_b64_tr_b16 v[82:83], v5 offset:31744
    v_mfma_f32_16x16x32_bf16 v[64:67], a[160:163], v[88:91], v[64:67]
    v_mul_f32 v47, v44, v47
    v_mul_f32 v46, v45, v46
    v_mfma_f32_16x16x32_bf16 v[72:75], a[164:167], v[88:91], v[72:75]
    s_waitcnt lgkmcnt(6)
    v_fma_f32 v111, v111, v118, v118
    v_fma_f32 v119, v119, v118, v118
    v_mfma_f32_16x16x32_bf16 v[60:63], a[156:159], v[92:95], v[60:63]
    ds_read_b64_tr_b16 v[84:85], v6 offset:30720
    ds_read_b64_tr_b16 v[86:87], v6 offset:31744
    v_mfma_f32_16x16x32_bf16 v[68:71], a[160:163], v[92:95], v[68:71]
    global_load_dwordx4 a[72:75], v11, s[18:19] offset:0 sc1
    v_rcp_f32 v111, v111
    v_mfma_f32_16x16x32_bf16 v[76:79], a[164:167], v[92:95], v[76:79]
    s_waitcnt lgkmcnt(6)
    v_rcp_f32 v119, v119
    v_mfma_f32_16x16x32_bf16 v[56:59], a[168:171], v[96:99], v[56:59]
    v_mul_f32 v111, v47, v111
    v_mul_f32 v119, v46, v119
    v_mfma_f32_16x16x32_bf16 v[64:67], a[172:175], v[96:99], v[64:67]
    v_cvt_pk_bf16_f32 v123, v111, v119
    v_mul_f32 v111, v48, v48
    v_mfma_f32_16x16x32_bf16 v[72:75], a[176:179], v[96:99], v[72:75]
    s_waitcnt lgkmcnt(4)
    global_load_dwordx4 a[76:79], v11, s[18:19] offset:1024 sc1
    v_mul_f32 v119, v49, v49
    v_mfma_f32_16x16x32_bf16 v[60:63], a[168:171], v[100:103], v[60:63]
    v_fma_f32 v111, v111, v109, v108
    v_fma_f32 v119, v119, v109, v108
    v_mfma_f32_16x16x32_bf16 v[68:71], a[172:175], v[100:103], v[68:71]
    v_mul_f32 v111, v48, v111
    v_mul_f32 v119, v49, v119
    v_mfma_f32_16x16x32_bf16 v[76:79], a[176:179], v[100:103], v[76:79]
    s_waitcnt lgkmcnt(2)
    v_exp_f32 v111, v111
    v_mfma_f32_16x16x32_bf16 v[56:59], a[180:183], v[80:83], v[56:59]
    global_load_dwordx4 a[84:87], v11, s[18:19] offset:2048 sc1
    v_exp_f32 v119, v119
    v_mfma_f32_16x16x32_bf16 v[64:67], a[184:187], v[80:83], v[64:67]
    v_mul_f32 v51, v48, v51
    v_mul_f32 v50, v49, v50
    v_mfma_f32_16x16x32_bf16 v[72:75], a[188:191], v[80:83], v[72:75]
    v_fma_f32 v111, v111, v110, v110
    v_fma_f32 v119, v119, v110, v110
    s_waitcnt lgkmcnt(0)
    v_mfma_f32_16x16x32_bf16 v[60:63], a[180:183], v[84:87], v[60:63]
    v_rcp_f32 v111, v111
    v_mfma_f32_16x16x32_bf16 v[68:71], a[184:187], v[84:87], v[68:71]
    global_load_dwordx4 a[88:91], v11, s[18:19] offset:3072 sc1
    v_rcp_f32 v119, v119
    v_mfma_f32_16x16x32_bf16 v[76:79], a[188:191], v[84:87], v[76:79]
    v_mul_f32 v111, v51, v111
    v_mul_f32 v119, v50, v119
    v_cvt_pk_bf16_f32 v124, v111, v119
    v_permlane16_swap_b32 v122, v123
    global_store_dwordx4 v9, v[120:123], s[42:43] sc1
    v_mul_f32 v111, v52, v52
    v_mul_f32 v119, v53, v53
    v_fma_f32 v111, v111, v117, v116
    v_fma_f32 v119, v119, v117, v116
    v_mul_f32 v111, v52, v111
    v_mul_f32 v119, v53, v119
    v_exp_f32 v111, v111
    v_exp_f32 v119, v119
    v_mul_f32 v55, v52, v55
    v_mul_f32 v54, v53, v54
    v_fma_f32 v111, v111, v118, v118
    v_fma_f32 v119, v119, v118, v118
    v_rcp_f32 v111, v111
    v_rcp_f32 v119, v119
    v_mul_f32 v111, v55, v111
    v_mul_f32 v119, v54, v119
    v_cvt_pk_bf16_f32 v125, v111, v119
    s_nop 1
    v_permlane16_swap_b32 v124, v125
    s_nop 1
    v_permlane32_swap_b32 v124, v126
    v_permlane32_swap_b32 v125, v127
    s_mov_b32 exec_hi, 0
    global_store_dwordx4 v9, v[124:127], s[42:43] offset:512 sc1
    s_mov_b32 exec_hi, -1
    v_add_u32 v9, 180224, v9
    s_waitcnt vmcnt(28)
    ds_read_b64_tr_b16 v[88:89], v13 offset:0
    ds_read_b64_tr_b16 v[90:91], v13 offset:1024
    ds_read_b64_tr_b16 v[92:93], v13 offset:2048
    ds_read_b64_tr_b16 v[94:95], v13 offset:3072
    s_barrier
    ds_read_b128 v[104:107], v7 offset:1024
    ds_read_b128 v[112:115], v7 offset:1536
    ds_read_b128 v[108:111], v7 offset:1040
    ds_read_b128 v[116:119], v7 offset:1552
    s_waitcnt lgkmcnt(3)
    v_mfma_f32_16x16x32_bf16 v[56:59], v[20:23], v[104:107], v[56:59]
    s_waitcnt lgkmcnt(2)
    v_mfma_f32_16x16x32_bf16 v[60:63], v[20:23], v[112:115], v[60:63]
    v_mfma_f32_16x16x32_bf16 v[64:67], v[24:27], v[104:107], v[64:67]
    v_mfma_f32_16x16x32_bf16 v[68:71], v[24:27], v[112:115], v[68:71]
    v_mfma_f32_16x16x32_bf16 v[72:75], v[28:31], v[104:107], v[72:75]
    v_mfma_f32_16x16x32_bf16 v[76:79], v[28:31], v[112:115], v[76:79]
    s_waitcnt lgkmcnt(0)
    v_cmp_u_f32 vcc, v108, v116
    s_or_b64 s[62:63], s[62:63], vcc
    v_pk_mul_f32 v[104:105], v[56:57], v[56:57]
    v_pk_fma_f32 v[104:105], v[104:105], v[108:109], v[108:109] op_sel:[0,1,0] op_sel_hi:[1,1,0]
    v_pk_mul_f32 v[104:105], v[56:57], v[104:105]
    v_exp_f32 v104, v104
    v_exp_f32 v105, v105
    s_nop 0
    v_pk_fma_f32 v[104:105], v[104:105], v[110:111], v[110:111] op_sel_hi:[1,0,0]
    v_rcp_f32 v104, v104
    v_rcp_f32 v105, v105
    v_pk_mul_f32 v[58:59], v[56:57], v[58:59] op_sel:[0,1] op_sel_hi:[1,0]
    v_pk_mul_f32 v[58:59], v[104:105], v[58:59]
    v_pk_mul_f32 v[112:113], v[60:61], v[60:61]
    v_pk_fma_f32 v[112:113], v[112:113], v[116:117], v[116:117] op_sel:[0,1,0] op_sel_hi:[1,1,0]
    v_pk_mul_f32 v[112:113], v[60:61], v[112:113]
    v_exp_f32 v112, v112
    v_exp_f32 v113, v113
    v_cvt_pk_bf16_f32 v120, v58, v59
    v_pk_fma_f32 v[112:113], v[112:113], v[118:119], v[118:119] op_sel_hi:[1,0,0]
    v_rcp_f32 v112, v112
    v_rcp_f32 v113, v113
    v_pk_mul_f32 v[62:63], v[60:61], v[62:63] op_sel:[0,1] op_sel_hi:[1,0]
    v_pk_mul_f32 v[62:63], v[112:113], v[62:63]
    v_pk_mul_f32 v[104:105], v[64:65], v[64:65]
    v_pk_fma_f32 v[104:105], v[104:105], v[108:109], v[108:109] op_sel:[0,1,0] op_sel_hi:[1,1,0]
    v_pk_mul_f32 v[104:105], v[64:65], v[104:105]
    v_exp_f32 v104, v104
    v_exp_f32 v105, v105
    v_cvt_pk_bf16_f32 v121, v62, v63
    v_pk_fma_f32 v[104:105], v[104:105], v[110:111], v[110:111] op_sel_hi:[1,0,0]
    v_rcp_f32 v104, v104
    v_rcp_f32 v105, v105
    v_pk_mul_f32 v[66:67], v[64:65], v[66:67] op_sel:[0,1] op_sel_hi:[1,0]
    v_pk_mul_f32 v[66:67], v[104:105], v[66:67]
    v_permlane16_swap_b32 v120, v121
    v_pk_mul_f32 v[112:113], v[68:69], v[68:69]
    v_pk_fma_f32 v[112:113], v[112:113], v[116:117], v[116:117] op_sel:[0,1,0] op_sel_hi:[1,1,0]
    v_pk_mul_f32 v[112:113], v[68:69], v[112:113]
    v_exp_f32 v112, v112
    v_exp_f32 v113, v113
    v_cvt_pk_bf16_f32 v122, v66, v67
    v_pk_fma_f32 v[112:113], v[112:113], v[118:119], v[118:119] op_sel_hi:[1,0,0]
    v_rcp_f32 v112, v112
    v_rcp_f32 v113, v113
    v_pk_mul_f32 v[70:71], v[68:69], v[70:71] op_sel:[0,1] op_sel_hi:[1,0]
    v_pk_mul_f32 v[70:71], v[112:113], v[70:71]
    v_pk_mul_f32 v[104:105], v[72:73], v[72:73]
    v_pk_fma_f32 v[104:105], v[104:105], v[108:109], v[108:109] op_sel:[0,1,0] op_sel_hi:[1,1,0]
    v_pk_mul_f32 v[104:105], v[72:73], v[104:105]
    v_exp_f32 v104, v104
    v_exp_f32 v105, v105
    v_cvt_pk_bf16_f32 v123, v70, v71
    v_pk_fma_f32 v[104:105], v[104:105], v[110:111], v[110:111] op_sel_hi:[1,0,0]
    v_rcp_f32 v104, v104
    v_rcp_f32 v105, v105
    v_pk_mul_f32 v[74:75], v[72:73], v[74:75] op_sel:[0,1] op_sel_hi:[1,0]
    v_pk_mul_f32 v[74:75], v[104:105], v[74:75]
    v_permlane16_swap_b32 v122, v123
    global_store_dwordx4 v9, v[120:123], s[42:43] sc1
    v_pk_mul_f32 v[112:113], v[76:77], v[76:77]
    v_pk_fma_f32 v[112:113], v[112:113], v[116:117], v[116:117] op_sel:[0,1,0] op_sel_hi:[1,1,0]
    v_pk_mul_f32 v[112:113], v[76:77], v[112:113]
    v_exp_f32 v112, v112
    v_exp_f32 v113, v113
    v_cvt_pk_bf16_f32 v124, v74, v75
    v_pk_fma_f32 v[112:113], v[112:113], v[118:119], v[118:119] op_sel_hi:[1,0,0]
    v_rcp_f32 v112, v112
    v_rcp_f32 v113, v113
    v_pk_mul_f32 v[78:79], v[76:77], v[78:79] op_sel:[0,1] op_sel_hi:[1,0]
    v_pk_mul_f32 v[78:79], v[112:113], v[78:79]
    v_cvt_pk_bf16_f32 v125, v78, v79
    s_nop 1
    v_permlane16_swap_b32 v124, v125
    s_nop 1
    v_permlane32_swap_b32 v124, v126
    v_permlane32_swap_b32 v125, v127
    s_mov_b32 exec_hi, 0
    global_store_dwordx4 v9, v[124:127], s[42:43] offset:512 sc1
    s_mov_b32 exec_hi, -1
    v_add_u32 v9, 180224, v9
    s_cmp_lg_u64 s[62:63], 0
    s_cbranch_scc1 L_redo
L_noredoa:
    s_mov_b32 s59, 0
L_rsa:
    v_pk_max_u16 v96, v88, v89
    v_pk_max_u16 v97, v90, v91
    v_pk_max_u16 v98, v92, v93
    v_pk_max_u16 v99, v94, v95
    v_pk_max_u16 v96, v96, v97
    v_pk_max_u16 v98, v98, v99
    v_pk_max_u16 v96, v96, v98
    v_pk_max_u16 v96, v96, v96 op_sel:[0,1] op_sel_hi:[1,0]
    v_cmp_eq_u32 vcc, -1, v96
    s_cbranch_vccnz L_rsra
L_rsoka:
    v_lshlrev_b32 v72, 16, v88
    v_and_b32 v73, s60, v88
    v_lshlrev_b32 v74, 16, v89
    v_and_b32 v75, s60, v89
    v_lshlrev_b32 v76, 16, v90
    v_and_b32 v77, s60, v90
    v_lshlrev_b32 v78, 16, v91
    v_and_b32 v79, s60, v91
    s_waitcnt vmcnt(26)
    v_mfma_f32_16x16x32_bf16 v[32:35], a[192:195], a[0:3], v[72:75]
    global_load_dwordx4 a[96:99], v12, s[16:17] offset:-4096 sc1
    v_lshlrev_b32 v80, 16, v92
    v_and_b32 v81, s60, v92
    v_mfma_f32_16x16x32_bf16 v[36:39], a[196:199], a[0:3], 0
    v_lshlrev_b32 v82, 16, v93
    v_and_b32 v83, s60, v93
    v_lshlrev_b32 v84, 16, v94
    v_mfma_f32_16x16x32_bf16 v[40:43], a[200:203], a[0:3], 0
    global_load_dwordx4 a[112:115], v12, s[18:19] offset:-4096 sc1
    v_and_b32 v85, s60, v94
    v_lshlrev_b32 v86, 16, v95
    v_mfma_f32_16x16x32_bf16 v[44:47], a[204:207], a[0:3], 0
    s_waitcnt vmcnt(14)
    v_and_b32 v87, s60, v95
    v_mfma_f32_16x16x32_bf16 v[48:51], a[192:195], a[48:51], v[76:79]
    global_load_dwordx4 v[240:243], v10, s[42:43] offset:-4096 sc1
    v_mfma_f32_16x16x32_bf16 v[52:55], a[196:199], a[48:51], 0
    v_mfma_f32_16x16x32_bf16 v[56:59], a[200:203], a[48:51], 0
    global_load_dwordx4 v[244:247], v10, s[42:43] offset:-3072 sc1
    v_mfma_f32_16x16x32_bf16 v[60:63], a[204:207], a[48:51], 0
    v_mfma_f32_16x16x32_bf16 v[32:35], a[208:211], a[4:7], v[32:35]
    global_load_dwordx4 v[248:251], v10, s[42:43] offset:-2048 sc1
    v_mfma_f32_16x16x32_bf16 v[36:39], a[212:215], a[4:7], v[36:39]
    v_mfma_f32_16x16x32_bf16 v[40:43], a[216:219], a[4:7], v[40:43]
    global_load_dwordx4 v[252:255], v10, s[42:43] offset:-1024 sc1
    v_mfma_f32_16x16x32_bf16 v[44:47], a[220:223], a[4:7], v[44:47]
    s_waitcnt vmcnt(16)
    v_mfma_f32_16x16x32_bf16 v[48:51], a[208:211], a[52:55], v[48:51]
    global_load_dwordx4 a[100:103], v12, s[16:17] offset:-3072 sc1
    v_mfma_f32_16x16x32_bf16 v[52:55], a[212:215], a[52:55], v[52:55]
    v_mfma_f32_16x16x32_bf16 v[56:59], a[216:219], a[52:55], v[56:59]
    global_load_dwordx4 a[120:123], v12, s[18:19] offset:-3072 sc1
    v_mfma_f32_16x16x32_bf16 v[60:63], a[220:223], a[52:55], v[60:63]
    v_mfma_f32_16x16x32_bf16 v[32:35], a[224:227], a[12:15], v[32:35]
    global_load_dwordx4 a[108:111], v12, s[16:17] offset:-2048 sc1
    v_mfma_f32_16x16x32_bf16 v[36:39], a[228:231], a[12:15], v[36:39]
    v_mfma_f32_16x16x32_bf16 v[40:43], a[232:235], a[12:15], v[40:43]
    global_load_dwordx4 a[124:127], v12, s[18:19] offset:-2048 sc1
    v_mfma_f32_16x16x32_bf16 v[44:47], a[236:239], a[12:15], v[44:47]
    s_waitcnt vmcnt(19)
    v_mfma_f32_16x16x32_bf16 v[48:51], a[224:227], a[60:63], v[48:51]
    global_load_dwordx4 a[132:135], v11, s[20:21] offset:-4096 sc1
    v_mfma_f32_16x16x32_bf16 v[52:55], a[228:231], a[60:63], v[52:55]
    v_mfma_f32_16x16x32_bf16 v[56:59], a[232:235], a[60:63], v[56:59]
    global_load_dwordx4 a[136:139], v11, s[20:21] offset:-3072 sc1
    v_mfma_f32_16x16x32_bf16 v[60:63], a[236:239], a[60:63], v[60:63]
    v_mfma_f32_16x16x32_bf16 v[32:35], v[128:131], a[16:19], v[32:35]
    global_load_dwordx4 a[144:147], v11, s[20:21] offset:-2048 sc1
    v_mfma_f32_16x16x32_bf16 v[36:39], v[132:135], a[16:19], v[36:39]
    v_mfma_f32_16x16x32_bf16 v[40:43], v[136:139], a[16:19], v[40:43]
    global_load_dwordx4 a[148:151], v11, s[20:21] offset:-1024 sc1
    v_mfma_f32_16x16x32_bf16 v[44:47], v[140:143], a[16:19], v[44:47]
    s_waitcnt vmcnt(22)
    v_mfma_f32_16x16x32_bf16 v[48:51], v[128:131], a[64:67], v[48:51]
    global_load_dwordx4 a[156:159], v11, s[20:21] offset:0 sc1
    v_mfma_f32_16x16x32_bf16 v[52:55], v[132:135], a[64:67], v[52:55]
    v_mfma_f32_16x16x32_bf16 v[56:59], v[136:139], a[64:67], v[56:59]
    global_load_dwordx4 a[160:163], v11, s[20:21] offset:1024 sc1
    v_mfma_f32_16x16x32_bf16 v[60:63], v[140:143], a[64:67], v[60:63]
    v_mfma_f32_16x16x32_bf16 v[32:35], v[144:147], a[24:27], v[32:35]
    global_load_dwordx4 a[168:171], v11, s[20:21] offset:2048 sc1
    v_mfma_f32_16x16x32_bf16 v[36:39], v[148:151], a[24:27], v[36:39]
    v_mfma_f32_16x16x32_bf16 v[40:43], v[152:155], a[24:27], v[40:43]
    global_load_dwordx4 a[172:175], v11, s[20:21] offset:3072 sc1
    v_mfma_f32_16x16x32_bf16 v[44:47], v[156:159], a[24:27], v[44:47]
    s_waitcnt vmcnt(25)
    v_mfma_f32_16x16x32_bf16 v[48:51], v[144:147], a[72:75], v[48:51]
    global_load_dwordx4 a[180:183], v12, s[20:21] offset:-4096 sc1
    v_mfma_f32_16x16x32_bf16 v[52:55], v[148:151], a[72:75], v[52:55]
    v_mfma_f32_16x16x32_bf16 v[56:59], v[152:155], a[72:75], v[56:59]
    global_load_dwordx4 a[184:187], v12, s[20:21] offset:-3072 sc1
    v_mfma_f32_16x16x32_bf16 v[60:63], v[156:159], a[72:75], v[60:63]
    v_mfma_f32_16x16x32_bf16 v[32:35], v[160:163], a[28:31], v[32:35]
    global_load_dwordx4 a[8:11], v12, s[20:21] offset:-2048 sc1
    v_mfma_f32_16x16x32_bf16 v[36:39], v[164:167], a[28:31], v[36:39]
    v_mfma_f32_16x16x32_bf16 v[40:43], v[168:171], a[28:31], v[40:43]
    v_mfma_f32_16x16x32_bf16 v[44:47], v[172:175], a[28:31], v[44:47]
    s_waitcnt vmcnt(27)
    v_mfma_f32_16x16x32_bf16 v[48:51], v[160:163], a[76:79], v[48:51]
    v_mfma_f32_16x16x32_bf16 v[52:55], v[164:167], a[76:79], v[52:55]
    v_mfma_f32_16x16x32_bf16 v[56:59], v[168:171], a[76:79], v[56:59]
    v_mfma_f32_16x16x32_bf16 v[60:63], v[172:175], a[76:79], v[60:63]
    v_mfma_f32_16x16x32_bf16 v[32:35], v[176:179], a[36:39], v[32:35]
    v_mfma_f32_16x16x32_bf16 v[36:39], v[180:183], a[36:39], v[36:39]
    v_mfma_f32_16x16x32_bf16 v[40:43], v[184:187], a[36:39], v[40:43]
    v_mfma_f32_16x16x32_bf16 v[44:47], v[188:191], a[36:39], v[44:47]
    s_waitcnt vmcnt(26)
    v_mfma_f32_16x16x32_bf16 v[48:51], v[176:179], a[84:87], v[48:51]
    v_mfma_f32_16x16x32_bf16 v[52:55], v[180:183], a[84:87], v[52:55]
    v_mfma_f32_16x16x32_bf16 v[56:59], v[184:187], a[84:87], v[56:59]
    v_mfma_f32_16x16x32_bf16 v[60:63], v[188:191], a[84:87], v[60:63]
    v_mfma_f32_16x16x32_bf16 v[32:35], v[192:195], a[40:43], v[32:35]
    v_mfma_f32_16x16x32_bf16 v[36:39], v[196:199], a[40:43], v[36:39]
    v_mfma_f32_16x16x32_bf16 v[40:43], v[200:203], a[40:43], v[40:43]
    v_mfma_f32_16x16x32_bf16 v[44:47], v[204:207], a[40:43], v[44:47]
    s_waitcnt vmcnt(25)
    v_mfma_f32_16x16x32_bf16 v[48:51], v[192:195], a[88:91], v[48:51]
    s_waitcnt vmcnt(21)
    global_load_dwordx4 a[20:23], v11, s[22:23] offset:-4096 sc1
    v_mfma_f32_16x16x32_bf16 v[52:55], v[196:199], a[88:91], v[52:55]
    v_mfma_f32_16x16x32_bf16 v[56:59], v[200:203], a[88:91], v[56:59]
    global_load_dwordx4 a[32:35], v11, s[22:23] offset:-3072 sc1
    v_mfma_f32_16x16x32_bf16 v[60:63], v[204:207], a[88:91], v[60:63]
    s_waitcnt vmcnt(22)
    v_mfma_f32_16x16x32_bf16 v[32:35], v[208:211], a[96:99], v[32:35]
    global_load_dwordx4 a[44:47], v11, s[22:23] offset:-2048 sc1
    v_mfma_f32_16x16x32_bf16 v[36:39], v[212:215], a[96:99], v[36:39]
    v_mfma_f32_16x16x32_bf16 v[40:43], v[216:219], a[96:99], v[40:43]
    global_load_dwordx4 a[56:59], v11, s[22:23] offset:-1024 sc1
    v_mfma_f32_16x16x32_bf16 v[44:47], v[220:223], a[96:99], v[44:47]
    s_waitcnt vmcnt(23)
    v_mfma_f32_16x16x32_bf16 v[48:51], v[208:211], a[112:115], v[48:51]
    global_load_dwordx4 a[68:71], v11, s[22:23] offset:0 sc1
    v_mfma_f32_16x16x32_bf16 v[52:55], v[212:215], a[112:115], v[52:55]
    v_mfma_f32_16x16x32_bf16 v[56:59], v[216:219], a[112:115], v[56:59]
    global_load_dwordx4 a[80:83], v11, s[22:23] offset:1024 sc1
    v_mfma_f32_16x16x32_bf16 v[60:63], v[220:223], a[112:115], v[60:63]
    s_waitcnt vmcnt(20)
    v_mfma_f32_16x16x32_bf16 v[32:35], v[224:227], a[100:103], v[32:35]
    global_load_dwordx4 a[92:95], v11, s[22:23] offset:2048 sc1
    v_mfma_f32_16x16x32_bf16 v[36:39], v[228:231], a[100:103], v[36:39]
    v_mfma_f32_16x16x32_bf16 v[40:43], v[232:235], a[100:103], v[40:43]
    global_load_dwordx4 a[104:107], v11, s[22:23] offset:3072 sc1
    v_mfma_f32_16x16x32_bf16 v[44:47], v[236:239], a[100:103], v[44:47]
    s_waitcnt vmcnt(21)
    v_mfma_f32_16x16x32_bf16 v[48:51], v[224:227], a[120:123], v[48:51]
    global_load_dwordx4 a[116:119], v12, s[22:23] offset:-4096 sc1
    v_mfma_f32_16x16x32_bf16 v[52:55], v[228:231], a[120:123], v[52:55]
    s_waitcnt vmcnt(19)
    v_accvgpr_read_b32 v20, a132
    s_waitcnt vmcnt(18)
    v_accvgpr_read_b32 v21, a136
    v_mfma_f32_16x16x32_bf16 v[56:59], v[232:235], a[120:123], v[56:59]
    global_load_dwordx4 a[128:131], v12, s[22:23] offset:-3072 sc1
    s_waitcnt vmcnt(18)
    v_accvgpr_read_b32 v22, a144
    v_mfma_f32_16x16x32_bf16 v[60:63], v[236:239], a[120:123], v[60:63]
    s_waitcnt vmcnt(17)
    v_accvgpr_read_b32 v23, a148
    s_waitcnt vmcnt(16)
    v_accvgpr_read_b32 v24, a156
    v_mfma_f32_16x16x32_bf16 v[32:35], v[240:243], a[108:111], v[32:35]
    global_load_dwordx4 a[140:143], v12, s[22:23] offset:-2048 sc1
    s_waitcnt vmcnt(16)
    v_accvgpr_read_b32 v25, a160
    v_mfma_f32_16x16x32_bf16 v[36:39], v[244:247], a[108:111], v[36:39]
    s_waitcnt vmcnt(15)
    v_accvgpr_read_b32 v26, a168
    s_waitcnt vmcnt(14)
    v_accvgpr_read_b32 v27, a172
    v_mfma_f32_16x16x32_bf16 v[40:43], v[248:251], a[108:111], v[40:43]
    s_waitcnt vmcnt(13)
    v_accvgpr_read_b32 v28, a180
    s_waitcnt vmcnt(12)
    v_accvgpr_read_b32 v29, a184
    v_mfma_f32_16x16x32_bf16 v[44:47], v[252:255], a[108:111], v[44:47]
    s_waitcnt vmcnt(11)
    v_accvgpr_read_b32 v30, a8
    v_max3_u32 v20, v20, v21, v22
    v_mfma_f32_16x16x32_bf16 v[48:51], v[240:243], a[124:127], v[48:51]
    v_max3_u32 v23, v23, v24, v25
    v_max3_u32 v26, v26, v27, v28
    v_mfma_f32_16x16x32_bf16 v[52:55], v[244:247], a[124:127], v[52:55]
    v_max3_u32 v20, v20, v29, v30
    v_max3_u32 v20, v20, v23, v26
    v_mfma_f32_16x16x32_bf16 v[56:59], v[248:251], a[124:127], v[56:59]
    v_cmp_eq_u32 vcc, -1, v20
    s_cbranch_vccnz L_pc2a
L_pcok2a:
    v_mfma_f32_16x16x32_bf16 v[60:63], v[252:255], a[124:127], v[60:63]
    v_mfma_f32_16x16x32_bf16 v[104:107], a[192:195], a[132:135], v[80:83]
    v_mfma_f32_16x16x32_bf16 v[108:111], a[196:199], a[132:135], 0
    v_mfma_f32_16x16x32_bf16 v[112:115], a[200:203], a[132:135], 0
    v_mfma_f32_16x16x32_bf16 v[116:119], a[204:207], a[132:135], 0
    v_mfma_f32_16x16x32_bf16 v[104:107], a[208:211], a[136:139], v[104:107]
    v_cmp_u_f32 vcc, v44, v44
    s_cbranch_vccnz L_rt0a
L_rtok0a:
    v_mfma_f32_16x16x32_bf16 v[108:111], a[212:215], a[136:139], v[108:111]
    v_cmp_u_f32 vcc, v60, v60
    s_cbranch_vccnz L_rt1a
L_rtok1a:
    v_mfma_f32_16x16x32_bf16 v[112:115], a[216:219], a[136:139], v[112:115]
    ds_write_b128 v16, v[32:35] offset:0
    v_mfma_f32_16x16x32_bf16 v[116:119], a[220:223], a[136:139], v[116:119]
    ds_write_b128 v17, v[36:39] offset:0
    v_mfma_f32_16x16x32_bf16 v[104:107], a[224:227], a[144:147], v[104:107]
    ds_write_b128 v18, v[40:43] offset:0
    v_mfma_f32_16x16x32_bf16 v[108:111], a[228:231], a[144:147], v[108:111]
    ds_write_b128 v19, v[44:47] offset:0
    v_mfma_f32_16x16x32_bf16 v[112:115], a[232:235], a[144:147], v[112:115]
    ds_write_b128 v16, v[48:51] offset:16384
    v_mfma_f32_16x16x32_bf16 v[116:119], a[236:239], a[144:147], v[116:119]
    ds_write_b128 v17, v[52:55] offset:16384
    v_mfma_f32_16x16x32_bf16 v[104:107], v[128:131], a[148:151], v[104:107]
    ds_write_b128 v18, v[56:59] offset:16384
    v_mfma_f32_16x16x32_bf16 v[108:111], v[132:135], a[148:151], v[108:111]
    ds_write_b128 v19, v[60:63] offset:16384
    v_mfma_f32_16x16x32_bf16 v[112:115], v[136:139], a[148:151], v[112:115]
    v_mfma_f32_16x16x32_bf16 v[116:119], v[140:143], a[148:151], v[116:119]
    v_mfma_f32_16x16x32_bf16 v[104:107], v[144:147], a[156:159], v[104:107]
    v_mfma_f32_16x16x32_bf16 v[108:111], v[148:151], a[156:159], v[108:111]
    v_mfma_f32_16x16x32_bf16 v[112:115], v[152:155], a[156:159], v[112:115]
    s_waitcnt lgkmcnt(0)
    s_barrier
    ds_read_b128 v[88:91], v14 offset:0
    v_mfma_f32_16x16x32_bf16 v[116:119], v[156:159], a[156:159], v[116:119]
    ds_read_b128 v[92:95], v14 offset:4096
    v_mfma_f32_16x16x32_bf16 v[104:107], v[160:163], a[160:163], v[104:107]
    ds_read_b128 v[96:99], v14 offset:8192
    v_mfma_f32_16x16x32_bf16 v[108:111], v[164:167], a[160:163], v[108:111]
    ds_read_b128 v[100:103], v14 offset:12288
    v_mfma_f32_16x16x32_bf16 v[112:115], v[168:171], a[160:163], v[112:115]
    v_mfma_f32_16x16x32_bf16 v[116:119], v[172:175], a[160:163], v[116:119]
    v_mfma_f32_16x16x32_bf16 v[104:107], v[176:179], a[168:171], v[104:107]
    v_mfma_f32_16x16x32_bf16 v[108:111], v[180:183], a[168:171], v[108:111]
    v_mfma_f32_16x16x32_bf16 v[112:115], v[184:187], a[168:171], v[112:115]
    s_waitcnt lgkmcnt(2)
    v_add_f32 v88, v88, v92
    s_waitcnt lgkmcnt(0)
    v_add_f32 v96, v96, v100
    v_mfma_f32_16x16x32_bf16 v[116:119], v[188:191], a[168:171], v[116:119]
    v_add_f32 v89, v89, v93
    v_add_f32 v97, v97, v101
    v_mfma_f32_16x16x32_bf16 v[104:107], v[192:195], a[172:175], v[104:107]
    v_add_f32 v90, v90, v94
    v_add_f32 v98, v98, v102
    v_mfma_f32_16x16x32_bf16 v[108:111], v[196:199], a[172:175], v[108:111]
    v_add_f32 v91, v91, v95
    v_add_f32 v99, v99, v103
    v_mfma_f32_16x16x32_bf16 v[112:115], v[200:203], a[172:175], v[112:115]
    v_add_f32 v88, v88, v96
    v_add_f32 v89, v89, v97
    v_mfma_f32_16x16x32_bf16 v[116:119], v[204:207], a[172:175], v[116:119]
    v_add_f32 v90, v90, v98
    v_add_f32 v91, v91, v99
    s_waitcnt vmcnt(10)
    v_accvgpr_read_b32 v20, a20
    v_mfma_f32_16x16x32_bf16 v[104:107], v[208:211], a[180:183], v[104:107]
    v_cvt_pk_bf16_f32 v120, v88, v89
    v_cvt_pk_bf16_f32 v121, v90, v91
    s_waitcnt vmcnt(9)
    v_accvgpr_read_b32 v21, a32
    v_mfma_f32_16x16x32_bf16 v[108:111], v[212:215], a[180:183], v[108:111]
    global_store_dwordx2 v15, v[120:121], s[38:39] sc1
    v_add_u32 v15, 0x80000, v15
    s_waitcnt vmcnt(9)
    v_accvgpr_read_b32 v22, a44
    v_mfma_f32_16x16x32_bf16 v[112:115], v[216:219], a[180:183], v[112:115]
    ds_read_b128 v[88:91], v14 offset:16384
    s_waitcnt vmcnt(8)
    v_accvgpr_read_b32 v23, a56
    s_waitcnt vmcnt(7)
    v_accvgpr_read_b32 v24, a68
    v_mfma_f32_16x16x32_bf16 v[116:119], v[220:223], a[180:183], v[116:119]
    ds_read_b128 v[92:95], v14 offset:20480
    s_waitcnt vmcnt(6)
    v_accvgpr_read_b32 v25, a80
    s_waitcnt vmcnt(5)
    v_accvgpr_read_b32 v26, a92
    v_mfma_f32_16x16x32_bf16 v[104:107], v[224:227], a[184:187], v[104:107]
    ds_read_b128 v[96:99], v14 offset:24576
    s_waitcnt vmcnt(4)
    v_accvgpr_read_b32 v27, a104
    s_waitcnt vmcnt(3)
    v_accvgpr_read_b32 v28, a116
    v_mfma_f32_16x16x32_bf16 v[108:111], v[228:231], a[184:187], v[108:111]
    ds_read_b128 v[100:103], v14 offset:28672
    s_waitcnt vmcnt(2)
    v_accvgpr_read_b32 v29, a128
    s_waitcnt vmcnt(1)
    v_accvgpr_read_b32 v30, a140
    v_mfma_f32_16x16x32_bf16 v[112:115], v[232:235], a[184:187], v[112:115]
    v_max3_u32 v20, v20, v21, v22
    v_max3_u32 v23, v23, v24, v25
    v_max3_u32 v26, v26, v27, v28
    v_mfma_f32_16x16x32_bf16 v[116:119], v[236:239], a[184:187], v[116:119]
    v_max3_u32 v20, v20, v29, v30
    v_max3_u32 v20, v20, v23, v26
    v_cmp_eq_u32 vcc, -1, v20
    v_mfma_f32_16x16x32_bf16 v[104:107], v[240:243], a[8:11], v[104:107]
    s_cbranch_vccnz L_pc3a
L_pcok3a:
    v_mfma_f32_16x16x32_bf16 v[108:111], v[244:247], a[8:11], v[108:111]
    v_mfma_f32_16x16x32_bf16 v[112:115], v[248:251], a[8:11], v[112:115]
    s_waitcnt lgkmcnt(2)
    v_add_f32 v88, v88, v92
    s_waitcnt lgkmcnt(0)
    v_add_f32 v96, v96, v100
    v_mfma_f32_16x16x32_bf16 v[116:119], v[252:255], a[8:11], v[116:119]
    v_add_f32 v89, v89, v93
    v_add_f32 v97, v97, v101
    v_mfma_f32_16x16x32_bf16 v[32:35], a[192:195], a[20:23], v[84:87]
    v_add_f32 v90, v90, v94
    v_add_f32 v98, v98, v102
    v_mfma_f32_16x16x32_bf16 v[32:35], a[208:211], a[32:35], v[32:35]
    v_add_f32 v91, v91, v95
    v_add_f32 v99, v99, v103
    v_mfma_f32_16x16x32_bf16 v[32:35], a[224:227], a[44:47], v[32:35]
    v_add_f32 v88, v88, v96
    v_add_f32 v89, v89, v97
    v_mfma_f32_16x16x32_bf16 v[32:35], v[128:131], a[56:59], v[32:35]
    v_add_f32 v90, v90, v98
    v_add_f32 v91, v91, v99
    v_mfma_f32_16x16x32_bf16 v[32:35], v[144:147], a[68:71], v[32:35]
    v_cvt_pk_bf16_f32 v122, v88, v89
    v_cvt_pk_bf16_f32 v123, v90, v91
    v_mfma_f32_16x16x32_bf16 v[32:35], v[160:163], a[80:83], v[32:35]
    global_store_dwordx2 v15, v[122:123], s[38:39] sc1
    v_add_u32 v15, 0x80000, v15
    v_mfma_f32_16x16x32_bf16 v[32:35], v[176:179], a[92:95], v[32:35]
    v_cmp_u_f32 vcc, v116, v116
    s_cbranch_vccnz L_rt2a
L_rtok2a:
    v_mfma_f32_16x16x32_bf16 v[32:35], v[192:195], a[104:107], v[32:35]
    ds_write_b128 v16, v[104:107] offset:32768
    v_mfma_f32_16x16x32_bf16 v[32:35], v[208:211], a[116:119], v[32:35]
    ds_write_b128 v17, v[108:111] offset:32768
    v_mfma_f32_16x16x32_bf16 v[32:35], v[224:227], a[128:131], v[32:35]
    ds_write_b128 v18, v[112:115] offset:32768
    v_mfma_f32_16x16x32_bf16 v[32:35], v[240:243], a[140:143], v[32:35]
    ds_write_b128 v19, v[116:119] offset:32768
    v_mfma_f32_16x16x32_bf16 v[36:39], a[196:199], a[20:23], 0
    v_mfma_f32_16x16x32_bf16 v[36:39], a[212:215], a[32:35], v[36:39]
    v_mfma_f32_16x16x32_bf16 v[36:39], a[228:231], a[44:47], v[36:39]
    v_mfma_f32_16x16x32_bf16 v[36:39], v[132:135], a[56:59], v[36:39]
    v_mfma_f32_16x16x32_bf16 v[36:39], v[148:151], a[68:71], v[36:39]
    s_waitcnt lgkmcnt(0)
    s_barrier
    ds_read_b128 v[88:91], v14 offset:32768
    v_mfma_f32_16x16x32_bf16 v[36:39], v[164:167], a[80:83], v[36:39]
    ds_read_b128 v[92:95], v14 offset:36864
    ds_write_b128 v16, v[32:35] offset:49152
    v_mfma_f32_16x16x32_bf16 v[36:39], v[180:183], a[92:95], v[36:39]
    ds_read_b128 v[96:99], v14 offset:40960
    v_mfma_f32_16x16x32_bf16 v[36:39], v[196:199], a[104:107], v[36:39]
    ds_read_b128 v[100:103], v14 offset:45056
    v_mfma_f32_16x16x32_bf16 v[36:39], v[212:215], a[116:119], v[36:39]
    v_mfma_f32_16x16x32_bf16 v[36:39], v[228:231], a[128:131], v[36:39]
    v_mfma_f32_16x16x32_bf16 v[36:39], v[244:247], a[140:143], v[36:39]
    v_mfma_f32_16x16x32_bf16 v[40:43], a[200:203], a[20:23], 0
    v_mfma_f32_16x16x32_bf16 v[40:43], a[216:219], a[32:35], v[40:43]
    s_waitcnt lgkmcnt(3)
    v_add_f32 v88, v88, v92
    s_waitcnt lgkmcnt(0)
    v_add_f32 v96, v96, v100
    v_mfma_f32_16x16x32_bf16 v[40:43], a[232:235], a[44:47], v[40:43]
    v_add_f32 v89, v89, v93
    v_add_f32 v97, v97, v101
    v_mfma_f32_16x16x32_bf16 v[40:43], v[136:139], a[56:59], v[40:43]
    v_add_f32 v90, v90, v94
    v_add_f32 v98, v98, v102
    v_mfma_f32_16x16x32_bf16 v[40:43], v[152:155], a[68:71], v[40:43]
    v_add_f32 v91, v91, v95
    v_add_f32 v99, v99, v103
    v_mfma_f32_16x16x32_bf16 v[40:43], v[168:171], a[80:83], v[40:43]
    ds_write_b128 v17, v[36:39] offset:49152
    v_add_f32 v88, v88, v96
    v_mfma_f32_16x16x32_bf16 v[40:43], v[184:187], a[92:95], v[40:43]
    v_add_f32 v89, v89, v97
    v_add_f32 v90, v90, v98
    v_mfma_f32_16x16x32_bf16 v[40:43], v[200:203], a[104:107], v[40:43]
    v_add_f32 v91, v91, v99
    v_cvt_pk_bf16_f32 v124, v88, v89
    v_mfma_f32_16x16x32_bf16 v[40:43], v[216:219], a[116:119], v[40:43]
    v_cvt_pk_bf16_f32 v125, v90, v91
    v_mfma_f32_16x16x32_bf16 v[40:43], v[232:235], a[128:131], v[40:43]
    global_store_dwordx2 v15, v[124:125], s[38:39] sc1
    v_add_u32 v15, 0x80000, v15
    v_mfma_f32_16x16x32_bf16 v[40:43], v[248:251], a[140:143], v[40:43]
    v_mfma_f32_16x16x32_bf16 v[44:47], a[204:207], a[20:23], 0
    v_mfma_f32_16x16x32_bf16 v[44:47], a[220:223], a[32:35], v[44:47]
    v_mfma_f32_16x16x32_bf16 v[44:47], a[236:239], a[44:47], v[44:47]
    v_mfma_f32_16x16x32_bf16 v[44:47], v[140:143], a[56:59], v[44:47]
    v_mfma_f32_16x16x32_bf16 v[44:47], v[156:159], a[68:71], v[44:47]
    v_mfma_f32_16x16x32_bf16 v[44:47], v[172:175], a[80:83], v[44:47]
    s_nop 1
    ds_write_b128 v18, v[40:43] offset:49152
    v_mfma_f32_16x16x32_bf16 v[44:47], v[188:191], a[92:95], v[44:47]
    v_mfma_f32_16x16x32_bf16 v[44:47], v[204:207], a[104:107], v[44:47]
    v_mfma_f32_16x16x32_bf16 v[44:47], v[220:223], a[116:119], v[44:47]
    v_mfma_f32_16x16x32_bf16 v[44:47], v[236:239], a[128:131], v[44:47]
    v_mfma_f32_16x16x32_bf16 v[44:47], v[252:255], a[140:143], v[44:47]
    v_cmp_u_f32 vcc, v36, v36
    s_cbranch_vccnz L_rt3a
L_rtok3a:
    s_nop 5
    ds_write_b128 v19, v[44:47] offset:49152
    s_waitcnt lgkmcnt(0)
    s_barrier
    ds_read_b128 v[88:91], v14 offset:49152
    ds_read_b128 v[92:95], v14 offset:53248
    ds_read_b128 v[96:99], v14 offset:57344
    ds_read_b128 v[100:103], v14 offset:61440
    s_waitcnt lgkmcnt(2)
    v_pk_add_f32 v[88:89], v[88:89], v[92:93]
    v_pk_add_f32 v[90:91], v[90:91], v[94:95]
    s_waitcnt lgkmcnt(0)
    v_pk_add_f32 v[96:97], v[96:97], v[100:101]
    v_pk_add_f32 v[98:99], v[98:99], v[102:103]
    v_pk_add_f32 v[88:89], v[88:89], v[96:97]
    v_pk_add_f32 v[90:91], v[90:91], v[98:99]
    v_cvt_pk_bf16_f32 v126, v88, v89
    v_cvt_pk_bf16_f32 v127, v90, v91
    global_store_dwordx2 v15, v[126:127], s[38:39] sc1
    s_branch L_fin
L_g1w3:
    ds_read_b64_tr_b16 v[80:81], v5 offset:0
    ds_read_b64_tr_b16 v[82:83], v5 offset:1024
    ds_read_b64_tr_b16 v[84:85], v6 offset:0
    ds_read_b64_tr_b16 v[86:87], v6 offset:1024
    ds_read_b64_tr_b16 v[88:89], v5 offset:2048
    ds_read_b64_tr_b16 v[90:91], v5 offset:3072
    ds_read_b64_tr_b16 v[92:93], v6 offset:2048
    ds_read_b64_tr_b16 v[94:95], v6 offset:3072
    s_waitcnt lgkmcnt(6)
    v_mfma_f32_16x16x32_bf16 v[32:35], a[0:3], v[80:83], 0
    ds_read_b64_tr_b16 v[96:97], v5 offset:4096
    ds_read_b64_tr_b16 v[98:99], v5 offset:5120
    ds_read_b128 v[240:243], v114 offset:0
    v_mfma_f32_16x16x32_bf16 v[40:43], a[4:7], v[80:83], 0
    global_load_dwordx4 a[124:127], v123, s[42:43] offset:-2048 sc1
    ds_read_b128 v[248:251], v114 offset:4096
    ds_read_b128 v[244:247], v115 offset:0
    v_mfma_f32_16x16x32_bf16 v[48:51], v[80:83], v[80:83], 0
    s_waitcnt lgkmcnt(9)
    ds_read_b128 v[252:255], v115 offset:4096
    v_mfma_f32_16x16x32_bf16 v[36:39], a[0:3], v[84:87], 0
    ds_read_b64_tr_b16 v[100:101], v6 offset:4096
    ds_read_b64_tr_b16 v[102:103], v6 offset:5120
    v_mfma_f32_16x16x32_bf16 v[44:47], a[4:7], v[84:87], 0
    global_load_dwordx4 a[132:135], v122, s[42:43] offset:-1024 sc1
    v_mfma_f32_16x16x32_bf16 v[52:55], v[84:87], v[84:87], 0
    s_waitcnt lgkmcnt(10)
    v_mfma_f32_16x16x32_bf16 v[32:35], a[12:15], v[88:91], v[32:35]
    ds_read_b64_tr_b16 v[80:81], v5 offset:6144
    ds_read_b64_tr_b16 v[82:83], v5 offset:7168
    v_mfma_f32_16x16x32_bf16 v[40:43], a[16:19], v[88:91], v[40:43]
    global_load_dwordx4 a[136:139], v123, s[42:43] offset:-1024 sc1
    s_waitcnt lgkmcnt(7)
    v_add_f32 v240, v240, v56
    v_add_f32 v241, v241, v57
    v_mfma_f32_16x16x32_bf16 v[48:51], v[88:91], v[88:91], v[48:51]
    v_add_f32 v242, v242, v58
    v_add_f32 v243, v243, v59
    s_waitcnt lgkmcnt(5)
    v_add_f32 v244, v244, v60
    v_mfma_f32_16x16x32_bf16 v[36:39], a[12:15], v[92:95], v[36:39]
    ds_read_b64_tr_b16 v[84:85], v6 offset:6144
    ds_read_b64_tr_b16 v[86:87], v6 offset:7168
    v_add_f32 v245, v245, v61
    v_mfma_f32_16x16x32_bf16 v[44:47], a[16:19], v[92:95], v[44:47]
    global_load_dwordx4 a[144:147], v122, s[42:43] offset:0 sc1
    v_add_f32 v246, v246, v62
    v_add_f32 v247, v247, v63
    v_mfma_f32_16x16x32_bf16 v[52:55], v[92:95], v[92:95], v[52:55]
    v_add_f32 v240, v240, v248
    v_add_f32 v241, v241, v249
    v_add_f32 v242, v242, v250
    v_mfma_f32_16x16x32_bf16 v[32:35], a[24:27], v[96:99], v[32:35]
    ds_read_b64_tr_b16 v[88:89], v5 offset:8192
    ds_read_b64_tr_b16 v[90:91], v5 offset:9216
    v_add_f32 v243, v243, v251
    v_mfma_f32_16x16x32_bf16 v[40:43], a[28:31], v[96:99], v[40:43]
    global_load_dwordx4 a[148:151], v123, s[42:43] offset:0 sc1
    s_waitcnt lgkmcnt(8)
    v_add_f32 v244, v244, v252
    v_add_f32 v245, v245, v253
    v_mfma_f32_16x16x32_bf16 v[48:51], v[96:99], v[96:99], v[48:51]
    s_waitcnt lgkmcnt(6)
    v_add_f32 v246, v246, v254
    v_add_f32 v247, v247, v255
    v_cvt_pk_bf16_f32 v252, v240, v241
    v_mfma_f32_16x16x32_bf16 v[36:39], a[24:27], v[100:103], v[36:39]
    ds_read_b64_tr_b16 v[92:93], v6 offset:8192
    ds_read_b64_tr_b16 v[94:95], v6 offset:9216
    v_cvt_pk_bf16_f32 v253, v242, v243
    v_mfma_f32_16x16x32_bf16 v[44:47], a[28:31], v[100:103], v[44:47]
    global_load_dwordx4 a[156:159], v122, s[42:43] offset:1024 sc1
    v_cvt_pk_bf16_f32 v254, v244, v245
    v_cvt_pk_bf16_f32 v255, v246, v247
    v_mfma_f32_16x16x32_bf16 v[52:55], v[100:103], v[100:103], v[52:55]
    s_cmp_lg_u32 s61, 0
    s_cbranch_scc1 L_nobb
    global_store_dwordx4 v121, v[252:255], s[42:43] sc1
L_nobb:
    s_waitcnt lgkmcnt(6)
    v_mfma_f32_16x16x32_bf16 v[32:35], a[36:39], v[80:83], v[32:35]
    ds_read_b64_tr_b16 v[96:97], v5 offset:10240
    ds_read_b64_tr_b16 v[98:99], v5 offset:11264
    v_mfma_f32_16x16x32_bf16 v[40:43], a[40:43], v[80:83], v[40:43]
    global_load_dwordx4 a[160:163], v123, s[42:43] offset:1024 sc1
    v_mfma_f32_16x16x32_bf16 v[48:51], v[80:83], v[80:83], v[48:51]
    s_waitcnt lgkmcnt(6)
    v_mfma_f32_16x16x32_bf16 v[36:39], a[36:39], v[84:87], v[36:39]
    ds_read_b64_tr_b16 v[100:101], v6 offset:10240
    ds_read_b64_tr_b16 v[102:103], v6 offset:11264
    v_mfma_f32_16x16x32_bf16 v[44:47], a[40:43], v[84:87], v[44:47]
    global_load_dwordx4 a[168:171], v122, s[42:43] offset:2048 sc1
    v_mfma_f32_16x16x32_bf16 v[52:55], v[84:87], v[84:87], v[52:55]
    s_waitcnt lgkmcnt(6)
    v_mfma_f32_16x16x32_bf16 v[32:35], a[48:51], v[88:91], v[32:35]
    ds_read_b64_tr_b16 v[80:81], v5 offset:12288
    ds_read_b64_tr_b16 v[82:83], v5 offset:13312
    v_mfma_f32_16x16x32_bf16 v[40:43], a[52:55], v[88:91], v[40:43]
    global_load_dwordx4 a[172:175], v123, s[42:43] offset:2048 sc1
    v_mfma_f32_16x16x32_bf16 v[48:51], v[88:91], v[88:91], v[48:51]
    s_waitcnt lgkmcnt(6)
    v_mfma_f32_16x16x32_bf16 v[36:39], a[48:51], v[92:95], v[36:39]
    ds_read_b64_tr_b16 v[84:85], v6 offset:12288
    ds_read_b64_tr_b16 v[86:87], v6 offset:13312
    v_mfma_f32_16x16x32_bf16 v[44:47], a[52:55], v[92:95], v[44:47]
    global_load_dwordx4 a[180:183], v122, s[42:43] offset:3072 sc1
    v_mfma_f32_16x16x32_bf16 v[52:55], v[92:95], v[92:95], v[52:55]
    s_waitcnt lgkmcnt(6)
    v_mfma_f32_16x16x32_bf16 v[32:35], a[60:63], v[96:99], v[32:35]
    ds_read_b64_tr_b16 v[88:89], v5 offset:14336
    ds_read_b64_tr_b16 v[90:91], v5 offset:15360
    v_mfma_f32_16x16x32_bf16 v[40:43], a[64:67], v[96:99], v[40:43]
    global_load_dwordx4 a[184:187], v123, s[42:43] offset:3072 sc1
    s_add_u32 m0, s12, 32768
    v_mfma_f32_16x16x32_bf16 v[48:51], v[96:99], v[96:99], v[48:51]
    s_waitcnt lgkmcnt(6)
    v_mfma_f32_16x16x32_bf16 v[36:39], a[60:63], v[100:103], v[36:39]
    ds_read_b64_tr_b16 v[92:93], v6 offset:14336
    ds_read_b64_tr_b16 v[94:95], v6 offset:15360
    v_mfma_f32_16x16x32_bf16 v[44:47], a[64:67], v[100:103], v[44:47]
    global_load_lds_dwordx4 v4, s[42:43] offset:0 sc1
    v_mfma_f32_16x16x32_bf16 v[52:55], v[100:103], v[100:103], v[52:55]
    s_waitcnt lgkmcnt(6)
    v_mfma_f32_16x16x32_bf16 v[32:35], a[72:75], v[80:83], v[32:35]
    ds_read_b64_tr_b16 a[8:9], v5 offset:16384
    ds_read_b64_tr_b16 a[10:11], v5 offset:17408
    v_mfma_f32_16x16x32_bf16 v[40:43], a[76:79], v[80:83], v[40:43]
    global_load_lds_dwordx4 v4, s[42:43] offset:1024 sc1
    v_mfma_f32_16x16x32_bf16 v[48:51], v[80:83], v[80:83], v[48:51]
    s_waitcnt lgkmcnt(6)
    v_mfma_f32_16x16x32_bf16 v[36:39], a[72:75], v[84:87], v[36:39]
    ds_read_b64_tr_b16 a[20:21], v6 offset:16384
    ds_read_b64_tr_b16 a[22:23], v6 offset:17408
    v_mfma_f32_16x16x32_bf16 v[44:47], a[76:79], v[84:87], v[44:47]
    global_load_lds_dwordx4 v4, s[42:43] offset:2048 sc1
    global_load_dword v20, v125, s[42:43] offset:0 sc1
    v_mfma_f32_16x16x32_bf16 v[52:55], v[84:87], v[84:87], v[52:55]
    s_waitcnt vmcnt(25) lgkmcnt(6)
    global_load_dword v21, v125, s[42:43] offset:256 sc1
    v_mfma_f32_16x16x32_bf16 v[32:35], a[84:87], v[88:91], v[32:35]
    s_waitcnt vmcnt(25)
    ds_read_b64_tr_b16 a[32:33], v5 offset:18432
    ds_read_b64_tr_b16 a[34:35], v5 offset:19456
    v_mfma_f32_16x16x32_bf16 v[40:43], a[88:91], v[88:91], v[40:43]
    global_load_lds_dwordx4 v4, s[42:43] offset:3072 sc1
    global_load_dword v22, v125, s[42:43] offset:512 sc1
    v_mfma_f32_16x16x32_bf16 v[48:51], v[88:91], v[88:91], v[48:51]
    s_waitcnt lgkmcnt(6)
    global_load_dword v23, v125, s[42:43] offset:768 sc1
    v_add_u32 v4, 4096, v4
    v_mfma_f32_16x16x32_bf16 v[36:39], a[84:87], v[92:95], v[36:39]
    ds_read_b64_tr_b16 a[44:45], v6 offset:18432
    ds_read_b64_tr_b16 a[46:47], v6 offset:19456
    v_mfma_f32_16x16x32_bf16 v[44:47], a[88:91], v[92:95], v[44:47]
    s_add_u32 m0, s12, 36864
    s_nop 0
    global_load_lds_dwordx4 v4, s[42:43] offset:0 sc1
    global_load_dword v24, v125, s[42:43] offset:1024 sc1
    v_mfma_f32_16x16x32_bf16 v[52:55], v[92:95], v[92:95], v[52:55]
    s_waitcnt vmcnt(27) lgkmcnt(6)
    global_load_dword v25, v125, s[42:43] offset:1280 sc1
    v_mfma_f32_16x16x32_bf16 v[40:43], a[100:103], a[8:11], v[40:43]
    ds_read_b64_tr_b16 a[56:57], v5 offset:20480
    ds_read_b64_tr_b16 a[58:59], v5 offset:21504
    v_mfma_f32_16x16x32_bf16 v[48:51], a[8:11], a[8:11], v[48:51]
    s_waitcnt lgkmcnt(6)
    global_load_lds_dwordx4 v4, s[42:43] offset:1024 sc1
    global_load_dword v26, v125, s[42:43] offset:1536 sc1
    v_mfma_f32_16x16x32_bf16 v[44:47], a[100:103], a[20:23], v[44:47]
    ds_read_b64_tr_b16 a[68:69], v6 offset:20480
    ds_read_b64_tr_b16 a[70:71], v6 offset:21504
    v_mfma_f32_16x16x32_bf16 v[52:55], a[20:23], a[20:23], v[52:55]
    s_waitcnt vmcnt(27) lgkmcnt(6)
    global_load_lds_dwordx4 v4, s[42:43] offset:2048 sc1
    global_load_dword v27, v125, s[42:43] offset:1792 sc1
    v_mfma_f32_16x16x32_bf16 v[40:43], a[112:115], a[32:35], v[40:43]
    ds_read_b64_tr_b16 a[80:81], v5 offset:22528
    ds_read_b64_tr_b16 a[82:83], v5 offset:23552
    v_mfma_f32_16x16x32_bf16 v[48:51], a[32:35], a[32:35], v[48:51]
    global_load_lds_dwordx4 v4, s[42:43] offset:3072 sc1
    v_add_u32 v4, 520192, v4
    s_waitcnt vmcnt(27)
    v_cmp_ne_u32 vcc, s52, v105
    s_waitcnt lgkmcnt(6)
    v_mfma_f32_16x16x32_bf16 v[44:47], a[112:115], a[44:47], v[44:47]
    ds_read_b64_tr_b16 a[92:93], v6 offset:22528
    ds_read_b64_tr_b16 a[94:95], v6 offset:23552
    s_cbranch_vccnz L_flrb
L_flokb:
    v_mfma_f32_16x16x32_bf16 v[52:55], a[44:47], a[44:47], v[52:55]
    s_barrier
    global_load_dwordx4 a[192:195], v10, s[42:43] offset:-4096 sc1
    s_waitcnt vmcnt(27) lgkmcnt(6)
    v_mfma_f32_16x16x32_bf16 v[40:43], a[124:127], a[56:59], v[40:43]
    ds_read_b64_tr_b16 a[104:105], v5 offset:24576
    ds_read_b64_tr_b16 a[106:107], v5 offset:25600
    v_mfma_f32_16x16x32_bf16 v[48:51], a[56:59], a[56:59], v[48:51]
    s_waitcnt lgkmcnt(6)
    v_mfma_f32_16x16x32_bf16 v[44:47], a[124:127], a[68:71], v[44:47]
    ds_read_b64_tr_b16 a[116:117], v6 offset:24576
    ds_read_b64_tr_b16 a[118:119], v6 offset:25600
    v_mfma_f32_16x16x32_bf16 v[52:55], a[68:71], a[68:71], v[52:55]
    s_waitcnt vmcnt(25) lgkmcnt(6)
    v_mfma_f32_16x16x32_bf16 v[40:43], a[136:139], a[80:83], v[40:43]
    ds_read_b64_tr_b16 a[128:129], v5 offset:26624
    ds_read_b64_tr_b16 a[130:131], v5 offset:27648
    v_mfma_f32_16x16x32_bf16 v[48:51], a[80:83], a[80:83], v[48:51]
    s_waitcnt lgkmcnt(6)
    global_load_dwordx4 a[196:199], v10, s[42:43] offset:-3072 sc1
    v_mfma_f32_16x16x32_bf16 v[44:47], a[136:139], a[92:95], v[44:47]
    ds_read_b64_tr_b16 a[140:141], v6 offset:26624
    ds_read_b64_tr_b16 a[142:143], v6 offset:27648
    v_mfma_f32_16x16x32_bf16 v[52:55], a[92:95], a[92:95], v[52:55]
    s_waitcnt vmcnt(24) lgkmcnt(6)
    v_mfma_f32_16x16x32_bf16 v[40:43], a[148:151], a[104:107], v[40:43]
    ds_read_b64_tr_b16 a[152:153], v5 offset:28672
    ds_read_b64_tr_b16 a[154:155], v5 offset:29696
    v_mfma_f32_16x16x32_bf16 v[48:51], a[104:107], a[104:107], v[48:51]
    s_waitcnt lgkmcnt(6)
    v_mfma_f32_16x16x32_bf16 v[44:47], a[148:151], a[116:119], v[44:47]
    ds_read_b64_tr_b16 a[164:165], v6 offset:28672
    ds_read_b64_tr_b16 a[166:167], v6 offset:29696
    v_mfma_f32_16x16x32_bf16 v[52:55], a[116:119], a[116:119], v[52:55]
    s_waitcnt vmcnt(22) lgkmcnt(6)
    global_load_dwordx4 a[200:203], v10, s[42:43] offset:-2048 sc1
    v_mfma_f32_16x16x32_bf16 v[40:43], a[160:163], a[128:131], v[40:43]
    ds_read_b64_tr_b16 a[176:177], v5 offset:30720
    ds_read_b64_tr_b16 a[178:179], v5 offset:31744
    v_mfma_f32_16x16x32_bf16 v[48:51], a[128:131], a[128:131], v[48:51]
    s_waitcnt lgkmcnt(6)
    v_mfma_f32_16x16x32_bf16 v[44:47], a[160:163], a[140:143], v[44:47]
    ds_read_b64_tr_b16 a[188:189], v6 offset:30720
    ds_read_b64_tr_b16 a[190:191], v6 offset:31744
    v_mfma_f32_16x16x32_bf16 v[52:55], a[140:143], a[140:143], v[52:55]
    s_waitcnt vmcnt(21) lgkmcnt(6)
    v_mfma_f32_16x16x32_bf16 v[40:43], a[172:175], a[152:155], v[40:43]
    global_load_dwordx4 a[204:207], v10, s[42:43] offset:-1024 sc1
    v_mfma_f32_16x16x32_bf16 v[48:51], a[152:155], a[152:155], v[48:51]
    s_waitcnt lgkmcnt(4)
    v_mfma_f32_16x16x32_bf16 v[44:47], a[172:175], a[164:167], v[44:47]
    v_mfma_f32_16x16x32_bf16 v[52:55], a[164:167], a[164:167], v[52:55]
    s_waitcnt vmcnt(20) lgkmcnt(2)
    v_mfma_f32_16x16x32_bf16 v[40:43], a[184:187], a[176:179], v[40:43]
    v_mfma_f32_16x16x32_bf16 v[48:51], a[176:179], a[176:179], v[48:51]
    global_load_dwordx4 a[208:211], v10, s[42:43] offset:0 sc1
    s_waitcnt lgkmcnt(0)
    v_mfma_f32_16x16x32_bf16 v[44:47], a[184:187], a[188:191], v[44:47]
    v_mfma_f32_16x16x32_bf16 v[52:55], a[188:191], a[188:191], v[52:55]
    v_mfma_f32_16x16x32_bf16 v[32:35], a[96:99], a[8:11], v[32:35]
    v_mfma_f32_16x16x32_bf16 v[36:39], a[96:99], a[20:23], v[36:39]
    v_mfma_f32_16x16x32_bf16 v[32:35], a[108:111], a[32:35], v[32:35]
    global_load_dwordx4 a[212:215], v10, s[42:43] offset:1024 sc1
    v_cndmask_b32 v124, 0, v48, s[24:25]
    s_nop 2
    v_cndmask_b32 v125, 0, v52, s[24:25]
    v_cndmask_b32 v124, v124, v49, s[26:27]
    v_mfma_f32_16x16x32_bf16 v[36:39], a[108:111], a[44:47], v[36:39]
    s_waitcnt vmcnt(6)
    s_barrier
    v_add_u32 v5, 0x8000, v5
    v_add_u32 v6, 0x8000, v6
    v_cndmask_b32 v125, v125, v53, s[26:27]
    v_mfma_f32_16x16x32_bf16 v[32:35], a[120:123], a[56:59], v[32:35]
    v_cndmask_b32 v124, v124, v50, s[28:29]
    v_cndmask_b32 v125, v125, v54, s[28:29]
    v_cndmask_b32 v124, v124, v51, s[30:31]
    v_cndmask_b32 v125, v125, v55, s[30:31]
    v_mfma_f32_16x16x32_bf16 v[36:39], a[120:123], a[68:71], v[36:39]
    v_mov_b32 v126, v40
    v_mov_b32 v127, v44
    v_permlane16_swap_b32 v124, v125
    v_mfma_f32_16x16x32_bf16 v[32:35], a[132:135], a[80:83], v[32:35]
    ds_read_b64_tr_b16 v[88:89], v5 offset:0
    ds_read_b64_tr_b16 v[90:91], v5 offset:1024
    v_permlane16_swap_b32 v126, v127
    v_mfma_f32_16x16x32_bf16 v[36:39], a[132:135], a[92:95], v[36:39]
    ds_read_b64_tr_b16 v[92:93], v6 offset:0
    ds_read_b64_tr_b16 v[94:95], v6 offset:1024
    v_add_f32 v124, v124, v125
    v_mov_b32 v125, v124
    v_mfma_f32_16x16x32_bf16 v[32:35], a[144:147], a[104:107], v[32:35]
    global_load_dwordx4 a[216:219], v10, s[42:43] offset:2048 sc1
    v_permlane32_swap_b32 v124, v125
    v_add_f32 v124, v124, v125
    v_mfma_f32_16x16x32_bf16 v[36:39], a[144:147], a[116:119], v[36:39]
    v_mul_f32 v127, 0x3b000000, v127
    v_mul_f32 v124, 0x3b000000, v124
    v_fma_f32 v124, -v127, v127, v124
    v_max_f32 v124, 0, v124
    v_mfma_f32_16x16x32_bf16 v[32:35], a[156:159], a[128:131], v[32:35]
    ds_read_b64_tr_b16 v[96:97], v5 offset:2048
    ds_read_b64_tr_b16 v[98:99], v5 offset:3072
    v_cvt_pk_bf16_f32 v127, v127, v124
    v_and_b32 v124, s60, v127
    v_mfma_f32_16x16x32_bf16 v[36:39], a[156:159], a[140:143], v[36:39]
    ds_read_b64_tr_b16 v[100:101], v6 offset:2048
    ds_read_b64_tr_b16 v[102:103], v6 offset:3072
    v_add_f32 v124, 0x3727c5ac, v124
    v_cvt_pk_bf16_f32 v125, v124, v124
    v_mfma_f32_16x16x32_bf16 v[32:35], a[168:171], a[152:155], v[32:35]
    v_and_b32 v124, s60, v125
    v_sqrt_f32 v124, v124
    v_lshlrev_b32 v127, 16, v127
    v_mfma_f32_16x16x32_bf16 v[36:39], a[168:171], a[164:167], v[36:39]
    global_load_dwordx4 a[220:223], v10, s[42:43] offset:3072 sc1
    v_add_u32 v10, 0x2000, v10
    v_cvt_pk_bf16_f32 v125, v124, v124
    v_and_b32 v124, s60, v125
    v_mfma_f32_16x16x32_bf16 v[32:35], a[180:183], a[176:179], v[32:35]
    v_rcp_f32 v125, v124
    v_cvt_pk_bf16_f32 v48, -v127, -v127
    v_mul_f32 v54, v124, v124
    v_mfma_f32_16x16x32_bf16 v[36:39], a[180:183], a[188:191], v[36:39]
    v_mul_f32 v52, 0xc0135761, v125
    v_mul_f32 v125, v125, v125
    v_mov_b32 v49, v48
    v_mul_f32 v125, 0x3d372713, v125
    v_mov_b32 v50, v48
    v_mul_f32 v53, v52, v125
    v_mov_b32 v51, v48
    v_fma_f32 v52, v127, 0, v52
    s_mov_b32 exec_lo, 0
    ds_write_b128 v8, v[48:51] offset:0
    ds_write_b128 v8, v[52:55] offset:16
    s_mov_b32 exec_lo, -1
    s_waitcnt lgkmcnt(8)
    v_mfma_f32_16x16x32_bf16 v[56:59], a[0:3], v[88:91], 0
    ds_read_b64_tr_b16 v[80:81], v5 offset:4096
    ds_read_b64_tr_b16 v[82:83], v5 offset:5120
    v_mfma_f32_16x16x32_bf16 v[64:67], a[4:7], v[88:91], 0
    s_add_u32 m0, s12, 65536
    s_nop 0
    global_load_lds_dwordx4 v4, s[42:43] offset:0 sc1
    s_waitcnt lgkmcnt(2)
    s_barrier
    v_mfma_f32_16x16x32_bf16 v[72:75], v[88:91], v[88:91], 0
    ds_read_b128 v[104:107], v7 offset:0
    ds_read_b128 v[112:115], v7 offset:512
    v_mfma_f32_16x16x32_bf16 v[60:63], a[0:3], v[92:95], 0
    ds_read_b64_tr_b16 v[84:85], v6 offset:4096
    ds_read_b64_tr_b16 v[86:87], v6 offset:5120
    v_mfma_f32_16x16x32_bf16 v[68:71], a[4:7], v[92:95], 0
    global_load_lds_dwordx4 v4, s[42:43] offset:1024 sc1
    ds_read_b128 v[108:111], v7 offset:16
    v_mfma_f32_16x16x32_bf16 v[76:79], v[92:95], v[92:95], 0
    ds_read_b128 v[116:119], v7 offset:528
    v_mfma_f32_16x16x32_bf16 v[56:59], a[12:15], v[96:99], v[56:59]
    ds_read_b64_tr_b16 v[88:89], v5 offset:6144
    ds_read_b64_tr_b16 v[90:91], v5 offset:7168
    v_mfma_f32_16x16x32_bf16 v[64:67], a[16:19], v[96:99], v[64:67]
    global_load_lds_dwordx4 v4, s[42:43] offset:2048 sc1
    v_mfma_f32_16x16x32_bf16 v[72:75], v[96:99], v[96:99], v[72:75]
    v_mfma_f32_16x16x32_bf16 v[60:63], a[12:15], v[100:103], v[60:63]
    s_waitcnt lgkmcnt(7)
    ds_read_b64_tr_b16 v[92:93], v6 offset:6144
    ds_read_b64_tr_b16 v[94:95], v6 offset:7168
    v_mfma_f32_16x16x32_bf16 v[32:35], v[20:23], v[104:107], v[32:35]
    s_waitcnt lgkmcnt(8)
    v_mfma_f32_16x16x32_bf16 v[36:39], v[20:23], v[112:115], v[36:39]
    global_load_lds_dwordx4 v4, s[42:43] offset:3072 sc1
    v_add_u32 v4, 4096, v4
    v_mfma_f32_16x16x32_bf16 v[68:71], a[16:19], v[100:103], v[68:71]
    s_add_u32 m0, s12, 69632
    v_mfma_f32_16x16x32_bf16 v[76:79], v[100:103], v[100:103], v[76:79]
    global_load_lds_dwordx4 v4, s[42:43] offset:0 sc1
    s_waitcnt lgkmcnt(4)
    v_cmp_u_f32 vcc, v108, v116
    v_mfma_f32_16x16x32_bf16 v[56:59], a[24:27], v[80:83], v[56:59]
    ds_read_b64_tr_b16 v[96:97], v5 offset:8192
    ds_read_b64_tr_b16 v[98:99], v5 offset:9216
    v_mfma_f32_16x16x32_bf16 v[64:67], a[28:31], v[80:83], v[64:67]
    global_load_lds_dwordx4 v4, s[42:43] offset:1024 sc1
    s_or_b64 s[62:63], s[62:63], vcc
    v_mfma_f32_16x16x32_bf16 v[72:75], v[80:83], v[80:83], v[72:75]
    v_mul_f32 v111, v32, v32
    v_mul_f32 v119, v33, v33
    v_mfma_f32_16x16x32_bf16 v[60:63], a[24:27], v[84:87], v[60:63]
    ds_read_b64_tr_b16 v[100:101], v6 offset:8192
    ds_read_b64_tr_b16 v[102:103], v6 offset:9216
    v_mfma_f32_16x16x32_bf16 v[68:71], a[28:31], v[84:87], v[68:71]
    global_load_lds_dwordx4 v4, s[42:43] offset:2048 sc1
    v_fma_f32 v111, v111, v109, v108
    v_mfma_f32_16x16x32_bf16 v[76:79], v[84:87], v[84:87], v[76:79]
    s_waitcnt lgkmcnt(6)
    v_fma_f32 v119, v119, v109, v108
    v_mul_f32 v111, v32, v111
    v_mfma_f32_16x16x32_bf16 v[56:59], a[36:39], v[88:91], v[56:59]
    ds_read_b64_tr_b16 v[80:81], v5 offset:10240
    ds_read_b64_tr_b16 v[82:83], v5 offset:11264
    v_mfma_f32_16x16x32_bf16 v[64:67], a[40:43], v[88:91], v[64:67]
    global_load_lds_dwordx4 v4, s[42:43] offset:3072 sc1
    v_add_u32 v4, 520192, v4
    v_mfma_f32_16x16x32_bf16 v[72:75], v[88:91], v[88:91], v[72:75]
    s_waitcnt lgkmcnt(6)
    global_load_dwordx4 a[224:227], v10, s[42:43] offset:-4096 sc1
    v_mul_f32 v119, v33, v119
    v_mfma_f32_16x16x32_bf16 v[60:63], a[36:39], v[92:95], v[60:63]
    ds_read_b64_tr_b16 v[84:85], v6 offset:10240
    ds_read_b64_tr_b16 v[86:87], v6 offset:11264
    v_mfma_f32_16x16x32_bf16 v[68:71], a[40:43], v[92:95], v[68:71]
    v_exp_f32 v111, v111
    v_mfma_f32_16x16x32_bf16 v[76:79], v[92:95], v[92:95], v[76:79]
    s_waitcnt lgkmcnt(6)
    v_exp_f32 v119, v119
    v_mfma_f32_16x16x32_bf16 v[56:59], a[48:51], v[96:99], v[56:59]
    ds_read_b64_tr_b16 v[88:89], v5 offset:12288
    ds_read_b64_tr_b16 v[90:91], v5 offset:13312
    v_mfma_f32_16x16x32_bf16 v[64:67], a[52:55], v[96:99], v[64:67]
    global_load_dwordx4 a[228:231], v10, s[42:43] offset:-3072 sc1
    v_mul_f32 v35, v32, v35
    v_mfma_f32_16x16x32_bf16 v[72:75], v[96:99], v[96:99], v[72:75]
    s_waitcnt lgkmcnt(6)
    v_mul_f32 v34, v33, v34
    v_fma_f32 v111, v111, v110, v110
    v_mfma_f32_16x16x32_bf16 v[60:63], a[48:51], v[100:103], v[60:63]
    ds_read_b64_tr_b16 v[92:93], v6 offset:12288
    ds_read_b64_tr_b16 v[94:95], v6 offset:13312
    v_mfma_f32_16x16x32_bf16 v[68:71], a[52:55], v[100:103], v[68:71]
    v_fma_f32 v119, v119, v110, v110
    v_rcp_f32 v111, v111
    v_mfma_f32_16x16x32_bf16 v[76:79], v[100:103], v[100:103], v[76:79]
    s_waitcnt lgkmcnt(6)
    v_rcp_f32 v119, v119
    v_mfma_f32_16x16x32_bf16 v[56:59], a[60:63], v[80:83], v[56:59]
    ds_read_b64_tr_b16 v[96:97], v5 offset:14336
    ds_read_b64_tr_b16 v[98:99], v5 offset:15360
    v_mfma_f32_16x16x32_bf16 v[64:67], a[64:67], v[80:83], v[64:67]
    global_load_dwordx4 a[232:235], v10, s[42:43] offset:-2048 sc1
    v_mul_f32 v111, v35, v111
    v_mfma_f32_16x16x32_bf16 v[72:75], v[80:83], v[80:83], v[72:75]
    v_mul_f32 v119, v34, v119
    v_cvt_pk_bf16_f32 v120, v111, v119
    v_mfma_f32_16x16x32_bf16 v[40:43], v[24:27], v[104:107], v[40:43]
    v_mfma_f32_16x16x32_bf16 v[44:47], v[24:27], v[112:115], v[44:47]
    s_waitcnt lgkmcnt(6)
    v_mul_f32 v111, v36, v36
    v_mul_f32 v119, v37, v37
    v_mfma_f32_16x16x32_bf16 v[60:63], a[60:63], v[84:87], v[60:63]
    ds_read_b64_tr_b16 v[100:101], v6 offset:14336
    ds_read_b64_tr_b16 v[102:103], v6 offset:15360
    v_mfma_f32_16x16x32_bf16 v[68:71], a[64:67], v[84:87], v[68:71]
    v_fma_f32 v111, v111, v117, v116
    v_fma_f32 v119, v119, v117, v116
    v_mfma_f32_16x16x32_bf16 v[76:79], v[84:87], v[84:87], v[76:79]
    s_waitcnt lgkmcnt(6)
    v_mul_f32 v111, v36, v111
    v_mul_f32 v119, v37, v119
    v_mfma_f32_16x16x32_bf16 v[56:59], a[72:75], v[88:91], v[56:59]
    ds_read_b64_tr_b16 a[8:9], v5 offset:16384
    ds_read_b64_tr_b16 a[10:11], v5 offset:17408
    v_mfma_f32_16x16x32_bf16 v[64:67], a[76:79], v[88:91], v[64:67]
    global_load_dwordx4 a[236:239], v10, s[42:43] offset:-1024 sc1
    v_exp_f32 v111, v111
    v_mfma_f32_16x16x32_bf16 v[72:75], v[88:91], v[88:91], v[72:75]
    s_waitcnt lgkmcnt(6)
    v_exp_f32 v119, v119
    v_mfma_f32_16x16x32_bf16 v[60:63], a[72:75], v[92:95], v[60:63]
    ds_read_b64_tr_b16 a[20:21], v6 offset:16384
    ds_read_b64_tr_b16 a[22:23], v6 offset:17408
    v_mfma_f32_16x16x32_bf16 v[68:71], a[76:79], v[92:95], v[68:71]
    v_mul_f32 v39, v36, v39
    v_mul_f32 v38, v37, v38
    v_mfma_f32_16x16x32_bf16 v[76:79], v[92:95], v[92:95], v[76:79]
    s_waitcnt lgkmcnt(6)
    v_fma_f32 v111, v111, v118, v118
    v_fma_f32 v119, v119, v118, v118
    v_mfma_f32_16x16x32_bf16 v[56:59], a[84:87], v[96:99], v[56:59]
    ds_read_b64_tr_b16 a[32:33], v5 offset:18432
    ds_read_b64_tr_b16 a[34:35], v5 offset:19456
    v_mfma_f32_16x16x32_bf16 v[64:67], a[88:91], v[96:99], v[64:67]
    global_load_dwordx4 v[128:131], v10, s[42:43] offset:0 sc1
    v_rcp_f32 v111, v111
    v_mfma_f32_16x16x32_bf16 v[72:75], v[96:99], v[96:99], v[72:75]
    s_waitcnt lgkmcnt(6)
    v_rcp_f32 v119, v119
    v_mfma_f32_16x16x32_bf16 v[60:63], a[84:87], v[100:103], v[60:63]
    ds_read_b64_tr_b16 a[44:45], v6 offset:18432
    ds_read_b64_tr_b16 a[46:47], v6 offset:19456
    v_mfma_f32_16x16x32_bf16 v[68:71], a[88:91], v[100:103], v[68:71]
    v_mul_f32 v111, v39, v111
    v_mul_f32 v119, v38, v119
    v_mfma_f32_16x16x32_bf16 v[76:79], v[100:103], v[100:103], v[76:79]
    s_waitcnt lgkmcnt(6)
    v_cvt_pk_bf16_f32 v121, v111, v119
    v_mul_f32 v111, v40, v40
    v_mfma_f32_16x16x32_bf16 v[64:67], a[100:103], a[8:11], v[64:67]
    ds_read_b64_tr_b16 a[56:57], v5 offset:20480
    ds_read_b64_tr_b16 a[58:59], v5 offset:21504
    v_mfma_f32_16x16x32_bf16 v[72:75], a[8:11], a[8:11], v[72:75]
    s_waitcnt lgkmcnt(6)
    global_load_dwordx4 v[132:135], v10, s[42:43] offset:1024 sc1
    v_mul_f32 v119, v41, v41
    v_mfma_f32_16x16x32_bf16 v[68:71], a[100:103], a[20:23], v[68:71]
    ds_read_b64_tr_b16 a[68:69], v6 offset:20480
    ds_read_b64_tr_b16 a[70:71], v6 offset:21504
    v_mfma_f32_16x16x32_bf16 v[76:79], a[20:23], a[20:23], v[76:79]
    s_waitcnt lgkmcnt(6)
    v_fma_f32 v111, v111, v109, v108
    v_fma_f32 v119, v119, v109, v108
    v_mfma_f32_16x16x32_bf16 v[64:67], a[112:115], a[32:35], v[64:67]
    ds_read_b64_tr_b16 a[80:81], v5 offset:22528
    ds_read_b64_tr_b16 a[82:83], v5 offset:23552
    v_mfma_f32_16x16x32_bf16 v[72:75], a[32:35], a[32:35], v[72:75]
    s_waitcnt lgkmcnt(6)
    v_mul_f32 v111, v40, v111
    v_mul_f32 v119, v41, v119
    v_mfma_f32_16x16x32_bf16 v[68:71], a[112:115], a[44:47], v[68:71]
    ds_read_b64_tr_b16 a[92:93], v6 offset:22528
    ds_read_b64_tr_b16 a[94:95], v6 offset:23552
    v_mfma_f32_16x16x32_bf16 v[76:79], a[44:47], a[44:47], v[76:79]
    s_waitcnt lgkmcnt(6)
    global_load_dwordx4 v[136:139], v10, s[42:43] offset:2048 sc1
    v_exp_f32 v111, v111
    v_mfma_f32_16x16x32_bf16 v[64:67], a[124:127], a[56:59], v[64:67]
    ds_read_b64_tr_b16 a[104:105], v5 offset:24576
    ds_read_b64_tr_b16 a[106:107], v5 offset:25600
    v_mfma_f32_16x16x32_bf16 v[72:75], a[56:59], a[56:59], v[72:75]
    s_waitcnt lgkmcnt(6)
    v_exp_f32 v119, v119
    v_mfma_f32_16x16x32_bf16 v[68:71], a[124:127], a[68:71], v[68:71]
    ds_read_b64_tr_b16 a[116:117], v6 offset:24576
    ds_read_b64_tr_b16 a[118:119], v6 offset:25600
    v_mfma_f32_16x16x32_bf16 v[76:79], a[68:71], a[68:71], v[76:79]
    s_waitcnt lgkmcnt(6)
    v_mul_f32 v43, v40, v43
    v_mul_f32 v42, v41, v42
    v_mfma_f32_16x16x32_bf16 v[64:67], a[136:139], a[80:83], v[64:67]
    ds_read_b64_tr_b16 a[128:129], v5 offset:26624
    ds_read_b64_tr_b16 a[130:131], v5 offset:27648
    v_mfma_f32_16x16x32_bf16 v[72:75], a[80:83], a[80:83], v[72:75]
    s_waitcnt lgkmcnt(6)
    global_load_dwordx4 v[140:143], v10, s[42:43] offset:3072 sc1
    v_add_u32 v10, 0x2000, v10
    v_mfma_f32_16x16x32_bf16 v[68:71], a[136:139], a[92:95], v[68:71]
    ds_read_b64_tr_b16 a[140:141], v6 offset:26624
    ds_read_b64_tr_b16 a[142:143], v6 offset:27648
    v_mfma_f32_16x16x32_bf16 v[76:79], a[92:95], a[92:95], v[76:79]
    s_waitcnt lgkmcnt(6)
    v_fma_f32 v111, v111, v110, v110
    v_fma_f32 v119, v119, v110, v110
    v_mfma_f32_16x16x32_bf16 v[64:67], a[148:151], a[104:107], v[64:67]
    ds_read_b64_tr_b16 a[152:153], v5 offset:28672
    ds_read_b64_tr_b16 a[154:155], v5 offset:29696
    v_mfma_f32_16x16x32_bf16 v[72:75], a[104:107], a[104:107], v[72:75]
    s_waitcnt lgkmcnt(6)
    v_rcp_f32 v111, v111
    v_mfma_f32_16x16x32_bf16 v[68:71], a[148:151], a[116:119], v[68:71]
    ds_read_b64_tr_b16 a[164:165], v6 offset:28672
    ds_read_b64_tr_b16 a[166:167], v6 offset:29696
    v_lshl_add_u32 v253, v2, 2, s12
    v_mfma_f32_16x16x32_bf16 v[76:79], a[116:119], a[116:119], v[76:79]
    s_waitcnt lgkmcnt(6)
    global_load_dwordx4 v[144:147], v10, s[42:43] offset:-4096 sc1
    v_rcp_f32 v119, v119
    v_mfma_f32_16x16x32_bf16 v[64:67], a[160:163], a[128:131], v[64:67]
    ds_read_b64_tr_b16 a[176:177], v5 offset:30720
    ds_read_b64_tr_b16 a[178:179], v5 offset:31744
    v_lshl_add_u32 v253, v1, 7, v253
    v_mfma_f32_16x16x32_bf16 v[72:75], a[128:131], a[128:131], v[72:75]
    v_mul_f32 v111, v43, v111
    v_mul_f32 v119, v42, v119
    v_add_u32 v253, 0x10000, v253
    s_waitcnt vmcnt(9)
    s_waitcnt lgkmcnt(6)
    v_mfma_f32_16x16x32_bf16 v[68:71], a[160:163], a[140:143], v[68:71]
    ds_read_b64_tr_b16 a[188:189], v6 offset:30720
    ds_read_b64_tr_b16 a[190:191], v6 offset:31744
    ds_read2_b32 v[254:255], v253 offset0:0 offset1:16
    v_mfma_f32_16x16x32_bf16 v[76:79], a[140:143], a[140:143], v[76:79]
    s_waitcnt lgkmcnt(7)
    v_cvt_pk_bf16_f32 v122, v111, v119
    v_permlane16_swap_b32 v120, v121
    v_mfma_f32_16x16x32_bf16 v[64:67], a[172:175], a[152:155], v[64:67]
    global_load_dwordx4 v[148:151], v10, s[42:43] offset:-3072 sc1
    v_mul_f32 v111, v44, v44
    v_mfma_f32_16x16x32_bf16 v[72:75], a[152:155], a[152:155], v[72:75]
    s_waitcnt lgkmcnt(5)
    v_mul_f32 v119, v45, v45
    v_fma_f32 v111, v111, v117, v116
    v_mfma_f32_16x16x32_bf16 v[68:71], a[172:175], a[164:167], v[68:71]
    v_fma_f32 v119, v119, v117, v116
    v_mul_f32 v111, v44, v111
    v_mfma_f32_16x16x32_bf16 v[76:79], a[164:167], a[164:167], v[76:79]
    s_waitcnt lgkmcnt(3)
    v_mul_f32 v119, v45, v119
    v_exp_f32 v111, v111
    v_mfma_f32_16x16x32_bf16 v[64:67], a[184:187], a[176:179], v[64:67]
    v_exp_f32 v119, v119
    s_waitcnt lgkmcnt(0)
    v_max_u32 v255, v254, v255
    v_mfma_f32_16x16x32_bf16 v[72:75], a[176:179], a[176:179], v[72:75]
    global_load_dwordx4 v[152:155], v10, s[42:43] offset:-2048 sc1
    v_mul_f32 v47, v44, v47
    v_cmp_eq_u32 vcc, -1, v255
    v_mfma_f32_16x16x32_bf16 v[68:71], a[184:187], a[188:191], v[68:71]
    s_cbranch_vccnz L_h2rb
L_h2okb:
    v_mul_f32 v46, v45, v46
    v_fma_f32 v111, v111, v118, v118
    v_mfma_f32_16x16x32_bf16 v[76:79], a[188:191], a[188:191], v[76:79]
    v_fma_f32 v119, v119, v118, v118
    v_rcp_f32 v111, v111
    v_mfma_f32_16x16x32_bf16 v[56:59], a[96:99], a[8:11], v[56:59]
    v_rcp_f32 v119, v119
    v_mfma_f32_16x16x32_bf16 v[60:63], a[96:99], a[20:23], v[60:63]
    v_mul_f32 v111, v47, v111
    v_mul_f32 v119, v46, v119
    v_mfma_f32_16x16x32_bf16 v[56:59], a[108:111], a[32:35], v[56:59]
    global_load_dwordx4 v[156:159], v10, s[42:43] offset:-1024 sc1
    v_cvt_pk_bf16_f32 v123, v111, v119
    v_mfma_f32_16x16x32_bf16 v[60:63], a[108:111], a[44:47], v[60:63]
    s_barrier
    v_add_u32 v5, 0x8000, v5
    v_add_u32 v6, 0x8000, v6
    v_mfma_f32_16x16x32_bf16 v[56:59], a[120:123], a[56:59], v[56:59]
    v_permlane16_swap_b32 v122, v123
    v_mfma_f32_16x16x32_bf16 v[60:63], a[120:123], a[68:71], v[60:63]
    global_store_dwordx4 v9, v[120:123], s[42:43] sc1
    v_cndmask_b32 v124, 0, v72, s[24:25]
    v_cndmask_b32 v125, 0, v76, s[24:25]
    v_cndmask_b32 v124, v124, v73, s[26:27]
    v_mfma_f32_16x16x32_bf16 v[56:59], a[132:135], a[80:83], v[56:59]
    ds_read_b64_tr_b16 v[96:97], v5 offset:0
    ds_read_b64_tr_b16 v[98:99], v5 offset:1024
    v_cndmask_b32 v125, v125, v77, s[26:27]
    v_cndmask_b32 v124, v124, v74, s[28:29]
    v_mfma_f32_16x16x32_bf16 v[60:63], a[132:135], a[92:95], v[60:63]
    ds_read_b64_tr_b16 v[100:101], v6 offset:0
    ds_read_b64_tr_b16 v[102:103], v6 offset:1024
    v_cndmask_b32 v125, v125, v78, s[28:29]
    v_cndmask_b32 v124, v124, v75, s[30:31]
    v_mfma_f32_16x16x32_bf16 v[56:59], a[144:147], a[104:107], v[56:59]
    global_load_dwordx4 v[160:163], v10, s[42:43] offset:0 sc1
    v_cndmask_b32 v125, v125, v79, s[30:31]
    v_mov_b32 v126, v64
    v_mov_b32 v127, v68
    v_mfma_f32_16x16x32_bf16 v[60:63], a[144:147], a[116:119], v[60:63]
    v_permlane16_swap_b32 v124, v125
    v_permlane16_swap_b32 v126, v127
    v_mfma_f32_16x16x32_bf16 v[56:59], a[156:159], a[128:131], v[56:59]
    ds_read_b64_tr_b16 v[80:81], v5 offset:2048
    ds_read_b64_tr_b16 v[82:83], v5 offset:3072
    v_add_f32 v124, v124, v125
    v_mov_b32 v125, v124
    v_mfma_f32_16x16x32_bf16 v[60:63], a[156:159], a[140:143], v[60:63]
    ds_read_b64_tr_b16 v[84:85], v6 offset:2048
    ds_read_b64_tr_b16 v[86:87], v6 offset:3072
    v_permlane32_swap_b32 v124, v125
    v_mfma_f32_16x16x32_bf16 v[56:59], a[168:171], a[152:155], v[56:59]
    v_add_f32 v124, v124, v125
    v_mul_f32 v127, 0x3b000000, v127
    v_mul_f32 v124, 0x3b000000, v124
    v_fma_f32 v124, -v127, v127, v124
    v_mfma_f32_16x16x32_bf16 v[60:63], a[168:171], a[164:167], v[60:63]
    global_load_dwordx4 v[164:167], v10, s[42:43] offset:1024 sc1
    v_max_f32 v124, 0, v124
    v_cvt_pk_bf16_f32 v127, v127, v124
    v_and_b32 v124, s60, v127
    v_mfma_f32_16x16x32_bf16 v[56:59], a[180:183], a[176:179], v[56:59]
    v_add_f32 v124, 0x3727c5ac, v124
    v_cvt_pk_bf16_f32 v125, v124, v124
    v_and_b32 v124, s60, v125
    v_mfma_f32_16x16x32_bf16 v[60:63], a[180:183], a[188:191], v[60:63]
    v_sqrt_f32 v124, v124
    v_lshlrev_b32 v127, 16, v127
    v_cvt_pk_bf16_f32 v125, v124, v124
    v_and_b32 v124, s60, v125
    v_rcp_f32 v125, v124
    v_cvt_pk_bf16_f32 v72, -v127, -v127
    v_mul_f32 v78, v124, v124
    v_mul_f32 v76, 0xc0135761, v125
    v_mul_f32 v125, v125, v125
    v_mov_b32 v73, v72
    v_mul_f32 v125, 0x3d372713, v125
    v_mov_b32 v74, v72
    v_mul_f32 v77, v76, v125
    v_mov_b32 v75, v72
    v_fma_f32 v76, v127, 0, v76
    s_mov_b32 exec_lo, 0
    ds_write_b128 v8, v[72:75] offset:1024
    ds_write_b128 v8, v[76:79] offset:1040
    s_mov_b32 exec_lo, -1
    v_add_u32 v9, 180224, v9
    s_waitcnt lgkmcnt(8)
    v_mfma_f32_16x16x32_bf16 v[32:35], a[0:3], v[96:99], 0
    ds_read_b64_tr_b16 v[88:89], v5 offset:4096
    ds_read_b64_tr_b16 v[90:91], v5 offset:5120
    v_mfma_f32_16x16x32_bf16 v[40:43], a[4:7], v[96:99], 0
    s_add_u32 m0, s12, 98304
    s_nop 0
    global_load_lds_dwordx4 v4, s[42:43] offset:0 sc1
    s_waitcnt lgkmcnt(2)
    s_barrier
    v_mfma_f32_16x16x32_bf16 v[48:51], v[96:99], v[96:99], 0
    ds_read_b128 v[104:107], v7 offset:1024
    ds_read_b128 v[112:115], v7 offset:1536
    v_mfma_f32_16x16x32_bf16 v[36:39], a[0:3], v[100:103], 0
    ds_read_b64_tr_b16 v[92:93], v6 offset:4096
    ds_read_b64_tr_b16 v[94:95], v6 offset:5120
    v_mfma_f32_16x16x32_bf16 v[44:47], a[4:7], v[100:103], 0
    global_load_lds_dwordx4 v4, s[42:43] offset:1024 sc1
    ds_read_b128 v[108:111], v7 offset:1040
    v_mfma_f32_16x16x32_bf16 v[52:55], v[100:103], v[100:103], 0
    ds_read_b128 v[116:119], v7 offset:1552
    v_mfma_f32_16x16x32_bf16 v[32:35], a[12:15], v[80:83], v[32:35]
    ds_read_b64_tr_b16 v[96:97], v5 offset:6144
    ds_read_b64_tr_b16 v[98:99], v5 offset:7168
    v_mfma_f32_16x16x32_bf16 v[40:43], a[16:19], v[80:83], v[40:43]
    global_load_lds_dwordx4 v4, s[42:43] offset:2048 sc1
    v_mfma_f32_16x16x32_bf16 v[48:51], v[80:83], v[80:83], v[48:51]
    v_mfma_f32_16x16x32_bf16 v[36:39], a[12:15], v[84:87], v[36:39]
    s_waitcnt lgkmcnt(7)
    ds_read_b64_tr_b16 v[100:101], v6 offset:6144
    ds_read_b64_tr_b16 v[102:103], v6 offset:7168
    v_mfma_f32_16x16x32_bf16 v[56:59], v[20:23], v[104:107], v[56:59]
    s_waitcnt lgkmcnt(8)
    v_mfma_f32_16x16x32_bf16 v[60:63], v[20:23], v[112:115], v[60:63]
    global_load_lds_dwordx4 v4, s[42:43] offset:3072 sc1
    v_add_u32 v4, 4096, v4
    v_mfma_f32_16x16x32_bf16 v[44:47], a[16:19], v[84:87], v[44:47]
    s_add_u32 m0, s12, 102400
    v_mfma_f32_16x16x32_bf16 v[52:55], v[84:87], v[84:87], v[52:55]
    global_load_lds_dwordx4 v4, s[42:43] offset:0 sc1
    s_waitcnt lgkmcnt(4)
    v_cmp_u_f32 vcc, v108, v116
    v_mfma_f32_16x16x32_bf16 v[32:35], a[24:27], v[88:91], v[32:35]
    ds_read_b64_tr_b16 v[80:81], v5 offset:8192
    ds_read_b64_tr_b16 v[82:83], v5 offset:9216
    v_mfma_f32_16x16x32_bf16 v[40:43], a[28:31], v[88:91], v[40:43]
    global_load_lds_dwordx4 v4, s[42:43] offset:1024 sc1
    s_or_b64 s[62:63], s[62:63], vcc
    v_mfma_f32_16x16x32_bf16 v[48:51], v[88:91], v[88:91], v[48:51]
    v_mul_f32 v111, v56, v56
    v_mul_f32 v119, v57, v57
    v_mfma_f32_16x16x32_bf16 v[36:39], a[24:27], v[92:95], v[36:39]
    ds_read_b64_tr_b16 v[84:85], v6 offset:8192
    ds_read_b64_tr_b16 v[86:87], v6 offset:9216
    v_mfma_f32_16x16x32_bf16 v[44:47], a[28:31], v[92:95], v[44:47]
    global_load_lds_dwordx4 v4, s[42:43] offset:2048 sc1
    v_fma_f32 v111, v111, v109, v108
    v_mfma_f32_16x16x32_bf16 v[52:55], v[92:95], v[92:95], v[52:55]
    s_waitcnt lgkmcnt(6)
    v_fma_f32 v119, v119, v109, v108
    v_mul_f32 v111, v56, v111
    v_mfma_f32_16x16x32_bf16 v[32:35], a[36:39], v[96:99], v[32:35]
    ds_read_b64_tr_b16 v[88:89], v5 offset:10240
    ds_read_b64_tr_b16 v[90:91], v5 offset:11264
    v_mfma_f32_16x16x32_bf16 v[40:43], a[40:43], v[96:99], v[40:43]
    global_load_lds_dwordx4 v4, s[42:43] offset:3072 sc1
    v_add_u32 v4, 520192, v4
    v_mfma_f32_16x16x32_bf16 v[48:51], v[96:99], v[96:99], v[48:51]
    s_waitcnt lgkmcnt(6)
    global_load_dwordx4 v[168:171], v10, s[42:43] offset:2048 sc1
    v_mul_f32 v119, v57, v119
    v_mfma_f32_16x16x32_bf16 v[36:39], a[36:39], v[100:103], v[36:39]
    ds_read_b64_tr_b16 v[92:93], v6 offset:10240
    ds_read_b64_tr_b16 v[94:95], v6 offset:11264
    v_mfma_f32_16x16x32_bf16 v[44:47], a[40:43], v[100:103], v[44:47]
    v_exp_f32 v111, v111
    v_mfma_f32_16x16x32_bf16 v[52:55], v[100:103], v[100:103], v[52:55]
    s_waitcnt lgkmcnt(6)
    v_exp_f32 v119, v119
    v_mfma_f32_16x16x32_bf16 v[32:35], a[48:51], v[80:83], v[32:35]
    ds_read_b64_tr_b16 v[96:97], v5 offset:12288
    ds_read_b64_tr_b16 v[98:99], v5 offset:13312
    v_mfma_f32_16x16x32_bf16 v[40:43], a[52:55], v[80:83], v[40:43]
    global_load_dwordx4 v[172:175], v10, s[42:43] offset:3072 sc1
    v_add_u32 v10, 0x2000, v10
    v_mfma_f32_16x16x32_bf16 v[48:51], v[80:83], v[80:83], v[48:51]
    s_waitcnt lgkmcnt(6)
    v_mul_f32 v59, v56, v59
    v_mul_f32 v58, v57, v58
    v_mfma_f32_16x16x32_bf16 v[36:39], a[48:51], v[84:87], v[36:39]
    ds_read_b64_tr_b16 v[100:101], v6 offset:12288
    ds_read_b64_tr_b16 v[102:103], v6 offset:13312
    v_mfma_f32_16x16x32_bf16 v[44:47], a[52:55], v[84:87], v[44:47]
    v_fma_f32 v111, v111, v110, v110
    v_fma_f32 v119, v119, v110, v110
    v_mfma_f32_16x16x32_bf16 v[52:55], v[84:87], v[84:87], v[52:55]
    s_waitcnt lgkmcnt(6)
    v_rcp_f32 v111, v111
    v_mfma_f32_16x16x32_bf16 v[32:35], a[60:63], v[88:91], v[32:35]
    ds_read_b64_tr_b16 v[80:81], v5 offset:14336
    ds_read_b64_tr_b16 v[82:83], v5 offset:15360
    v_mfma_f32_16x16x32_bf16 v[40:43], a[64:67], v[88:91], v[40:43]
    global_load_dwordx4 v[176:179], v10, s[42:43] offset:-4096 sc1
    v_rcp_f32 v119, v119
    v_mfma_f32_16x16x32_bf16 v[48:51], v[88:91], v[88:91], v[48:51]
    s_waitcnt lgkmcnt(6)
    v_mul_f32 v111, v59, v111
    v_mul_f32 v119, v58, v119
    v_mfma_f32_16x16x32_bf16 v[36:39], a[60:63], v[92:95], v[36:39]
    ds_read_b64_tr_b16 v[84:85], v6 offset:14336
    ds_read_b64_tr_b16 v[86:87], v6 offset:15360
    v_mfma_f32_16x16x32_bf16 v[44:47], a[64:67], v[92:95], v[44:47]
    v_cvt_pk_bf16_f32 v120, v111, v119
    v_mfma_f32_16x16x32_bf16 v[64:67], v[24:27], v[104:107], v[64:67]
    v_mfma_f32_16x16x32_bf16 v[68:71], v[24:27], v[112:115], v[68:71]
    v_mul_f32 v111, v60, v60
    v_mul_f32 v119, v61, v61
    v_mfma_f32_16x16x32_bf16 v[52:55], v[92:95], v[92:95], v[52:55]
    s_waitcnt lgkmcnt(6)
    v_fma_f32 v111, v111, v117, v116
    v_fma_f32 v119, v119, v117, v116
    v_mfma_f32_16x16x32_bf16 v[32:35], a[72:75], v[96:99], v[32:35]
    ds_read_b64_tr_b16 a[8:9], v5 offset:16384
    ds_read_b64_tr_b16 a[10:11], v5 offset:17408
    v_mfma_f32_16x16x32_bf16 v[40:43], a[76:79], v[96:99], v[40:43]
    global_load_dwordx4 v[180:183], v10, s[42:43] offset:-3072 sc1
    v_mul_f32 v111, v60, v111
    v_mfma_f32_16x16x32_bf16 v[48:51], v[96:99], v[96:99], v[48:51]
    s_waitcnt lgkmcnt(6)
    v_mul_f32 v119, v61, v119
    v_exp_f32 v111, v111
    v_mfma_f32_16x16x32_bf16 v[36:39], a[72:75], v[100:103], v[36:39]
    ds_read_b64_tr_b16 a[20:21], v6 offset:16384
    ds_read_b64_tr_b16 a[22:23], v6 offset:17408
    v_mfma_f32_16x16x32_bf16 v[44:47], a[76:79], v[100:103], v[44:47]
    v_exp_f32 v119, v119
    v_mfma_f32_16x16x32_bf16 v[52:55], v[100:103], v[100:103], v[52:55]
    s_waitcnt lgkmcnt(6)
    v_mul_f32 v63, v60, v63
    v_mul_f32 v62, v61, v62
    v_mfma_f32_16x16x32_bf16 v[32:35], a[84:87], v[80:83], v[32:35]
    ds_read_b64_tr_b16 a[32:33], v5 offset:18432
    ds_read_b64_tr_b16 a[34:35], v5 offset:19456
    v_mfma_f32_16x16x32_bf16 v[40:43], a[88:91], v[80:83], v[40:43]
    global_load_dwordx4 v[184:187], v10, s[42:43] offset:-2048 sc1
    v_fma_f32 v111, v111, v118, v118
    v_mfma_f32_16x16x32_bf16 v[48:51], v[80:83], v[80:83], v[48:51]
    s_waitcnt lgkmcnt(6)
    v_fma_f32 v119, v119, v118, v118
    v_rcp_f32 v111, v111
    v_mfma_f32_16x16x32_bf16 v[36:39], a[84:87], v[84:87], v[36:39]
    ds_read_b64_tr_b16 a[44:45], v6 offset:18432
    ds_read_b64_tr_b16 a[46:47], v6 offset:19456
    v_mfma_f32_16x16x32_bf16 v[44:47], a[88:91], v[84:87], v[44:47]
    v_rcp_f32 v119, v119
    v_mfma_f32_16x16x32_bf16 v[52:55], v[84:87], v[84:87], v[52:55]
    s_waitcnt lgkmcnt(6)
    v_mul_f32 v111, v63, v111
    v_mul_f32 v119, v62, v119
    v_mfma_f32_16x16x32_bf16 v[40:43], a[100:103], a[8:11], v[40:43]
    ds_read_b64_tr_b16 a[56:57], v5 offset:20480
    ds_read_b64_tr_b16 a[58:59], v5 offset:21504
    v_mfma_f32_16x16x32_bf16 v[48:51], a[8:11], a[8:11], v[48:51]
    s_waitcnt lgkmcnt(6)
    global_load_dwordx4 v[188:191], v10, s[42:43] offset:-1024 sc1
    v_cvt_pk_bf16_f32 v121, v111, v119
    v_mfma_f32_16x16x32_bf16 v[44:47], a[100:103], a[20:23], v[44:47]
    ds_read_b64_tr_b16 a[68:69], v6 offset:20480
    ds_read_b64_tr_b16 a[70:71], v6 offset:21504
    v_mfma_f32_16x16x32_bf16 v[52:55], a[20:23], a[20:23], v[52:55]
    s_waitcnt lgkmcnt(6)
    v_mul_f32 v111, v64, v64
    v_mul_f32 v119, v65, v65
    v_mfma_f32_16x16x32_bf16 v[40:43], a[112:115], a[32:35], v[40:43]
    ds_read_b64_tr_b16 a[80:81], v5 offset:22528
    ds_read_b64_tr_b16 a[82:83], v5 offset:23552
    v_mfma_f32_16x16x32_bf16 v[48:51], a[32:35], a[32:35], v[48:51]
    s_waitcnt lgkmcnt(6)
    v_fma_f32 v111, v111, v109, v108
    v_fma_f32 v119, v119, v109, v108
    v_mfma_f32_16x16x32_bf16 v[44:47], a[112:115], a[44:47], v[44:47]
    ds_read_b64_tr_b16 a[92:93], v6 offset:22528
    ds_read_b64_tr_b16 a[94:95], v6 offset:23552
    v_mfma_f32_16x16x32_bf16 v[52:55], a[44:47], a[44:47], v[52:55]
    s_waitcnt lgkmcnt(6)
    global_load_dwordx4 v[192:195], v10, s[42:43] offset:0 sc1
    v_mul_f32 v111, v64, v111
    v_mfma_f32_16x16x32_bf16 v[40:43], a[124:127], a[56:59], v[40:43]
    ds_read_b64_tr_b16 a[104:105], v5 offset:24576
    ds_read_b64_tr_b16 a[106:107], v5 offset:25600
    v_mfma_f32_16x16x32_bf16 v[48:51], a[56:59], a[56:59], v[48:51]
    s_waitcnt lgkmcnt(6)
    v_mul_f32 v119, v65, v119
    v_exp_f32 v111, v111
    v_mfma_f32_16x16x32_bf16 v[44:47], a[124:127], a[68:71], v[44:47]
    ds_read_b64_tr_b16 a[116:117], v6 offset:24576
    ds_read_b64_tr_b16 a[118:119], v6 offset:25600
    v_mfma_f32_16x16x32_bf16 v[52:55], a[68:71], a[68:71], v[52:55]
    s_waitcnt lgkmcnt(6)
    v_exp_f32 v119, v119
    v_mfma_f32_16x16x32_bf16 v[40:43], a[136:139], a[80:83], v[40:43]
    ds_read_b64_tr_b16 a[128:129], v5 offset:26624
    ds_read_b64_tr_b16 a[130:131], v5 offset:27648
    v_mfma_f32_16x16x32_bf16 v[48:51], a[80:83], a[80:83], v[48:51]
    s_waitcnt lgkmcnt(6)
    global_load_dwordx4 v[196:199], v10, s[42:43] offset:1024 sc1
    v_mul_f32 v67, v64, v67
    v_mfma_f32_16x16x32_bf16 v[44:47], a[136:139], a[92:95], v[44:47]
    ds_read_b64_tr_b16 a[140:141], v6 offset:26624
    ds_read_b64_tr_b16 a[142:143], v6 offset:27648
    v_mfma_f32_16x16x32_bf16 v[52:55], a[92:95], a[92:95], v[52:55]
    s_waitcnt lgkmcnt(6)
    v_mul_f32 v66, v65, v66
    v_fma_f32 v111, v111, v110, v110
    v_mfma_f32_16x16x32_bf16 v[40:43], a[148:151], a[104:107], v[40:43]
    ds_read_b64_tr_b16 a[152:153], v5 offset:28672
    ds_read_b64_tr_b16 a[154:155], v5 offset:29696
    v_mfma_f32_16x16x32_bf16 v[48:51], a[104:107], a[104:107], v[48:51]
    s_waitcnt lgkmcnt(6)
    v_fma_f32 v119, v119, v110, v110
    v_rcp_f32 v111, v111
    v_mfma_f32_16x16x32_bf16 v[44:47], a[148:151], a[116:119], v[44:47]
    ds_read_b64_tr_b16 a[164:165], v6 offset:28672
    ds_read_b64_tr_b16 a[166:167], v6 offset:29696
    v_mfma_f32_16x16x32_bf16 v[52:55], a[116:119], a[116:119], v[52:55]
    s_waitcnt lgkmcnt(6)
    global_load_dwordx4 v[200:203], v10, s[42:43] offset:2048 sc1
    v_rcp_f32 v119, v119
    v_mfma_f32_16x16x32_bf16 v[40:43], a[160:163], a[128:131], v[40:43]
    ds_read_b64_tr_b16 a[176:177], v5 offset:30720
    ds_read_b64_tr_b16 a[178:179], v5 offset:31744
    v_mfma_f32_16x16x32_bf16 v[48:51], a[128:131], a[128:131], v[48:51]
    s_waitcnt lgkmcnt(6)
    v_mul_f32 v111, v67, v111
    v_mul_f32 v119, v66, v119
    v_mfma_f32_16x16x32_bf16 v[44:47], a[160:163], a[140:143], v[44:47]
    ds_read_b64_tr_b16 a[188:189], v6 offset:30720
    ds_read_b64_tr_b16 a[190:191], v6 offset:31744
    v_mfma_f32_16x16x32_bf16 v[52:55], a[140:143], a[140:143], v[52:55]
    s_waitcnt lgkmcnt(6)
    v_cvt_pk_bf16_f32 v122, v111, v119
    v_permlane16_swap_b32 v120, v121
    v_mfma_f32_16x16x32_bf16 v[40:43], a[172:175], a[152:155], v[40:43]
    global_load_dwordx4 v[204:207], v10, s[42:43] offset:3072 sc1
    v_add_u32 v10, 0x2000, v10
    v_mfma_f32_16x16x32_bf16 v[48:51], a[152:155], a[152:155], v[48:51]
    s_waitcnt lgkmcnt(4)
    v_mul_f32 v111, v68, v68
    v_mul_f32 v119, v69, v69
    v_mfma_f32_16x16x32_bf16 v[44:47], a[172:175], a[164:167], v[44:47]
    v_fma_f32 v111, v111, v117, v116
    v_fma_f32 v119, v119, v117, v116
    v_mfma_f32_16x16x32_bf16 v[52:55], a[164:167], a[164:167], v[52:55]
    s_waitcnt lgkmcnt(2)
    v_mul_f32 v111, v68, v111
    v_mul_f32 v119, v69, v119
    v_mfma_f32_16x16x32_bf16 v[40:43], a[184:187], a[176:179], v[40:43]
    v_exp_f32 v111, v111
    v_mfma_f32_16x16x32_bf16 v[48:51], a[176:179], a[176:179], v[48:51]
    global_load_dwordx4 v[208:211], v10, s[42:43] offset:-4096 sc1
    v_exp_f32 v119, v119
    s_waitcnt lgkmcnt(0)
    v_mfma_f32_16x16x32_bf16 v[44:47], a[184:187], a[188:191], v[44:47]
    v_mul_f32 v71, v68, v71
    v_mul_f32 v70, v69, v70
    v_mfma_f32_16x16x32_bf16 v[52:55], a[188:191], a[188:191], v[52:55]
    v_fma_f32 v111, v111, v118, v118
    v_fma_f32 v119, v119, v118, v118
    v_mfma_f32_16x16x32_bf16 v[32:35], a[96:99], a[8:11], v[32:35]
    v_rcp_f32 v111, v111
    v_mfma_f32_16x16x32_bf16 v[36:39], a[96:99], a[20:23], v[36:39]
    v_rcp_f32 v119, v119
    v_mfma_f32_16x16x32_bf16 v[32:35], a[108:111], a[32:35], v[32:35]
    global_load_dwordx4 v[212:215], v10, s[42:43] offset:-3072 sc1
    v_mul_f32 v111, v71, v111
    v_mfma_f32_16x16x32_bf16 v[36:39], a[108:111], a[44:47], v[36:39]
    s_waitcnt vmcnt(12)
    s_barrier
    v_add_u32 v5, 0x8000, v5
    v_add_u32 v6, 0x8000, v6
    v_mfma_f32_16x16x32_bf16 v[32:35], a[120:123], a[56:59], v[32:35]
    v_mul_f32 v119, v70, v119
    v_cvt_pk_bf16_f32 v123, v111, v119
    v_mfma_f32_16x16x32_bf16 v[36:39], a[120:123], a[68:71], v[36:39]
    s_nop 0
    v_permlane16_swap_b32 v122, v123
    v_mfma_f32_16x16x32_bf16 v[32:35], a[132:135], a[80:83], v[32:35]
    ds_read_b64_tr_b16 v[80:81], v5 offset:0
    ds_read_b64_tr_b16 v[82:83], v5 offset:1024
    v_mfma_f32_16x16x32_bf16 v[36:39], a[132:135], a[92:95], v[36:39]
    ds_read_b64_tr_b16 v[84:85], v6 offset:0
    ds_read_b64_tr_b16 v[86:87], v6 offset:1024
    v_mfma_f32_16x16x32_bf16 v[32:35], a[144:147], a[104:107], v[32:35]
    global_load_dwordx4 v[216:219], v10, s[42:43] offset:-2048 sc1
    global_store_dwordx4 v9, v[120:123], s[42:43] sc1
    v_cndmask_b32 v124, 0, v48, s[24:25]
    v_cndmask_b32 v125, 0, v52, s[24:25]
    v_mfma_f32_16x16x32_bf16 v[36:39], a[144:147], a[116:119], v[36:39]
    v_cndmask_b32 v124, v124, v49, s[26:27]
    v_cndmask_b32 v125, v125, v53, s[26:27]
    v_cndmask_b32 v124, v124, v50, s[28:29]
    v_cndmask_b32 v125, v125, v54, s[28:29]
    v_mfma_f32_16x16x32_bf16 v[32:35], a[156:159], a[128:131], v[32:35]
    ds_read_b64_tr_b16 v[88:89], v5 offset:2048
    ds_read_b64_tr_b16 v[90:91], v5 offset:3072
    v_cndmask_b32 v124, v124, v51, s[30:31]
    v_cndmask_b32 v125, v125, v55, s[30:31]
    v_mfma_f32_16x16x32_bf16 v[36:39], a[156:159], a[140:143], v[36:39]
    ds_read_b64_tr_b16 v[92:93], v6 offset:2048
    ds_read_b64_tr_b16 v[94:95], v6 offset:3072
    v_mov_b32 v126, v40
    v_mov_b32 v127, v44
    v_mfma_f32_16x16x32_bf16 v[32:35], a[168:171], a[152:155], v[32:35]
    v_permlane16_swap_b32 v124, v125
    v_permlane16_swap_b32 v126, v127
    v_mfma_f32_16x16x32_bf16 v[36:39], a[168:171], a[164:167], v[36:39]
    global_load_dwordx4 v[220:223], v10, s[42:43] offset:-1024 sc1
    v_add_f32 v124, v124, v125
    v_mov_b32 v125, v124
    v_mfma_f32_16x16x32_bf16 v[32:35], a[180:183], a[176:179], v[32:35]
    s_nop 0
    v_permlane32_swap_b32 v124, v125
    v_add_f32 v124, v124, v125
    v_mul_f32 v127, 0x3b000000, v127
    v_mfma_f32_16x16x32_bf16 v[36:39], a[180:183], a[188:191], v[36:39]
    v_mul_f32 v124, 0x3b000000, v124
    v_fma_f32 v124, -v127, v127, v124
    v_max_f32 v124, 0, v124
    v_cvt_pk_bf16_f32 v127, v127, v124
    v_and_b32 v124, s60, v127
    v_add_f32 v124, 0x3727c5ac, v124
    v_cvt_pk_bf16_f32 v125, v124, v124
    v_and_b32 v124, s60, v125
    v_sqrt_f32 v124, v124
    v_lshlrev_b32 v127, 16, v127
    v_cvt_pk_bf16_f32 v125, v124, v124
    v_and_b32 v124, s60, v125
    v_rcp_f32 v125, v124
    v_cvt_pk_bf16_f32 v48, -v127, -v127
    v_mul_f32 v54, v124, v124
    v_mul_f32 v52, 0xc0135761, v125
    v_mul_f32 v125, v125, v125
    v_mov_b32 v49, v48
    v_mul_f32 v125, 0x3d372713, v125
    v_mov_b32 v50, v48
    v_mul_f32 v53, v52, v125
    v_mov_b32 v51, v48
    v_fma_f32 v52, v127, 0, v52
    s_mov_b32 exec_lo, 0
    ds_write_b128 v8, v[48:51] offset:0
    ds_write_b128 v8, v[52:55] offset:16
    s_mov_b32 exec_lo, -1
    v_add_u32 v9, 180224, v9
    s_waitcnt lgkmcnt(8)
    v_mfma_f32_16x16x32_bf16 v[56:59], a[0:3], v[80:83], 0
    ds_read_b64_tr_b16 v[96:97], v5 offset:4096
    ds_read_b64_tr_b16 v[98:99], v5 offset:5120
    v_mfma_f32_16x16x32_bf16 v[64:67], a[4:7], v[80:83], 0
    s_waitcnt lgkmcnt(2)
    s_barrier
    ds_read_b128 v[104:107], v7 offset:0
    ds_read_b128 v[112:115], v7 offset:512
    v_mfma_f32_16x16x32_bf16 v[72:75], v[80:83], v[80:83], 0
    ds_read_b128 v[108:111], v7 offset:16
    ds_read_b128 v[116:119], v7 offset:528
    v_mfma_f32_16x16x32_bf16 v[60:63], a[0:3], v[84:87], 0
    ds_read_b64_tr_b16 v[100:101], v6 offset:4096
    ds_read_b64_tr_b16 v[102:103], v6 offset:5120
    v_mfma_f32_16x16x32_bf16 v[68:71], a[4:7], v[84:87], 0
    v_lshl_add_u32 v4, v1, 4, s15
    s_add_u32 m0, s14, 0
    v_mfma_f32_16x16x32_bf16 v[76:79], v[84:87], v[84:87], 0
    global_load_lds_dwordx4 v4, s[42:43] sc1
    v_add_u32 v4, 0x80000, v4
    v_mfma_f32_16x16x32_bf16 v[56:59], a[12:15], v[88:91], v[56:59]
    s_waitcnt lgkmcnt(5)
    ds_read_b64_tr_b16 v[80:81], v5 offset:6144
    ds_read_b64_tr_b16 v[82:83], v5 offset:7168
    v_mfma_f32_16x16x32_bf16 v[32:35], v[20:23], v[104:107], v[32:35]
    s_waitcnt lgkmcnt(6)
    v_mfma_f32_16x16x32_bf16 v[36:39], v[20:23], v[112:115], v[36:39]
    s_add_u32 m0, s14, 1024
    v_mfma_f32_16x16x32_bf16 v[64:67], a[16:19], v[88:91], v[64:67]
    global_load_lds_dwordx4 v4, s[42:43] sc1
    v_add_u32 v4, 0x80000, v4
    v_mfma_f32_16x16x32_bf16 v[72:75], v[88:91], v[88:91], v[72:75]
    s_add_u32 m0, s14, 2048
    s_waitcnt lgkmcnt(4)
    v_cmp_u_f32 vcc, v108, v116
    s_or_b64 s[62:63], s[62:63], vcc
    v_mfma_f32_16x16x32_bf16 v[60:63], a[12:15], v[92:95], v[60:63]
    ds_read_b64_tr_b16 v[84:85], v6 offset:6144
    ds_read_b64_tr_b16 v[86:87], v6 offset:7168
    v_mfma_f32_16x16x32_bf16 v[68:71], a[16:19], v[92:95], v[68:71]
    global_load_lds_dwordx4 v4, s[42:43] sc1
    v_add_u32 v4, 0x80000, v4
    v_mfma_f32_16x16x32_bf16 v[76:79], v[92:95], v[92:95], v[76:79]
    s_add_u32 m0, s14, 3072
    v_mul_f32 v111, v32, v32
    v_mul_f32 v119, v33, v33
    v_mfma_f32_16x16x32_bf16 v[56:59], a[24:27], v[96:99], v[56:59]
    ds_read_b64_tr_b16 v[88:89], v5 offset:8192
    ds_read_b64_tr_b16 v[90:91], v5 offset:9216
    v_mfma_f32_16x16x32_bf16 v[64:67], a[28:31], v[96:99], v[64:67]
    global_load_lds_dwordx4 v4, s[42:43] sc1
    global_load_dwordx4 v[224:227], v10, s[42:43] offset:0 sc1
    v_mfma_f32_16x16x32_bf16 v[72:75], v[96:99], v[96:99], v[72:75]
    s_waitcnt lgkmcnt(6)
    v_fma_f32 v111, v111, v109, v108
    v_fma_f32 v119, v119, v109, v108
    v_mfma_f32_16x16x32_bf16 v[60:63], a[24:27], v[100:103], v[60:63]
    ds_read_b64_tr_b16 v[92:93], v6 offset:8192
    ds_read_b64_tr_b16 v[94:95], v6 offset:9216
    v_mfma_f32_16x16x32_bf16 v[68:71], a[28:31], v[100:103], v[68:71]
    v_mul_f32 v111, v32, v111
    v_mul_f32 v119, v33, v119
    v_mfma_f32_16x16x32_bf16 v[76:79], v[100:103], v[100:103], v[76:79]
    s_waitcnt lgkmcnt(6)
    v_exp_f32 v111, v111
    v_mfma_f32_16x16x32_bf16 v[56:59], a[36:39], v[80:83], v[56:59]
    ds_read_b64_tr_b16 v[96:97], v5 offset:10240
    ds_read_b64_tr_b16 v[98:99], v5 offset:11264
    v_mfma_f32_16x16x32_bf16 v[64:67], a[40:43], v[80:83], v[64:67]
    global_load_dwordx4 v[228:231], v10, s[42:43] offset:1024 sc1
    v_exp_f32 v119, v119
    v_mfma_f32_16x16x32_bf16 v[72:75], v[80:83], v[80:83], v[72:75]
    s_waitcnt lgkmcnt(6)
    v_mul_f32 v35, v32, v35
    v_mul_f32 v34, v33, v34
    v_mfma_f32_16x16x32_bf16 v[60:63], a[36:39], v[84:87], v[60:63]
    ds_read_b64_tr_b16 v[100:101], v6 offset:10240
    ds_read_b64_tr_b16 v[102:103], v6 offset:11264
    v_mfma_f32_16x16x32_bf16 v[68:71], a[40:43], v[84:87], v[68:71]
    v_fma_f32 v111, v111, v110, v110
    v_fma_f32 v119, v119, v110, v110
    v_mfma_f32_16x16x32_bf16 v[76:79], v[84:87], v[84:87], v[76:79]
    s_waitcnt lgkmcnt(6)
    v_rcp_f32 v111, v111
    v_mfma_f32_16x16x32_bf16 v[56:59], a[48:51], v[88:91], v[56:59]
    ds_read_b64_tr_b16 v[80:81], v5 offset:12288
    ds_read_b64_tr_b16 v[82:83], v5 offset:13312
    v_mfma_f32_16x16x32_bf16 v[64:67], a[52:55], v[88:91], v[64:67]
    global_load_dwordx4 v[232:235], v10, s[42:43] offset:2048 sc1
    global_load_dwordx4 a[0:3], v11, s[16:17] offset:-4096 sc1
    v_mfma_f32_16x16x32_bf16 v[72:75], v[88:91], v[88:91], v[72:75]
    s_waitcnt lgkmcnt(6)
    v_rcp_f32 v119, v119
    v_mfma_f32_16x16x32_bf16 v[60:63], a[48:51], v[92:95], v[60:63]
    ds_read_b64_tr_b16 v[84:85], v6 offset:12288
    ds_read_b64_tr_b16 v[86:87], v6 offset:13312
    v_mfma_f32_16x16x32_bf16 v[68:71], a[52:55], v[92:95], v[68:71]
    v_mul_f32 v111, v35, v111
    v_mul_f32 v119, v34, v119
    v_mfma_f32_16x16x32_bf16 v[76:79], v[92:95], v[92:95], v[76:79]
    global_load_dwordx4 a[4:7], v11, s[16:17] offset:-3072 sc1
    v_cvt_pk_bf16_f32 v120, v111, v119
    v_mfma_f32_16x16x32_bf16 v[40:43], v[24:27], v[104:107], v[40:43]
    v_mfma_f32_16x16x32_bf16 v[44:47], v[24:27], v[112:115], v[44:47]
    s_waitcnt lgkmcnt(6)
    v_mul_f32 v111, v36, v36
    v_mul_f32 v119, v37, v37
    v_mfma_f32_16x16x32_bf16 v[56:59], a[60:63], v[96:99], v[56:59]
    ds_read_b64_tr_b16 v[88:89], v5 offset:14336
    ds_read_b64_tr_b16 v[90:91], v5 offset:15360
    v_mfma_f32_16x16x32_bf16 v[64:67], a[64:67], v[96:99], v[64:67]
    global_load_dwordx4 v[236:239], v10, s[42:43] offset:3072 sc1
    v_add_u32 v10, 0x2000, v10
    v_mfma_f32_16x16x32_bf16 v[72:75], v[96:99], v[96:99], v[72:75]
    s_waitcnt lgkmcnt(6)
    v_fma_f32 v111, v111, v117, v116
    v_fma_f32 v119, v119, v117, v116
    v_mfma_f32_16x16x32_bf16 v[60:63], a[60:63], v[100:103], v[60:63]
    ds_read_b64_tr_b16 v[92:93], v6 offset:14336
    ds_read_b64_tr_b16 v[94:95], v6 offset:15360
    v_mfma_f32_16x16x32_bf16 v[68:71], a[64:67], v[100:103], v[68:71]
    global_load_dwordx4 a[12:15], v11, s[16:17] offset:-2048 sc1
    v_mul_f32 v111, v36, v111
    v_mfma_f32_16x16x32_bf16 v[76:79], v[100:103], v[100:103], v[76:79]
    s_waitcnt lgkmcnt(6)
    v_mul_f32 v119, v37, v119
    v_exp_f32 v111, v111
    v_mfma_f32_16x16x32_bf16 v[56:59], a[72:75], v[80:83], v[56:59]
    ds_read_b64_tr_b16 a[8:9], v5 offset:16384
    ds_read_b64_tr_b16 a[10:11], v5 offset:17408
    v_mfma_f32_16x16x32_bf16 v[64:67], a[76:79], v[80:83], v[64:67]
    v_exp_f32 v119, v119
    v_mfma_f32_16x16x32_bf16 v[72:75], v[80:83], v[80:83], v[72:75]
    s_waitcnt lgkmcnt(6)
    global_load_dwordx4 a[16:19], v11, s[16:17] offset:-1024 sc1
    v_mul_f32 v39, v36, v39
    v_mfma_f32_16x16x32_bf16 v[60:63], a[72:75], v[84:87], v[60:63]
    ds_read_b64_tr_b16 a[20:21], v6 offset:16384
    ds_read_b64_tr_b16 a[22:23], v6 offset:17408
    v_mfma_f32_16x16x32_bf16 v[68:71], a[76:79], v[84:87], v[68:71]
    v_mul_f32 v38, v37, v38
    v_fma_f32 v111, v111, v118, v118
    v_mfma_f32_16x16x32_bf16 v[76:79], v[84:87], v[84:87], v[76:79]
    s_waitcnt lgkmcnt(6)
    v_fma_f32 v119, v119, v118, v118
    v_rcp_f32 v111, v111
    v_mfma_f32_16x16x32_bf16 v[56:59], a[84:87], v[88:91], v[56:59]
    ds_read_b64_tr_b16 a[32:33], v5 offset:18432
    ds_read_b64_tr_b16 a[34:35], v5 offset:19456
    v_mfma_f32_16x16x32_bf16 v[64:67], a[88:91], v[88:91], v[64:67]
    global_load_dwordx4 a[24:27], v11, s[16:17] offset:0 sc1
    v_rcp_f32 v119, v119
    v_mfma_f32_16x16x32_bf16 v[72:75], v[88:91], v[88:91], v[72:75]
    s_waitcnt lgkmcnt(6)
    v_mul_f32 v111, v39, v111
    v_mul_f32 v119, v38, v119
    v_mfma_f32_16x16x32_bf16 v[60:63], a[84:87], v[92:95], v[60:63]
    ds_read_b64_tr_b16 a[44:45], v6 offset:18432
    ds_read_b64_tr_b16 a[46:47], v6 offset:19456
    v_mfma_f32_16x16x32_bf16 v[68:71], a[88:91], v[92:95], v[68:71]
    v_cvt_pk_bf16_f32 v121, v111, v119
    v_mul_f32 v111, v40, v40
    v_mfma_f32_16x16x32_bf16 v[76:79], v[92:95], v[92:95], v[76:79]
    s_waitcnt lgkmcnt(6)
    global_load_dwordx4 a[28:31], v11, s[16:17] offset:1024 sc1
    v_mul_f32 v119, v41, v41
    v_mfma_f32_16x16x32_bf16 v[64:67], a[100:103], a[8:11], v[64:67]
    ds_read_b64_tr_b16 a[56:57], v5 offset:20480
    ds_read_b64_tr_b16 a[58:59], v5 offset:21504
    v_mfma_f32_16x16x32_bf16 v[72:75], a[8:11], a[8:11], v[72:75]
    s_waitcnt lgkmcnt(6)
    v_fma_f32 v111, v111, v109, v108
    v_fma_f32 v119, v119, v109, v108
    v_mfma_f32_16x16x32_bf16 v[68:71], a[100:103], a[20:23], v[68:71]
    ds_read_b64_tr_b16 a[68:69], v6 offset:20480
    ds_read_b64_tr_b16 a[70:71], v6 offset:21504
    v_mfma_f32_16x16x32_bf16 v[76:79], a[20:23], a[20:23], v[76:79]
    s_waitcnt lgkmcnt(6)
    global_load_dwordx4 a[36:39], v11, s[16:17] offset:2048 sc1
    v_mul_f32 v111, v40, v111
    v_mfma_f32_16x16x32_bf16 v[64:67], a[112:115], a[32:35], v[64:67]
    ds_read_b64_tr_b16 a[80:81], v5 offset:22528
    ds_read_b64_tr_b16 a[82:83], v5 offset:23552
    v_mfma_f32_16x16x32_bf16 v[72:75], a[32:35], a[32:35], v[72:75]
    s_waitcnt lgkmcnt(6)
    v_mul_f32 v119, v41, v119
    v_exp_f32 v111, v111
    v_mfma_f32_16x16x32_bf16 v[68:71], a[112:115], a[44:47], v[68:71]
    ds_read_b64_tr_b16 a[92:93], v6 offset:22528
    ds_read_b64_tr_b16 a[94:95], v6 offset:23552
    v_mfma_f32_16x16x32_bf16 v[76:79], a[44:47], a[44:47], v[76:79]
    s_waitcnt lgkmcnt(6)
    global_load_dwordx4 a[40:43], v11, s[16:17] offset:3072 sc1
    v_exp_f32 v119, v119
    v_mfma_f32_16x16x32_bf16 v[64:67], a[124:127], a[56:59], v[64:67]
    ds_read_b64_tr_b16 a[104:105], v5 offset:24576
    ds_read_b64_tr_b16 a[106:107], v5 offset:25600
    v_mfma_f32_16x16x32_bf16 v[72:75], a[56:59], a[56:59], v[72:75]
    s_waitcnt lgkmcnt(6)
    v_mul_f32 v43, v40, v43
    v_mul_f32 v42, v41, v42
    v_mfma_f32_16x16x32_bf16 v[68:71], a[124:127], a[68:71], v[68:71]
    ds_read_b64_tr_b16 a[116:117], v6 offset:24576
    ds_read_b64_tr_b16 a[118:119], v6 offset:25600
    v_mfma_f32_16x16x32_bf16 v[76:79], a[68:71], a[68:71], v[76:79]
    s_waitcnt lgkmcnt(6)
    v_fma_f32 v111, v111, v110, v110
    v_fma_f32 v119, v119, v110, v110
    v_mfma_f32_16x16x32_bf16 v[64:67], a[136:139], a[80:83], v[64:67]
    ds_read_b64_tr_b16 a[128:129], v5 offset:26624
    ds_read_b64_tr_b16 a[130:131], v5 offset:27648
    v_mfma_f32_16x16x32_bf16 v[72:75], a[80:83], a[80:83], v[72:75]
    s_waitcnt lgkmcnt(6)
    v_rcp_f32 v111, v111
    v_mfma_f32_16x16x32_bf16 v[68:71], a[136:139], a[92:95], v[68:71]
    ds_read_b64_tr_b16 a[140:141], v6 offset:26624
    ds_read_b64_tr_b16 a[142:143], v6 offset:27648
    v_mfma_f32_16x16x32_bf16 v[76:79], a[92:95], a[92:95], v[76:79]
    s_waitcnt lgkmcnt(6)
    v_rcp_f32 v119, v119
    v_mfma_f32_16x16x32_bf16 v[64:67], a[148:151], a[104:107], v[64:67]
    ds_read_b64_tr_b16 a[152:153], v5 offset:28672
    ds_read_b64_tr_b16 a[154:155], v5 offset:29696
    v_mfma_f32_16x16x32_bf16 v[72:75], a[104:107], a[104:107], v[72:75]
    s_waitcnt lgkmcnt(6)
    global_load_dwordx4 a[48:51], v11, s[18:19] offset:-4096 sc1
    v_mul_f32 v111, v43, v111
    v_mfma_f32_16x16x32_bf16 v[68:71], a[148:151], a[116:119], v[68:71]
    ds_read_b64_tr_b16 a[164:165], v6 offset:28672
    ds_read_b64_tr_b16 a[166:167], v6 offset:29696
    v_mfma_f32_16x16x32_bf16 v[76:79], a[116:119], a[116:119], v[76:79]
    s_waitcnt lgkmcnt(6)
    v_mul_f32 v119, v42, v119
    v_cvt_pk_bf16_f32 v122, v111, v119
    v_mfma_f32_16x16x32_bf16 v[64:67], a[160:163], a[128:131], v[64:67]
    ds_read_b64_tr_b16 a[176:177], v5 offset:30720
    ds_read_b64_tr_b16 a[178:179], v5 offset:31744
    v_mfma_f32_16x16x32_bf16 v[72:75], a[128:131], a[128:131], v[72:75]
    s_waitcnt lgkmcnt(6)
    global_load_dwordx4 a[52:55], v11, s[18:19] offset:-3072 sc1
    v_permlane16_swap_b32 v120, v121
    v_mfma_f32_16x16x32_bf16 v[68:71], a[160:163], a[140:143], v[68:71]
    ds_read_b64_tr_b16 a[188:189], v6 offset:30720
    ds_read_b64_tr_b16 a[190:191], v6 offset:31744
    v_mfma_f32_16x16x32_bf16 v[76:79], a[140:143], a[140:143], v[76:79]
    s_waitcnt lgkmcnt(6)
    v_mul_f32 v111, v44, v44
    v_mul_f32 v119, v45, v45
    v_mfma_f32_16x16x32_bf16 v[64:67], a[172:175], a[152:155], v[64:67]
    v_fma_f32 v111, v111, v117, v116
    v_fma_f32 v119, v119, v117, v116
    v_mfma_f32_16x16x32_bf16 v[72:75], a[152:155], a[152:155], v[72:75]
    s_waitcnt lgkmcnt(4)
    global_load_dwordx4 a[60:63], v11, s[18:19] offset:-2048 sc1
    v_mul_f32 v111, v44, v111
    v_mfma_f32_16x16x32_bf16 v[68:71], a[172:175], a[164:167], v[68:71]
    v_mul_f32 v119, v45, v119
    v_exp_f32 v111, v111
    v_mfma_f32_16x16x32_bf16 v[76:79], a[164:167], a[164:167], v[76:79]
    s_waitcnt lgkmcnt(2)
    v_exp_f32 v119, v119
    v_mfma_f32_16x16x32_bf16 v[64:67], a[184:187], a[176:179], v[64:67]
    v_mul_f32 v47, v44, v47
    v_mul_f32 v46, v45, v46
    v_mfma_f32_16x16x32_bf16 v[72:75], a[176:179], a[176:179], v[72:75]
    global_load_dwordx4 a[64:67], v11, s[18:19] offset:-1024 sc1
    v_fma_f32 v111, v111, v118, v118
    s_waitcnt lgkmcnt(0)
    v_mfma_f32_16x16x32_bf16 v[68:71], a[184:187], a[188:191], v[68:71]
    v_fma_f32 v119, v119, v118, v118
    v_rcp_f32 v111, v111
    v_mfma_f32_16x16x32_bf16 v[76:79], a[188:191], a[188:191], v[76:79]
    v_rcp_f32 v119, v119
    v_mfma_f32_16x16x32_bf16 v[56:59], a[96:99], a[8:11], v[56:59]
    v_mul_f32 v111, v47, v111
    v_mul_f32 v119, v46, v119
    v_mfma_f32_16x16x32_bf16 v[60:63], a[96:99], a[20:23], v[60:63]
    global_load_dwordx4 a[72:75], v11, s[18:19] offset:0 sc1
    v_cvt_pk_bf16_f32 v123, v111, v119
    v_mfma_f32_16x16x32_bf16 v[56:59], a[108:111], a[32:35], v[56:59]
    s_nop 0
    v_permlane16_swap_b32 v122, v123
    v_mfma_f32_16x16x32_bf16 v[60:63], a[108:111], a[44:47], v[60:63]
    global_store_dwordx4 v9, v[120:123], s[42:43] sc1
    v_cndmask_b32 v124, 0, v72, s[24:25]
    v_cndmask_b32 v125, 0, v76, s[24:25]
    v_cndmask_b32 v124, v124, v73, s[26:27]
    v_mfma_f32_16x16x32_bf16 v[56:59], a[120:123], a[56:59], v[56:59]
    v_cndmask_b32 v125, v125, v77, s[26:27]
    v_cndmask_b32 v124, v124, v74, s[28:29]
    v_cndmask_b32 v125, v125, v78, s[28:29]
    v_cndmask_b32 v124, v124, v75, s[30:31]
    v_mfma_f32_16x16x32_bf16 v[60:63], a[120:123], a[68:71], v[60:63]
    global_load_dwordx4 a[76:79], v11, s[18:19] offset:1024 sc1
    v_cndmask_b32 v125, v125, v79, s[30:31]
    v_mov_b32 v126, v64
    v_mov_b32 v127, v68
    v_mfma_f32_16x16x32_bf16 v[56:59], a[132:135], a[80:83], v[56:59]
    v_permlane16_swap_b32 v124, v125
    v_permlane16_swap_b32 v126, v127
    v_mfma_f32_16x16x32_bf16 v[60:63], a[132:135], a[92:95], v[60:63]
    v_add_f32 v124, v124, v125
    v_mov_b32 v125, v124
    s_nop 1
    v_permlane32_swap_b32 v124, v125
    v_mfma_f32_16x16x32_bf16 v[56:59], a[144:147], a[104:107], v[56:59]
    v_add_f32 v124, v124, v125
    v_mul_f32 v127, 0x3b000000, v127
    v_mul_f32 v124, 0x3b000000, v124
    v_fma_f32 v124, -v127, v127, v124
    v_mfma_f32_16x16x32_bf16 v[60:63], a[144:147], a[116:119], v[60:63]
    global_load_dwordx4 a[84:87], v11, s[18:19] offset:2048 sc1
    v_max_f32 v124, 0, v124
    v_cvt_pk_bf16_f32 v127, v127, v124
    v_and_b32 v124, s60, v127
    v_mfma_f32_16x16x32_bf16 v[56:59], a[156:159], a[128:131], v[56:59]
    v_add_f32 v124, 0x3727c5ac, v124
    v_cvt_pk_bf16_f32 v125, v124, v124
    v_and_b32 v124, s60, v125
    v_mfma_f32_16x16x32_bf16 v[60:63], a[156:159], a[140:143], v[60:63]
    v_sqrt_f32 v124, v124
    v_lshlrev_b32 v127, 16, v127
    v_cvt_pk_bf16_f32 v125, v124, v124
    v_mfma_f32_16x16x32_bf16 v[56:59], a[168:171], a[152:155], v[56:59]
    v_and_b32 v124, s60, v125
    v_rcp_f32 v125, v124
    v_cvt_pk_bf16_f32 v72, -v127, -v127
    v_mfma_f32_16x16x32_bf16 v[60:63], a[168:171], a[164:167], v[60:63]
    global_load_dwordx4 a[88:91], v11, s[18:19] offset:3072 sc1
    v_mul_f32 v78, v124, v124
    v_mul_f32 v76, 0xc0135761, v125
    v_mul_f32 v125, v125, v125
    v_mfma_f32_16x16x32_bf16 v[56:59], a[180:183], a[176:179], v[56:59]
    v_mov_b32 v73, v72
    v_mul_f32 v125, 0x3d372713, v125
    v_mov_b32 v74, v72
    v_mul_f32 v77, v76, v125
    v_mfma_f32_16x16x32_bf16 v[60:63], a[180:183], a[188:191], v[60:63]
    v_mov_b32 v75, v72
    v_fma_f32 v76, v127, 0, v76
    s_mov_b32 exec_lo, 0
    ds_write_b128 v8, v[72:75] offset:1024
    ds_write_b128 v8, v[76:79] offset:1040
    s_mov_b32 exec_lo, -1
    v_add_u32 v9, 180224, v9
    s_waitcnt vmcnt(21)
    ds_read_b64_tr_b16 v[88:89], v13 offset:0
    ds_read_b64_tr_b16 v[90:91], v13 offset:1024
    ds_read_b64_tr_b16 v[92:93], v13 offset:2048
    ds_read_b64_tr_b16 v[94:95], v13 offset:3072
    s_waitcnt lgkmcnt(4)
    s_barrier
    ds_read_b128 v[104:107], v7 offset:1024
    ds_read_b128 v[112:115], v7 offset:1536
    ds_read_b128 v[108:111], v7 offset:1040
    ds_read_b128 v[116:119], v7 offset:1552
    s_waitcnt lgkmcnt(3)
    v_mfma_f32_16x16x32_bf16 v[56:59], v[20:23], v[104:107], v[56:59]
    s_waitcnt lgkmcnt(2)
    v_mfma_f32_16x16x32_bf16 v[60:63], v[20:23], v[112:115], v[60:63]
    v_mfma_f32_16x16x32_bf16 v[64:67], v[24:27], v[104:107], v[64:67]
    v_mfma_f32_16x16x32_bf16 v[68:71], v[24:27], v[112:115], v[68:71]
    s_waitcnt lgkmcnt(0)
    v_cmp_u_f32 vcc, v108, v116
    s_or_b64 s[62:63], s[62:63], vcc
    s_nop 0
    v_pk_mul_f32 v[104:105], v[56:57], v[56:57]
    v_pk_fma_f32 v[104:105], v[104:105], v[108:109], v[108:109] op_sel:[0,1,0] op_sel_hi:[1,1,0]
    v_pk_mul_f32 v[104:105], v[56:57], v[104:105]
    v_exp_f32 v104, v104
    v_exp_f32 v105, v105
    s_nop 0
    v_pk_fma_f32 v[104:105], v[104:105], v[110:111], v[110:111] op_sel_hi:[1,0,0]
    v_rcp_f32 v104, v104
    v_rcp_f32 v105, v105
    v_pk_mul_f32 v[58:59], v[56:57], v[58:59] op_sel:[0,1] op_sel_hi:[1,0]
    v_pk_mul_f32 v[58:59], v[104:105], v[58:59]
    v_pk_mul_f32 v[112:113], v[60:61], v[60:61]
    v_pk_fma_f32 v[112:113], v[112:113], v[116:117], v[116:117] op_sel:[0,1,0] op_sel_hi:[1,1,0]
    v_pk_mul_f32 v[112:113], v[60:61], v[112:113]
    v_exp_f32 v112, v112
    v_exp_f32 v113, v113
    v_cvt_pk_bf16_f32 v120, v58, v59
    v_pk_fma_f32 v[112:113], v[112:113], v[118:119], v[118:119] op_sel_hi:[1,0,0]
    v_rcp_f32 v112, v112
    v_rcp_f32 v113, v113
    v_pk_mul_f32 v[62:63], v[60:61], v[62:63] op_sel:[0,1] op_sel_hi:[1,0]
    v_pk_mul_f32 v[62:63], v[112:113], v[62:63]
    v_pk_mul_f32 v[104:105], v[64:65], v[64:65]
    v_pk_fma_f32 v[104:105], v[104:105], v[108:109], v[108:109] op_sel:[0,1,0] op_sel_hi:[1,1,0]
    v_pk_mul_f32 v[104:105], v[64:65], v[104:105]
    v_exp_f32 v104, v104
    v_exp_f32 v105, v105
    v_cvt_pk_bf16_f32 v121, v62, v63
    v_pk_fma_f32 v[104:105], v[104:105], v[110:111], v[110:111] op_sel_hi:[1,0,0]
    v_rcp_f32 v104, v104
    v_rcp_f32 v105, v105
    v_pk_mul_f32 v[66:67], v[64:65], v[66:67] op_sel:[0,1] op_sel_hi:[1,0]
    v_pk_mul_f32 v[66:67], v[104:105], v[66:67]
    v_permlane16_swap_b32 v120, v121
    v_pk_mul_f32 v[112:113], v[68:69], v[68:69]
    v_pk_fma_f32 v[112:113], v[112:113], v[116:117], v[116:117] op_sel:[0,1,0] op_sel_hi:[1,1,0]
    v_pk_mul_f32 v[112:113], v[68:69], v[112:113]
    v_exp_f32 v112, v112
    v_exp_f32 v113, v113
    v_cvt_pk_bf16_f32 v122, v66, v67
    v_pk_fma_f32 v[112:113], v[112:113], v[118:119], v[118:119] op_sel_hi:[1,0,0]
    v_rcp_f32 v112, v112
    v_rcp_f32 v113, v113
    v_pk_mul_f32 v[70:71], v[68:69], v[70:71] op_sel:[0,1] op_sel_hi:[1,0]
    v_pk_mul_f32 v[70:71], v[112:113], v[70:71]
    v_cvt_pk_bf16_f32 v123, v70, v71
    s_nop 1
    v_permlane16_swap_b32 v122, v123
    global_store_dwordx4 v9, v[120:123], s[42:43] sc1
    v_add_u32 v9, 180224, v9
    s_cmp_lg_u64 s[62:63], 0
    s_cbranch_scc1 L_redo
L_noredob:
    s_mov_b32 s59, 0
L_rsb:
    v_pk_max_u16 v96, v88, v89
    v_pk_max_u16 v97, v90, v91
    v_pk_max_u16 v98, v92, v93
    v_pk_max_u16 v99, v94, v95
    v_pk_max_u16 v96, v96, v97
    v_pk_max_u16 v98, v98, v99
    v_pk_max_u16 v96, v96, v98
    v_pk_max_u16 v96, v96, v96 op_sel:[0,1] op_sel_hi:[1,0]
    v_cmp_eq_u32 vcc, -1, v96
    s_cbranch_vccnz L_rsrb
L_rsokb:
    v_lshlrev_b32 v72, 16, v88
    v_and_b32 v73, s60, v88
    v_lshlrev_b32 v74, 16, v89
    v_and_b32 v75, s60, v89
    v_lshlrev_b32 v76, 16, v90
    v_and_b32 v77, s60, v90
    v_lshlrev_b32 v78, 16, v91
    v_and_b32 v79, s60, v91
    s_waitcnt vmcnt(18)
    v_mfma_f32_16x16x32_bf16 v[32:35], a[192:195], a[0:3], v[72:75]
    global_load_dwordx4 a[96:99], v12, s[16:17] offset:-4096 sc1
    v_lshlrev_b32 v80, 16, v92
    v_and_b32 v81, s60, v92
    v_mfma_f32_16x16x32_bf16 v[36:39], a[196:199], a[0:3], 0
    v_lshlrev_b32 v82, 16, v93
    v_and_b32 v83, s60, v93
    v_lshlrev_b32 v84, 16, v94
    v_mfma_f32_16x16x32_bf16 v[40:43], a[200:203], a[0:3], 0
    global_load_dwordx4 a[112:115], v12, s[18:19] offset:-4096 sc1
    v_and_b32 v85, s60, v94
    v_lshlrev_b32 v86, 16, v95
    v_mfma_f32_16x16x32_bf16 v[44:47], a[204:207], a[0:3], 0
    s_waitcnt vmcnt(11)
    v_and_b32 v87, s60, v95
    v_mfma_f32_16x16x32_bf16 v[48:51], a[192:195], a[48:51], v[76:79]
    global_load_dwordx4 v[240:243], v10, s[42:43] offset:-4096 sc1
    v_mfma_f32_16x16x32_bf16 v[52:55], a[196:199], a[48:51], 0
    v_mfma_f32_16x16x32_bf16 v[56:59], a[200:203], a[48:51], 0
    global_load_dwordx4 v[244:247], v10, s[42:43] offset:-3072 sc1
    v_mfma_f32_16x16x32_bf16 v[60:63], a[204:207], a[48:51], 0
    v_mfma_f32_16x16x32_bf16 v[32:35], a[208:211], a[4:7], v[32:35]
    global_load_dwordx4 v[248:251], v10, s[42:43] offset:-2048 sc1
    v_mfma_f32_16x16x32_bf16 v[36:39], a[212:215], a[4:7], v[36:39]
    v_mfma_f32_16x16x32_bf16 v[40:43], a[216:219], a[4:7], v[40:43]
    global_load_dwordx4 v[252:255], v10, s[42:43] offset:-1024 sc1
    v_mfma_f32_16x16x32_bf16 v[44:47], a[220:223], a[4:7], v[44:47]
    s_waitcnt vmcnt(14)
    v_mfma_f32_16x16x32_bf16 v[48:51], a[208:211], a[52:55], v[48:51]
    global_load_dwordx4 a[100:103], v12, s[16:17] offset:-3072 sc1
    v_mfma_f32_16x16x32_bf16 v[52:55], a[212:215], a[52:55], v[52:55]
    v_mfma_f32_16x16x32_bf16 v[56:59], a[216:219], a[52:55], v[56:59]
    global_load_dwordx4 a[120:123], v12, s[18:19] offset:-3072 sc1
    v_mfma_f32_16x16x32_bf16 v[60:63], a[220:223], a[52:55], v[60:63]
    v_mfma_f32_16x16x32_bf16 v[32:35], a[224:227], a[12:15], v[32:35]
    global_load_dwordx4 a[108:111], v12, s[16:17] offset:-2048 sc1
    v_mfma_f32_16x16x32_bf16 v[36:39], a[228:231], a[12:15], v[36:39]
    v_mfma_f32_16x16x32_bf16 v[40:43], a[232:235], a[12:15], v[40:43]
    global_load_dwordx4 a[124:127], v12, s[18:19] offset:-2048 sc1
    v_mfma_f32_16x16x32_bf16 v[44:47], a[236:239], a[12:15], v[44:47]
    s_waitcnt vmcnt(17)
    v_mfma_f32_16x16x32_bf16 v[48:51], a[224:227], a[60:63], v[48:51]
    global_load_dwordx4 a[132:135], v11, s[20:21] offset:-4096 sc1
    v_mfma_f32_16x16x32_bf16 v[52:55], a[228:231], a[60:63], v[52:55]
    v_mfma_f32_16x16x32_bf16 v[56:59], a[232:235], a[60:63], v[56:59]
    global_load_dwordx4 a[136:139], v11, s[20:21] offset:-3072 sc1
    v_mfma_f32_16x16x32_bf16 v[60:63], a[236:239], a[60:63], v[60:63]
    v_mfma_f32_16x16x32_bf16 v[32:35], v[128:131], a[16:19], v[32:35]
    global_load_dwordx4 a[144:147], v11, s[20:21] offset:-2048 sc1
    v_mfma_f32_16x16x32_bf16 v[36:39], v[132:135], a[16:19], v[36:39]
    v_mfma_f32_16x16x32_bf16 v[40:43], v[136:139], a[16:19], v[40:43]
    global_load_dwordx4 a[148:151], v11, s[20:21] offset:-1024 sc1
    v_mfma_f32_16x16x32_bf16 v[44:47], v[140:143], a[16:19], v[44:47]
    s_waitcnt vmcnt(20)
    v_mfma_f32_16x16x32_bf16 v[48:51], v[128:131], a[64:67], v[48:51]
    global_load_dwordx4 a[156:159], v11, s[20:21] offset:0 sc1
    v_mfma_f32_16x16x32_bf16 v[52:55], v[132:135], a[64:67], v[52:55]
    v_mfma_f32_16x16x32_bf16 v[56:59], v[136:139], a[64:67], v[56:59]
    global_load_dwordx4 a[160:163], v11, s[20:21] offset:1024 sc1
    v_mfma_f32_16x16x32_bf16 v[60:63], v[140:143], a[64:67], v[60:63]
    v_mfma_f32_16x16x32_bf16 v[32:35], v[144:147], a[24:27], v[32:35]
    global_load_dwordx4 a[168:171], v11, s[20:21] offset:2048 sc1
    v_mfma_f32_16x16x32_bf16 v[36:39], v[148:151], a[24:27], v[36:39]
    v_mfma_f32_16x16x32_bf16 v[40:43], v[152:155], a[24:27], v[40:43]
    global_load_dwordx4 a[172:175], v11, s[20:21] offset:3072 sc1
    v_mfma_f32_16x16x32_bf16 v[44:47], v[156:159], a[24:27], v[44:47]
    s_waitcnt vmcnt(23)
    v_mfma_f32_16x16x32_bf16 v[48:51], v[144:147], a[72:75], v[48:51]
    global_load_dwordx4 a[180:183], v12, s[20:21] offset:-4096 sc1
    v_mfma_f32_16x16x32_bf16 v[52:55], v[148:151], a[72:75], v[52:55]
    v_mfma_f32_16x16x32_bf16 v[56:59], v[152:155], a[72:75], v[56:59]
    global_load_dwordx4 a[184:187], v12, s[20:21] offset:-3072 sc1
    v_mfma_f32_16x16x32_bf16 v[60:63], v[156:159], a[72:75], v[60:63]
    v_mfma_f32_16x16x32_bf16 v[32:35], v[160:163], a[28:31], v[32:35]
    global_load_dwordx4 a[8:11], v12, s[20:21] offset:-2048 sc1
    v_mfma_f32_16x16x32_bf16 v[36:39], v[164:167], a[28:31], v[36:39]
    v_mfma_f32_16x16x32_bf16 v[40:43], v[168:171], a[28:31], v[40:43]
    v_mfma_f32_16x16x32_bf16 v[44:47], v[172:175], a[28:31], v[44:47]
    s_waitcnt vmcnt(24)
    v_mfma_f32_16x16x32_bf16 v[48:51], v[160:163], a[76:79], v[48:51]
    v_mfma_f32_16x16x32_bf16 v[52:55], v[164:167], a[76:79], v[52:55]
    v_mfma_f32_16x16x32_bf16 v[56:59], v[168:171], a[76:79], v[56:59]
    v_mfma_f32_16x16x32_bf16 v[60:63], v[172:175], a[76:79], v[60:63]
    v_mfma_f32_16x16x32_bf16 v[32:35], v[176:179], a[36:39], v[32:35]
    v_mfma_f32_16x16x32_bf16 v[36:39], v[180:183], a[36:39], v[36:39]
    v_mfma_f32_16x16x32_bf16 v[40:43], v[184:187], a[36:39], v[40:43]
    v_mfma_f32_16x16x32_bf16 v[44:47], v[188:191], a[36:39], v[44:47]
    s_waitcnt vmcnt(23)
    v_mfma_f32_16x16x32_bf16 v[48:51], v[176:179], a[84:87], v[48:51]
    v_mfma_f32_16x16x32_bf16 v[52:55], v[180:183], a[84:87], v[52:55]
    v_mfma_f32_16x16x32_bf16 v[56:59], v[184:187], a[84:87], v[56:59]
    v_mfma_f32_16x16x32_bf16 v[60:63], v[188:191], a[84:87], v[60:63]
    v_mfma_f32_16x16x32_bf16 v[32:35], v[192:195], a[40:43], v[32:35]
    v_mfma_f32_16x16x32_bf16 v[36:39], v[196:199], a[40:43], v[36:39]
    v_mfma_f32_16x16x32_bf16 v[40:43], v[200:203], a[40:43], v[40:43]
    v_mfma_f32_16x16x32_bf16 v[44:47], v[204:207], a[40:43], v[44:47]
    s_waitcnt vmcnt(22)
    v_mfma_f32_16x16x32_bf16 v[48:51], v[192:195], a[88:91], v[48:51]
    s_waitcnt vmcnt(21)
    global_load_dwordx4 a[20:23], v11, s[22:23] offset:-4096 sc1
    v_mfma_f32_16x16x32_bf16 v[52:55], v[196:199], a[88:91], v[52:55]
    v_mfma_f32_16x16x32_bf16 v[56:59], v[200:203], a[88:91], v[56:59]
    global_load_dwordx4 a[32:35], v11, s[22:23] offset:-3072 sc1
    v_mfma_f32_16x16x32_bf16 v[60:63], v[204:207], a[88:91], v[60:63]
    s_waitcnt vmcnt(22)
    v_mfma_f32_16x16x32_bf16 v[32:35], v[208:211], a[96:99], v[32:35]
    global_load_dwordx4 a[44:47], v11, s[22:23] offset:-2048 sc1
    v_mfma_f32_16x16x32_bf16 v[36:39], v[212:215], a[96:99], v[36:39]
    v_mfma_f32_16x16x32_bf16 v[40:43], v[216:219], a[96:99], v[40:43]
    global_load_dwordx4 a[56:59], v11, s[22:23] offset:-1024 sc1
    v_mfma_f32_16x16x32_bf16 v[44:47], v[220:223], a[96:99], v[44:47]
    s_waitcnt vmcnt(23)
    v_mfma_f32_16x16x32_bf16 v[48:51], v[208:211], a[112:115], v[48:51]
    global_load_dwordx4 a[68:71], v11, s[22:23] offset:0 sc1
    v_mfma_f32_16x16x32_bf16 v[52:55], v[212:215], a[112:115], v[52:55]
    v_mfma_f32_16x16x32_bf16 v[56:59], v[216:219], a[112:115], v[56:59]
    global_load_dwordx4 a[80:83], v11, s[22:23] offset:1024 sc1
    v_mfma_f32_16x16x32_bf16 v[60:63], v[220:223], a[112:115], v[60:63]
    s_waitcnt vmcnt(20)
    v_mfma_f32_16x16x32_bf16 v[32:35], v[224:227], a[100:103], v[32:35]
    global_load_dwordx4 a[92:95], v11, s[22:23] offset:2048 sc1
    v_mfma_f32_16x16x32_bf16 v[36:39], v[228:231], a[100:103], v[36:39]
    v_mfma_f32_16x16x32_bf16 v[40:43], v[232:235], a[100:103], v[40:43]
    global_load_dwordx4 a[104:107], v11, s[22:23] offset:3072 sc1
    v_mfma_f32_16x16x32_bf16 v[44:47], v[236:239], a[100:103], v[44:47]
    s_waitcnt vmcnt(21)
    v_mfma_f32_16x16x32_bf16 v[48:51], v[224:227], a[120:123], v[48:51]
    global_load_dwordx4 a[116:119], v12, s[22:23] offset:-4096 sc1
    v_mfma_f32_16x16x32_bf16 v[52:55], v[228:231], a[120:123], v[52:55]
    s_waitcnt vmcnt(19)
    v_accvgpr_read_b32 v20, a132
    s_waitcnt vmcnt(18)
    v_accvgpr_read_b32 v21, a136
    v_mfma_f32_16x16x32_bf16 v[56:59], v[232:235], a[120:123], v[56:59]
    global_load_dwordx4 a[128:131], v12, s[22:23] offset:-3072 sc1
    s_waitcnt vmcnt(18)
    v_accvgpr_read_b32 v22, a144
    v_mfma_f32_16x16x32_bf16 v[60:63], v[236:239], a[120:123], v[60:63]
    s_waitcnt vmcnt(17)
    v_accvgpr_read_b32 v23, a148
    s_waitcnt vmcnt(16)
    v_accvgpr_read_b32 v24, a156
    v_mfma_f32_16x16x32_bf16 v[32:35], v[240:243], a[108:111], v[32:35]
    global_load_dwordx4 a[140:143], v12, s[22:23] offset:-2048 sc1
    s_waitcnt vmcnt(16)
    v_accvgpr_read_b32 v25, a160
    v_mfma_f32_16x16x32_bf16 v[36:39], v[244:247], a[108:111], v[36:39]
    s_waitcnt vmcnt(15)
    v_accvgpr_read_b32 v26, a168
    s_waitcnt vmcnt(14)
    v_accvgpr_read_b32 v27, a172
    v_mfma_f32_16x16x32_bf16 v[40:43], v[248:251], a[108:111], v[40:43]
    s_waitcnt vmcnt(13)
    v_accvgpr_read_b32 v28, a180
    s_waitcnt vmcnt(12)
    v_accvgpr_read_b32 v29, a184
    v_mfma_f32_16x16x32_bf16 v[44:47], v[252:255], a[108:111], v[44:47]
    s_waitcnt vmcnt(11)
    v_accvgpr_read_b32 v30, a8
    v_max3_u32 v20, v20, v21, v22
    v_mfma_f32_16x16x32_bf16 v[48:51], v[240:243], a[124:127], v[48:51]
    v_max3_u32 v23, v23, v24, v25
    v_max3_u32 v26, v26, v27, v28
    v_mfma_f32_16x16x32_bf16 v[52:55], v[244:247], a[124:127], v[52:55]
    v_max3_u32 v20, v20, v29, v30
    v_max3_u32 v20, v20, v23, v26
    v_mfma_f32_16x16x32_bf16 v[56:59], v[248:251], a[124:127], v[56:59]
    v_cmp_eq_u32 vcc, -1, v20
    s_cbranch_vccnz L_pc2b
L_pcok2b:
    v_mfma_f32_16x16x32_bf16 v[60:63], v[252:255], a[124:127], v[60:63]
    v_mfma_f32_16x16x32_bf16 v[104:107], a[192:195], a[132:135], v[80:83]
    v_mfma_f32_16x16x32_bf16 v[108:111], a[196:199], a[132:135], 0
    v_mfma_f32_16x16x32_bf16 v[112:115], a[200:203], a[132:135], 0
    v_mfma_f32_16x16x32_bf16 v[116:119], a[204:207], a[132:135], 0
    v_mfma_f32_16x16x32_bf16 v[104:107], a[208:211], a[136:139], v[104:107]
    v_cmp_u_f32 vcc, v44, v44
    s_cbranch_vccnz L_rt0b
L_rtok0b:
    v_mfma_f32_16x16x32_bf16 v[108:111], a[212:215], a[136:139], v[108:111]
    v_cmp_u_f32 vcc, v60, v60
    s_cbranch_vccnz L_rt1b
L_rtok1b:
    v_mfma_f32_16x16x32_bf16 v[112:115], a[216:219], a[136:139], v[112:115]
    ds_write_b128 v16, v[32:35] offset:0
    v_mfma_f32_16x16x32_bf16 v[116:119], a[220:223], a[136:139], v[116:119]
    ds_write_b128 v17, v[36:39] offset:0
    v_mfma_f32_16x16x32_bf16 v[104:107], a[224:227], a[144:147], v[104:107]
    ds_write_b128 v18, v[40:43] offset:0
    v_mfma_f32_16x16x32_bf16 v[108:111], a[228:231], a[144:147], v[108:111]
    ds_write_b128 v19, v[44:47] offset:0
    v_mfma_f32_16x16x32_bf16 v[112:115], a[232:235], a[144:147], v[112:115]
    ds_write_b128 v16, v[48:51] offset:16384
    v_mfma_f32_16x16x32_bf16 v[116:119], a[236:239], a[144:147], v[116:119]
    ds_write_b128 v17, v[52:55] offset:16384
    v_mfma_f32_16x16x32_bf16 v[104:107], v[128:131], a[148:151], v[104:107]
    ds_write_b128 v18, v[56:59] offset:16384
    v_mfma_f32_16x16x32_bf16 v[108:111], v[132:135], a[148:151], v[108:111]
    ds_write_b128 v19, v[60:63] offset:16384
    v_mfma_f32_16x16x32_bf16 v[112:115], v[136:139], a[148:151], v[112:115]
    v_mfma_f32_16x16x32_bf16 v[116:119], v[140:143], a[148:151], v[116:119]
    v_mfma_f32_16x16x32_bf16 v[104:107], v[144:147], a[156:159], v[104:107]
    v_mfma_f32_16x16x32_bf16 v[108:111], v[148:151], a[156:159], v[108:111]
    v_mfma_f32_16x16x32_bf16 v[112:115], v[152:155], a[156:159], v[112:115]
    s_waitcnt lgkmcnt(0)
    s_barrier
    ds_read_b128 v[88:91], v14 offset:0
    v_mfma_f32_16x16x32_bf16 v[116:119], v[156:159], a[156:159], v[116:119]
    ds_read_b128 v[92:95], v14 offset:4096
    v_mfma_f32_16x16x32_bf16 v[104:107], v[160:163], a[160:163], v[104:107]
    ds_read_b128 v[96:99], v14 offset:8192
    v_mfma_f32_16x16x32_bf16 v[108:111], v[164:167], a[160:163], v[108:111]
    ds_read_b128 v[100:103], v14 offset:12288
    v_mfma_f32_16x16x32_bf16 v[112:115], v[168:171], a[160:163], v[112:115]
    v_mfma_f32_16x16x32_bf16 v[116:119], v[172:175], a[160:163], v[116:119]
    v_mfma_f32_16x16x32_bf16 v[104:107], v[176:179], a[168:171], v[104:107]
    v_mfma_f32_16x16x32_bf16 v[108:111], v[180:183], a[168:171], v[108:111]
    v_mfma_f32_16x16x32_bf16 v[112:115], v[184:187], a[168:171], v[112:115]
    s_waitcnt lgkmcnt(2)
    v_add_f32 v88, v88, v92
    s_waitcnt lgkmcnt(0)
    v_add_f32 v96, v96, v100
    v_mfma_f32_16x16x32_bf16 v[116:119], v[188:191], a[168:171], v[116:119]
    v_add_f32 v89, v89, v93
    v_add_f32 v97, v97, v101
    v_mfma_f32_16x16x32_bf16 v[104:107], v[192:195], a[172:175], v[104:107]
    v_add_f32 v90, v90, v94
    v_add_f32 v98, v98, v102
    v_mfma_f32_16x16x32_bf16 v[108:111], v[196:199], a[172:175], v[108:111]
    v_add_f32 v91, v91, v95
    v_add_f32 v99, v99, v103
    v_mfma_f32_16x16x32_bf16 v[112:115], v[200:203], a[172:175], v[112:115]
    v_add_f32 v88, v88, v96
    v_add_f32 v89, v89, v97
    v_mfma_f32_16x16x32_bf16 v[116:119], v[204:207], a[172:175], v[116:119]
    v_add_f32 v90, v90, v98
    v_add_f32 v91, v91, v99
    s_waitcnt vmcnt(10)
    v_accvgpr_read_b32 v20, a20
    v_mfma_f32_16x16x32_bf16 v[104:107], v[208:211], a[180:183], v[104:107]
    v_cvt_pk_bf16_f32 v120, v88, v89
    v_cvt_pk_bf16_f32 v121, v90, v91
    s_waitcnt vmcnt(9)
    v_accvgpr_read_b32 v21, a32
    v_mfma_f32_16x16x32_bf16 v[108:111], v[212:215], a[180:183], v[108:111]
    global_store_dwordx2 v15, v[120:121], s[38:39] sc1
    v_add_u32 v15, 0x80000, v15
    s_waitcnt vmcnt(9)
    v_accvgpr_read_b32 v22, a44
    v_mfma_f32_16x16x32_bf16 v[112:115], v[216:219], a[180:183], v[112:115]
    ds_read_b128 v[88:91], v14 offset:16384
    s_waitcnt vmcnt(8)
    v_accvgpr_read_b32 v23, a56
    s_waitcnt vmcnt(7)
    v_accvgpr_read_b32 v24, a68
    v_mfma_f32_16x16x32_bf16 v[116:119], v[220:223], a[180:183], v[116:119]
    ds_read_b128 v[92:95], v14 offset:20480
    s_waitcnt vmcnt(6)
    v_accvgpr_read_b32 v25, a80
    s_waitcnt vmcnt(5)
    v_accvgpr_read_b32 v26, a92
    v_mfma_f32_16x16x32_bf16 v[104:107], v[224:227], a[184:187], v[104:107]
    ds_read_b128 v[96:99], v14 offset:24576
    s_waitcnt vmcnt(4)
    v_accvgpr_read_b32 v27, a104
    s_waitcnt vmcnt(3)
    v_accvgpr_read_b32 v28, a116
    v_mfma_f32_16x16x32_bf16 v[108:111], v[228:231], a[184:187], v[108:111]
    ds_read_b128 v[100:103], v14 offset:28672
    s_waitcnt vmcnt(2)
    v_accvgpr_read_b32 v29, a128
    s_waitcnt vmcnt(1)
    v_accvgpr_read_b32 v30, a140
    v_mfma_f32_16x16x32_bf16 v[112:115], v[232:235], a[184:187], v[112:115]
    v_max3_u32 v20, v20, v21, v22
    v_max3_u32 v23, v23, v24, v25
    v_max3_u32 v26, v26, v27, v28
    v_mfma_f32_16x16x32_bf16 v[116:119], v[236:239], a[184:187], v[116:119]
    v_max3_u32 v20, v20, v29, v30
    v_max3_u32 v20, v20, v23, v26
    v_cmp_eq_u32 vcc, -1, v20
    v_mfma_f32_16x16x32_bf16 v[104:107], v[240:243], a[8:11], v[104:107]
    s_cbranch_vccnz L_pc3b
L_pcok3b:
    v_mfma_f32_16x16x32_bf16 v[108:111], v[244:247], a[8:11], v[108:111]
    v_mfma_f32_16x16x32_bf16 v[112:115], v[248:251], a[8:11], v[112:115]
    s_waitcnt lgkmcnt(2)
    v_add_f32 v88, v88, v92
    s_waitcnt lgkmcnt(0)
    v_add_f32 v96, v96, v100
    v_mfma_f32_16x16x32_bf16 v[116:119], v[252:255], a[8:11], v[116:119]
    v_add_f32 v89, v89, v93
    v_add_f32 v97, v97, v101
    v_mfma_f32_16x16x32_bf16 v[32:35], a[192:195], a[20:23], v[84:87]
    v_add_f32 v90, v90, v94
    v_add_f32 v98, v98, v102
    v_mfma_f32_16x16x32_bf16 v[32:35], a[208:211], a[32:35], v[32:35]
    v_add_f32 v91, v91, v95
    v_add_f32 v99, v99, v103
    v_mfma_f32_16x16x32_bf16 v[32:35], a[224:227], a[44:47], v[32:35]
    v_add_f32 v88, v88, v96
    v_add_f32 v89, v89, v97
    v_mfma_f32_16x16x32_bf16 v[32:35], v[128:131], a[56:59], v[32:35]
    v_add_f32 v90, v90, v98
    v_add_f32 v91, v91, v99
    v_mfma_f32_16x16x32_bf16 v[32:35], v[144:147], a[68:71], v[32:35]
    v_cvt_pk_bf16_f32 v122, v88, v89
    v_cvt_pk_bf16_f32 v123, v90, v91
    v_mfma_f32_16x16x32_bf16 v[32:35], v[160:163], a[80:83], v[32:35]
    global_store_dwordx2 v15, v[122:123], s[38:39] sc1
    v_add_u32 v15, 0x80000, v15
    v_mfma_f32_16x16x32_bf16 v[32:35], v[176:179], a[92:95], v[32:35]
    v_cmp_u_f32 vcc, v116, v116
    s_cbranch_vccnz L_rt2b
L_rtok2b:
    v_mfma_f32_16x16x32_bf16 v[32:35], v[192:195], a[104:107], v[32:35]
    ds_write_b128 v16, v[104:107] offset:32768
    v_mfma_f32_16x16x32_bf16 v[32:35], v[208:211], a[116:119], v[32:35]
    ds_write_b128 v17, v[108:111] offset:32768
    v_mfma_f32_16x16x32_bf16 v[32:35], v[224:227], a[128:131], v[32:35]
    ds_write_b128 v18, v[112:115] offset:32768
    v_mfma_f32_16x16x32_bf16 v[32:35], v[240:243], a[140:143], v[32:35]
    ds_write_b128 v19, v[116:119] offset:32768
    v_mfma_f32_16x16x32_bf16 v[36:39], a[196:199], a[20:23], 0
    v_mfma_f32_16x16x32_bf16 v[36:39], a[212:215], a[32:35], v[36:39]
    v_mfma_f32_16x16x32_bf16 v[36:39], a[228:231], a[44:47], v[36:39]
    v_mfma_f32_16x16x32_bf16 v[36:39], v[132:135], a[56:59], v[36:39]
    v_mfma_f32_16x16x32_bf16 v[36:39], v[148:151], a[68:71], v[36:39]
    s_waitcnt lgkmcnt(0)
    s_barrier
    ds_read_b128 v[88:91], v14 offset:32768
    v_mfma_f32_16x16x32_bf16 v[36:39], v[164:167], a[80:83], v[36:39]
    ds_read_b128 v[92:95], v14 offset:36864
    ds_write_b128 v16, v[32:35] offset:49152
    v_mfma_f32_16x16x32_bf16 v[36:39], v[180:183], a[92:95], v[36:39]
    ds_read_b128 v[96:99], v14 offset:40960
    v_mfma_f32_16x16x32_bf16 v[36:39], v[196:199], a[104:107], v[36:39]
    ds_read_b128 v[100:103], v14 offset:45056
    v_mfma_f32_16x16x32_bf16 v[36:39], v[212:215], a[116:119], v[36:39]
    v_mfma_f32_16x16x32_bf16 v[36:39], v[228:231], a[128:131], v[36:39]
    v_mfma_f32_16x16x32_bf16 v[36:39], v[244:247], a[140:143], v[36:39]
    v_mfma_f32_16x16x32_bf16 v[40:43], a[200:203], a[20:23], 0
    v_mfma_f32_16x16x32_bf16 v[40:43], a[216:219], a[32:35], v[40:43]
    s_waitcnt lgkmcnt(3)
    v_add_f32 v88, v88, v92
    s_waitcnt lgkmcnt(0)
    v_add_f32 v96, v96, v100
    v_mfma_f32_16x16x32_bf16 v[40:43], a[232:235], a[44:47], v[40:43]
    v_add_f32 v89, v89, v93
    v_add_f32 v97, v97, v101
    v_mfma_f32_16x16x32_bf16 v[40:43], v[136:139], a[56:59], v[40:43]
    v_add_f32 v90, v90, v94
    v_add_f32 v98, v98, v102
    v_mfma_f32_16x16x32_bf16 v[40:43], v[152:155], a[68:71], v[40:43]
    v_add_f32 v91, v91, v95
    v_add_f32 v99, v99, v103
    v_mfma_f32_16x16x32_bf16 v[40:43], v[168:171], a[80:83], v[40:43]
    ds_write_b128 v17, v[36:39] offset:49152
    v_add_f32 v88, v88, v96
    v_mfma_f32_16x16x32_bf16 v[40:43], v[184:187], a[92:95], v[40:43]
    v_add_f32 v89, v89, v97
    v_add_f32 v90, v90, v98
    v_mfma_f32_16x16x32_bf16 v[40:43], v[200:203], a[104:107], v[40:43]
    v_add_f32 v91, v91, v99
    v_cvt_pk_bf16_f32 v124, v88, v89
    v_mfma_f32_16x16x32_bf16 v[40:43], v[216:219], a[116:119], v[40:43]
    v_cvt_pk_bf16_f32 v125, v90, v91
    v_mfma_f32_16x16x32_bf16 v[40:43], v[232:235], a[128:131], v[40:43]
    global_store_dwordx2 v15, v[124:125], s[38:39] sc1
    v_add_u32 v15, 0x80000, v15
    v_mfma_f32_16x16x32_bf16 v[40:43], v[248:251], a[140:143], v[40:43]
    v_mfma_f32_16x16x32_bf16 v[44:47], a[204:207], a[20:23], 0
    v_mfma_f32_16x16x32_bf16 v[44:47], a[220:223], a[32:35], v[44:47]
    v_mfma_f32_16x16x32_bf16 v[44:47], a[236:239], a[44:47], v[44:47]
    v_mfma_f32_16x16x32_bf16 v[44:47], v[140:143], a[56:59], v[44:47]
    v_mfma_f32_16x16x32_bf16 v[44:47], v[156:159], a[68:71], v[44:47]
    v_mfma_f32_16x16x32_bf16 v[44:47], v[172:175], a[80:83], v[44:47]
    s_nop 1
    ds_write_b128 v18, v[40:43] offset:49152
    v_mfma_f32_16x16x32_bf16 v[44:47], v[188:191], a[92:95], v[44:47]
    v_mfma_f32_16x16x32_bf16 v[44:47], v[204:207], a[104:107], v[44:47]
    v_mfma_f32_16x16x32_bf16 v[44:47], v[220:223], a[116:119], v[44:47]
    v_mfma_f32_16x16x32_bf16 v[44:47], v[236:239], a[128:131], v[44:47]
    v_mfma_f32_16x16x32_bf16 v[44:47], v[252:255], a[140:143], v[44:47]
    v_cmp_u_f32 vcc, v36, v36
    s_cbranch_vccnz L_rt3b
L_rtok3b:
    s_nop 5
    ds_write_b128 v19, v[44:47] offset:49152
    s_waitcnt lgkmcnt(0)
    s_barrier
    ds_read_b128 v[88:91], v14 offset:49152
    ds_read_b128 v[92:95], v14 offset:53248
    ds_read_b128 v[96:99], v14 offset:57344
    ds_read_b128 v[100:103], v14 offset:61440
    s_waitcnt lgkmcnt(2)
    v_pk_add_f32 v[88:89], v[88:89], v[92:93]
    v_pk_add_f32 v[90:91], v[90:91], v[94:95]
    s_waitcnt lgkmcnt(0)
    v_pk_add_f32 v[96:97], v[96:97], v[100:101]
    v_pk_add_f32 v[98:99], v[98:99], v[102:103]
    v_pk_add_f32 v[88:89], v[88:89], v[96:97]
    v_pk_add_f32 v[90:91], v[90:91], v[98:99]
    v_cvt_pk_bf16_f32 v126, v88, v89
    v_cvt_pk_bf16_f32 v127, v90, v91
    global_store_dwordx2 v15, v[126:127], s[38:39] sc1
L_fin:
L_end:
    s_endpgm
L_sw1r:
    s_add_u32 s59, s59, 1
    s_cmp_ge_u32 s59, 100000
    s_cbranch_scc1 L_sw1ok
    s_sleep 4
    s_mov_b64 exec, vcc
    global_load_dwordx4 v[32:35], v4, s[42:43] offset:0 sc1
    global_load_dwordx4 v[36:39], v4, s[42:43] offset:1024 sc1
    global_load_dwordx4 v[40:43], v4, s[42:43] offset:2048 sc1
    global_load_dwordx4 v[48:51], v5, s[42:43] offset:0 sc1
    global_load_dwordx4 v[52:55], v5, s[42:43] offset:1024 sc1
    global_load_dwordx4 v[56:59], v5, s[42:43] offset:2048 sc1
    global_load_dwordx4 v[60:63], v5, s[42:43] offset:3072 sc1
    s_mov_b64 exec, -1
    s_waitcnt vmcnt(0)
    s_branch L_sw1
L_f2r:
    s_mov_b32 s59, 0
L_f2r2:
    s_sleep 4
    s_mov_b64 exec, vcc
    global_load_dword v64, v94, s[42:43] sc1
    s_mov_b64 exec, -1
    s_waitcnt vmcnt(0)
    v_cmp_ne_u32 vcc, s52, v64
    s_add_u32 s59, s59, 1
    s_cmp_lt_u32 s59, 100000
    s_cselect_b64 vcc, vcc, 0
    s_cbranch_vccnz L_f2r2
    s_branch L_f2ok
L_h0r:
    s_add_u32 s59, s59, 1
    s_cmp_ge_u32 s59, 100000
    s_cbranch_scc1 L_h0ok
    s_sleep 4
    v_subrev_u32 v4, 0x80000, v4
    s_add_u32 m0, s12, 0
    s_nop 0
    global_load_lds_dwordx4 v4, s[42:43] offset:0 sc1
    global_load_lds_dwordx4 v4, s[42:43] offset:1024 sc1
    global_load_lds_dwordx4 v4, s[42:43] offset:2048 sc1
    global_load_lds_dwordx4 v4, s[42:43] offset:3072 sc1
    v_add_u32 v4, 4096, v4
    s_add_u32 m0, s12, 4096
    s_nop 0
    global_load_lds_dwordx4 v4, s[42:43] offset:0 sc1
    global_load_lds_dwordx4 v4, s[42:43] offset:1024 sc1
    global_load_lds_dwordx4 v4, s[42:43] offset:2048 sc1
    global_load_lds_dwordx4 v4, s[42:43] offset:3072 sc1
    v_add_u32 v4, 520192, v4
    s_mov_b64 exec, -1
    s_waitcnt vmcnt(0)
    s_branch L_h0
L_bump:
    v_mov_b32 v126, 0
    v_mov_b32 v127, s52
    s_mov_b64 exec, 1
    global_store_dword v126, v127, s[42:43] sc1
    s_mov_b64 exec, -1
    s_branch L_bumped
L_hot_end:
L_redo:
    s_add_u32 s61, s61, 1
    s_cmp_lt_u32 s61, 6250
    s_cbranch_scc1 L_redo2
    s_cmp_eq_u32 s3, 3
    s_cbranch_scc1 L_noredob
    s_branch L_noredoa
L_redo2:
    s_waitcnt vmcnt(0) lgkmcnt(0)
    s_barrier
    s_lshl_b32 s10, s56, 15
    s_lshl_b32 s12, s3, 13
    s_add_u32 s10, s10, s12
    s_add_u32 s10, s10, 5242880
    v_lshl_add_u32 v4, v1, 4, s10
    v_bfe_u32 v127, v1, 3, 3
    v_lshlrev_b32 v5, 7, v127
    v_bfe_u32 v127, v1, 2, 1
    v_lshl_add_u32 v5, v127, 5, v5
    v_and_b32 v127, 3, v1
    v_lshl_add_u32 v5, v127, 3, v5
    v_and_b32 v127, 1, v3
    v_lshl_add_u32 v5, v127, 6, v5
    v_xor_b32 v6, 64, v5
    s_lshr_b32 s10, s56, 1
    s_mul_i32 s10, s10, 720896
    s_and_b32 s11, s56, 1
    s_mul_i32 s11, s11, 90112
    s_add_u32 s10, s10, s11
    s_mul_i32 s11, s55, 2816
    s_add_u32 s10, s10, s11
    s_mul_i32 s11, s3, 768
    s_add_u32 s10, s10, s11
    s_add_u32 s10, s10, 12582912
    v_mul_u32_u24 v9, 45056, v127
    v_lshrrev_b32 v127, 1, v3
    v_lshl_add_u32 v9, v127, 8, v9
    v_lshl_add_u32 v9, v2, 4, v9
    v_add_u32 v9, s10, v9
    s_lshl_b32 s10, s57, 2
    s_add_u32 s10, s10, s3
    s_mul_i32 s10, s10, 45056
    s_add_u32 s10, s10, 10489856
    v_lshl_add_u32 v10, v1, 4, s10
    s_mov_b64 s[62:63], 0
    s_mul_i32 s10, s55, 11
    s_mul_i32 s11, s3, 3
    s_add_u32 s10, s10, s11
    s_lshl_b32 s11, s10, 14
    s_add_u32 s11, s11, 7344128
    v_lshl_add_u32 v122, v1, 4, s11
    v_add_u32 v123, 0x4000, v122
    v_add_u32 v124, 0x8000, v122
    v_mov_b32 v127, s11
    s_cmp_eq_u32 s3, 3
    s_cselect_b64 vcc, -1, 0
    v_cndmask_b32 v124, v124, v127, vcc
    s_lshl_b32 s10, s10, 10
    s_add_u32 s10, s10, 65536
    v_lshl_add_u32 v125, v1, 2, s10
    global_load_dwordx4 a[0:3], v122, s[42:43] offset:-4096 sc1
    global_load_dwordx4 a[4:7], v123, s[42:43] offset:-4096 sc1
    global_load_dwordx4 a[8:11], v124, s[42:43] offset:-4096 sc1
    global_load_dwordx4 a[12:15], v122, s[42:43] offset:-3072 sc1
    global_load_dwordx4 a[16:19], v123, s[42:43] offset:-3072 sc1
    global_load_dwordx4 a[20:23], v124, s[42:43] offset:-3072 sc1
    global_load_dwordx4 a[24:27], v122, s[42:43] offset:-2048 sc1
    global_load_dwordx4 a[28:31], v123, s[42:43] offset:-2048 sc1
    global_load_dwordx4 a[32:35], v124, s[42:43] offset:-2048 sc1
    global_load_dwordx4 a[36:39], v122, s[42:43] offset:-1024 sc1
    global_load_dwordx4 a[40:43], v123, s[42:43] offset:-1024 sc1
    global_load_dwordx4 a[44:47], v124, s[42:43] offset:-1024 sc1
    global_load_dwordx4 a[48:51], v122, s[42:43] offset:0 sc1
    global_load_dwordx4 a[52:55], v123, s[42:43] offset:0 sc1
    global_load_dwordx4 a[56:59], v124, s[42:43] offset:0 sc1
    global_load_dwordx4 a[60:63], v122, s[42:43] offset:1024 sc1
    global_load_dwordx4 a[64:67], v123, s[42:43] offset:1024 sc1
    global_load_dwordx4 a[68:71], v124, s[42:43] offset:1024 sc1
    global_load_dwordx4 a[72:75], v122, s[42:43] offset:2048 sc1
    global_load_dwordx4 a[76:79], v123, s[42:43] offset:2048 sc1
    global_load_dwordx4 a[80:83], v124, s[42:43] offset:2048 sc1
    global_load_dwordx4 a[84:87], v122, s[42:43] offset:3072 sc1
    global_load_dwordx4 a[88:91], v123, s[42:43] offset:3072 sc1
    global_load_dwordx4 a[92:95], v124, s[42:43] offset:3072 sc1
    v_add_u32 v122, 0x2000, v122
    v_add_u32 v123, 0x2000, v123
    v_add_u32 v124, 0x2000, v124
    global_load_dwordx4 a[96:99], v122, s[42:43] offset:-4096 sc1
    global_load_dwordx4 a[100:103], v123, s[42:43] offset:-4096 sc1
    global_load_dwordx4 a[104:107], v124, s[42:43] offset:-4096 sc1
    global_load_dwordx4 a[108:111], v122, s[42:43] offset:-3072 sc1
    global_load_dwordx4 a[112:115], v123, s[42:43] offset:-3072 sc1
    global_load_dwordx4 a[116:119], v124, s[42:43] offset:-3072 sc1
    global_load_dwordx4 a[120:123], v122, s[42:43] offset:-2048 sc1
    s_add_u32 m0, s12, 0
    s_nop 0
    global_load_lds_dwordx4 v4, s[42:43] offset:0 sc1
    global_load_lds_dwordx4 v4, s[42:43] offset:1024 sc1
    global_load_lds_dwordx4 v4, s[42:43] offset:2048 sc1
    global_load_lds_dwordx4 v4, s[42:43] offset:3072 sc1
    v_add_u32 v4, 4096, v4
    s_add_u32 m0, s12, 4096
    s_nop 0
    global_load_lds_dwordx4 v4, s[42:43] offset:0 sc1
    global_load_lds_dwordx4 v4, s[42:43] offset:1024 sc1
    global_load_lds_dwordx4 v4, s[42:43] offset:2048 sc1
    global_load_lds_dwordx4 v4, s[42:43] offset:3072 sc1
    v_add_u32 v4, 520192, v4
    v_lshlrev_b32 v104, 6, v0
    v_add_u32 v104, 294912, v104
    global_load_dword v105, v104, s[42:43] sc1
    s_waitcnt vmcnt(0)
    s_mov_b32 s59, 0
    s_branch L_h0
L_h2ra:
    s_mov_b32 s59, 0
L_h2la:
    s_sleep 2
    v_subrev_u32 v4, 0x80000, v4
    s_add_u32 m0, s12, 65536
    s_nop 0
    global_load_lds_dwordx4 v4, s[42:43] offset:0 sc1
    global_load_lds_dwordx4 v4, s[42:43] offset:1024 sc1
    global_load_lds_dwordx4 v4, s[42:43] offset:2048 sc1
    global_load_lds_dwordx4 v4, s[42:43] offset:3072 sc1
    v_add_u32 v4, 4096, v4
    s_add_u32 m0, s12, 69632
    s_nop 0
    global_load_lds_dwordx4 v4, s[42:43] offset:0 sc1
    global_load_lds_dwordx4 v4, s[42:43] offset:1024 sc1
    global_load_lds_dwordx4 v4, s[42:43] offset:2048 sc1
    global_load_lds_dwordx4 v4, s[42:43] offset:3072 sc1
    v_add_u32 v4, 520192, v4
    s_mov_b64 exec, -1
    s_waitcnt vmcnt(0)
    v_lshl_add_u32 v253, v2, 2, s12
    v_lshl_add_u32 v253, v1, 7, v253
    v_add_u32 v253, 0x10000, v253
    ds_read2_b32 v[254:255], v253 offset0:0 offset1:16
    s_waitcnt lgkmcnt(0)
    v_max_u32 v255, v254, v255
    v_cmp_eq_u32 vcc, -1, v255
    s_add_u32 s59, s59, 1
    s_cmp_lt_u32 s59, 100000
    s_cselect_b64 vcc, vcc, 0
    s_cbranch_vccnz L_h2la
    s_branch L_h2oka
L_rsra:
    s_add_u32 s59, s59, 1
    s_cmp_ge_u32 s59, 100000
    s_cbranch_scc1 L_rsoka
    v_lshl_add_u32 v4, v1, 4, s15
    s_add_u32 m0, s14, 0
    s_nop 0
    global_load_lds_dwordx4 v4, s[42:43] sc1
    v_add_u32 v4, 0x80000, v4
    s_add_u32 m0, s14, 1024
    s_nop 0
    global_load_lds_dwordx4 v4, s[42:43] sc1
    v_add_u32 v4, 0x80000, v4
    s_add_u32 m0, s14, 2048
    s_nop 0
    global_load_lds_dwordx4 v4, s[42:43] sc1
    v_add_u32 v4, 0x80000, v4
    s_add_u32 m0, s14, 3072
    s_nop 0
    global_load_lds_dwordx4 v4, s[42:43] sc1
    s_waitcnt vmcnt(0)
    ds_read_b64_tr_b16 v[88:89], v13 offset:0
    ds_read_b64_tr_b16 v[90:91], v13 offset:1024
    ds_read_b64_tr_b16 v[92:93], v13 offset:2048
    ds_read_b64_tr_b16 v[94:95], v13 offset:3072
    s_waitcnt lgkmcnt(0)
    s_branch L_rsa
L_flra:
    s_mov_b32 s59, 0
L_flr2a:
    s_sleep 4
    s_mov_b64 exec, vcc
    global_load_dword v105, v104, s[42:43] sc1
    s_mov_b64 exec, -1
    s_waitcnt vmcnt(0)
    v_cmp_ne_u32 vcc, s52, v105
    s_add_u32 s59, s59, 1
    s_cmp_lt_u32 s59, 100000
    s_cselect_b64 vcc, vcc, 0
    s_cbranch_vccnz L_flr2a
    s_branch L_floka
L_pc2a:
    s_mov_b32 s59, 0
L_pcl2a:
    s_mov_b64 exec, vcc
    global_load_dwordx4 a[132:135], v11, s[20:21] offset:-4096 sc1
    global_load_dwordx4 a[136:139], v11, s[20:21] offset:-3072 sc1
    global_load_dwordx4 a[144:147], v11, s[20:21] offset:-2048 sc1
    global_load_dwordx4 a[148:151], v11, s[20:21] offset:-1024 sc1
    global_load_dwordx4 a[156:159], v11, s[20:21] offset:0 sc1
    global_load_dwordx4 a[160:163], v11, s[20:21] offset:1024 sc1
    global_load_dwordx4 a[168:171], v11, s[20:21] offset:2048 sc1
    global_load_dwordx4 a[172:175], v11, s[20:21] offset:3072 sc1
    global_load_dwordx4 a[180:183], v12, s[20:21] offset:-4096 sc1
    global_load_dwordx4 a[184:187], v12, s[20:21] offset:-3072 sc1
    global_load_dwordx4 a[8:11], v12, s[20:21] offset:-2048 sc1
    s_mov_b64 exec, -1
    s_waitcnt vmcnt(0)
    v_accvgpr_read_b32 v20, a132
    v_accvgpr_read_b32 v21, a136
    v_accvgpr_read_b32 v22, a144
    v_accvgpr_read_b32 v23, a148
    v_accvgpr_read_b32 v24, a156
    v_accvgpr_read_b32 v25, a160
    v_accvgpr_read_b32 v26, a168
    v_accvgpr_read_b32 v27, a172
    v_accvgpr_read_b32 v28, a180
    v_accvgpr_read_b32 v29, a184
    v_accvgpr_read_b32 v30, a8
    v_max3_u32 v20, v20, v21, v22
    v_max3_u32 v23, v23, v24, v25
    v_max3_u32 v26, v26, v27, v28
    v_max3_u32 v20, v20, v29, v30
    v_max3_u32 v20, v20, v23, v26
    v_cmp_eq_u32 vcc, -1, v20
    s_add_u32 s59, s59, 1
    s_cmp_lt_u32 s59, 100000
    s_cselect_b64 vcc, vcc, 0
    s_cbranch_vccnz L_pcl2a
    s_branch L_pcok2a
L_pc3a:
    s_mov_b32 s59, 0
L_pcl3a:
    s_mov_b64 exec, vcc
    global_load_dwordx4 a[20:23], v11, s[22:23] offset:-4096 sc1
    global_load_dwordx4 a[32:35], v11, s[22:23] offset:-3072 sc1
    global_load_dwordx4 a[44:47], v11, s[22:23] offset:-2048 sc1
    global_load_dwordx4 a[56:59], v11, s[22:23] offset:-1024 sc1
    global_load_dwordx4 a[68:71], v11, s[22:23] offset:0 sc1
    global_load_dwordx4 a[80:83], v11, s[22:23] offset:1024 sc1
    global_load_dwordx4 a[92:95], v11, s[22:23] offset:2048 sc1
    global_load_dwordx4 a[104:107], v11, s[22:23] offset:3072 sc1
    global_load_dwordx4 a[116:119], v12, s[22:23] offset:-4096 sc1
    global_load_dwordx4 a[128:131], v12, s[22:23] offset:-3072 sc1
    global_load_dwordx4 a[140:143], v12, s[22:23] offset:-2048 sc1
    s_mov_b64 exec, -1
    s_waitcnt vmcnt(0)
    v_accvgpr_read_b32 v20, a20
    v_accvgpr_read_b32 v21, a32
    v_accvgpr_read_b32 v22, a44
    v_accvgpr_read_b32 v23, a56
    v_accvgpr_read_b32 v24, a68
    v_accvgpr_read_b32 v25, a80
    v_accvgpr_read_b32 v26, a92
    v_accvgpr_read_b32 v27, a104
    v_accvgpr_read_b32 v28, a116
    v_accvgpr_read_b32 v29, a128
    v_accvgpr_read_b32 v30, a140
    v_max3_u32 v20, v20, v21, v22
    v_max3_u32 v23, v23, v24, v25
    v_max3_u32 v26, v26, v27, v28
    v_max3_u32 v20, v20, v29, v30
    v_max3_u32 v20, v20, v23, v26
    v_cmp_eq_u32 vcc, -1, v20
    s_add_u32 s59, s59, 1
    s_cmp_lt_u32 s59, 100000
    s_cselect_b64 vcc, vcc, 0
    s_cbranch_vccnz L_pcl3a
    s_branch L_pcok3a
L_rt0a:
    s_waitcnt vmcnt(0) lgkmcnt(0)
    s_mov_b32 s59, 0
L_rtl0a:
    global_load_dwordx4 a[0:3], v11, s[16:17] offset:-4096 sc1
    global_load_dwordx4 a[4:7], v11, s[16:17] offset:-3072 sc1
    global_load_dwordx4 a[12:15], v11, s[16:17] offset:-2048 sc1
    global_load_dwordx4 a[16:19], v11, s[16:17] offset:-1024 sc1
    global_load_dwordx4 a[24:27], v11, s[16:17] offset:0 sc1
    global_load_dwordx4 a[28:31], v11, s[16:17] offset:1024 sc1
    global_load_dwordx4 a[36:39], v11, s[16:17] offset:2048 sc1
    global_load_dwordx4 a[40:43], v11, s[16:17] offset:3072 sc1
    global_load_dwordx4 a[96:99], v12, s[16:17] offset:-4096 sc1
    global_load_dwordx4 a[100:103], v12, s[16:17] offset:-3072 sc1
    global_load_dwordx4 a[108:111], v12, s[16:17] offset:-2048 sc1
    s_waitcnt vmcnt(10)
    v_mfma_f32_16x16x32_bf16 v[32:35], a[192:195], a[0:3], v[72:75]
    v_mfma_f32_16x16x32_bf16 v[36:39], a[196:199], a[0:3], 0
    v_mfma_f32_16x16x32_bf16 v[40:43], a[200:203], a[0:3], 0
    v_mfma_f32_16x16x32_bf16 v[44:47], a[204:207], a[0:3], 0
    s_waitcnt vmcnt(9)
    v_mfma_f32_16x16x32_bf16 v[32:35], a[208:211], a[4:7], v[32:35]
    v_mfma_f32_16x16x32_bf16 v[36:39], a[212:215], a[4:7], v[36:39]
    v_mfma_f32_16x16x32_bf16 v[40:43], a[216:219], a[4:7], v[40:43]
    v_mfma_f32_16x16x32_bf16 v[44:47], a[220:223], a[4:7], v[44:47]
    s_waitcnt vmcnt(8)
    v_mfma_f32_16x16x32_bf16 v[32:35], a[224:227], a[12:15], v[32:35]
    v_mfma_f32_16x16x32_bf16 v[36:39], a[228:231], a[12:15], v[36:39]
    v_mfma_f32_16x16x32_bf16 v[40:43], a[232:235], a[12:15], v[40:43]
    v_mfma_f32_16x16x32_bf16 v[44:47], a[236:239], a[12:15], v[44:47]
    s_waitcnt vmcnt(7)
    v_mfma_f32_16x16x32_bf16 v[32:35], v[128:131], a[16:19], v[32:35]
    v_mfma_f32_16x16x32_bf16 v[36:39], v[132:135], a[16:19], v[36:39]
    v_mfma_f32_16x16x32_bf16 v[40:43], v[136:139], a[16:19], v[40:43]
    v_mfma_f32_16x16x32_bf16 v[44:47], v[140:143], a[16:19], v[44:47]
    s_waitcnt vmcnt(6)
    v_mfma_f32_16x16x32_bf16 v[32:35], v[144:147], a[24:27], v[32:35]
    v_mfma_f32_16x16x32_bf16 v[36:39], v[148:151], a[24:27], v[36:39]
    v_mfma_f32_16x16x32_bf16 v[40:43], v[152:155], a[24:27], v[40:43]
    v_mfma_f32_16x16x32_bf16 v[44:47], v[156:159], a[24:27], v[44:47]
    s_waitcnt vmcnt(5)
    v_mfma_f32_16x16x32_bf16 v[32:35], v[160:163], a[28:31], v[32:35]
    v_mfma_f32_16x16x32_bf16 v[36:39], v[164:167], a[28:31], v[36:39]
    v_mfma_f32_16x16x32_bf16 v[40:43], v[168:171], a[28:31], v[40:43]
    v_mfma_f32_16x16x32_bf16 v[44:47], v[172:175], a[28:31], v[44:47]
    s_waitcnt vmcnt(4)
    v_mfma_f32_16x16x32_bf16 v[32:35], v[176:179], a[36:39], v[32:35]
    v_mfma_f32_16x16x32_bf16 v[36:39], v[180:183], a[36:39], v[36:39]
    v_mfma_f32_16x16x32_bf16 v[40:43], v[184:187], a[36:39], v[40:43]
    v_mfma_f32_16x16x32_bf16 v[44:47], v[188:191], a[36:39], v[44:47]
    s_waitcnt vmcnt(3)
    v_mfma_f32_16x16x32_bf16 v[32:35], v[192:195], a[40:43], v[32:35]
    v_mfma_f32_16x16x32_bf16 v[36:39], v[196:199], a[40:43], v[36:39]
    v_mfma_f32_16x16x32_bf16 v[40:43], v[200:203], a[40:43], v[40:43]
    v_mfma_f32_16x16x32_bf16 v[44:47], v[204:207], a[40:43], v[44:47]
    s_waitcnt vmcnt(2)
    v_mfma_f32_16x16x32_bf16 v[32:35], v[208:211], a[96:99], v[32:35]
    v_mfma_f32_16x16x32_bf16 v[36:39], v[212:215], a[96:99], v[36:39]
    v_mfma_f32_16x16x32_bf16 v[40:43], v[216:219], a[96:99], v[40:43]
    v_mfma_f32_16x16x32_bf16 v[44:47], v[220:223], a[96:99], v[44:47]
    s_waitcnt vmcnt(1)
    v_mfma_f32_16x16x32_bf16 v[32:35], v[224:227], a[100:103], v[32:35]
    v_mfma_f32_16x16x32_bf16 v[36:39], v[228:231], a[100:103], v[36:39]
    v_mfma_f32_16x16x32_bf16 v[40:43], v[232:235], a[100:103], v[40:43]
    v_mfma_f32_16x16x32_bf16 v[44:47], v[236:239], a[100:103], v[44:47]
    s_waitcnt vmcnt(0)
    v_mfma_f32_16x16x32_bf16 v[32:35], v[240:243], a[108:111], v[32:35]
    v_mfma_f32_16x16x32_bf16 v[36:39], v[244:247], a[108:111], v[36:39]
    v_mfma_f32_16x16x32_bf16 v[40:43], v[248:251], a[108:111], v[40:43]
    v_mfma_f32_16x16x32_bf16 v[44:47], v[252:255], a[108:111], v[44:47]
    s_nop 7
    v_cmp_u_f32 vcc, v44, v44
    s_add_u32 s59, s59, 1
    s_cmp_lt_u32 s59, 100000
    s_cselect_b64 vcc, vcc, 0
    s_cbranch_vccnz L_rtl0a
    s_branch L_rtok0a
L_rt1a:
    s_waitcnt vmcnt(0) lgkmcnt(0)
    s_mov_b32 s59, 0
L_rtl1a:
    global_load_dwordx4 a[48:51], v11, s[18:19] offset:-4096 sc1
    global_load_dwordx4 a[52:55], v11, s[18:19] offset:-3072 sc1
    global_load_dwordx4 a[60:63], v11, s[18:19] offset:-2048 sc1
    global_load_dwordx4 a[64:67], v11, s[18:19] offset:-1024 sc1
    global_load_dwordx4 a[72:75], v11, s[18:19] offset:0 sc1
    global_load_dwordx4 a[76:79], v11, s[18:19] offset:1024 sc1
    global_load_dwordx4 a[84:87], v11, s[18:19] offset:2048 sc1
    global_load_dwordx4 a[88:91], v11, s[18:19] offset:3072 sc1
    global_load_dwordx4 a[112:115], v12, s[18:19] offset:-4096 sc1
    global_load_dwordx4 a[120:123], v12, s[18:19] offset:-3072 sc1
    global_load_dwordx4 a[124:127], v12, s[18:19] offset:-2048 sc1
    s_waitcnt vmcnt(10)
    v_mfma_f32_16x16x32_bf16 v[48:51], a[192:195], a[48:51], v[76:79]
    v_mfma_f32_16x16x32_bf16 v[52:55], a[196:199], a[48:51], 0
    v_mfma_f32_16x16x32_bf16 v[56:59], a[200:203], a[48:51], 0
    v_mfma_f32_16x16x32_bf16 v[60:63], a[204:207], a[48:51], 0
    s_waitcnt vmcnt(9)
    v_mfma_f32_16x16x32_bf16 v[48:51], a[208:211], a[52:55], v[48:51]
    v_mfma_f32_16x16x32_bf16 v[52:55], a[212:215], a[52:55], v[52:55]
    v_mfma_f32_16x16x32_bf16 v[56:59], a[216:219], a[52:55], v[56:59]
    v_mfma_f32_16x16x32_bf16 v[60:63], a[220:223], a[52:55], v[60:63]
    s_waitcnt vmcnt(8)
    v_mfma_f32_16x16x32_bf16 v[48:51], a[224:227], a[60:63], v[48:51]
    v_mfma_f32_16x16x32_bf16 v[52:55], a[228:231], a[60:63], v[52:55]
    v_mfma_f32_16x16x32_bf16 v[56:59], a[232:235], a[60:63], v[56:59]
    v_mfma_f32_16x16x32_bf16 v[60:63], a[236:239], a[60:63], v[60:63]
    s_waitcnt vmcnt(7)
    v_mfma_f32_16x16x32_bf16 v[48:51], v[128:131], a[64:67], v[48:51]
    v_mfma_f32_16x16x32_bf16 v[52:55], v[132:135], a[64:67], v[52:55]
    v_mfma_f32_16x16x32_bf16 v[56:59], v[136:139], a[64:67], v[56:59]
    v_mfma_f32_16x16x32_bf16 v[60:63], v[140:143], a[64:67], v[60:63]
    s_waitcnt vmcnt(6)
    v_mfma_f32_16x16x32_bf16 v[48:51], v[144:147], a[72:75], v[48:51]
    v_mfma_f32_16x16x32_bf16 v[52:55], v[148:151], a[72:75], v[52:55]
    v_mfma_f32_16x16x32_bf16 v[56:59], v[152:155], a[72:75], v[56:59]
    v_mfma_f32_16x16x32_bf16 v[60:63], v[156:159], a[72:75], v[60:63]
    s_waitcnt vmcnt(5)
    v_mfma_f32_16x16x32_bf16 v[48:51], v[160:163], a[76:79], v[48:51]
    v_mfma_f32_16x16x32_bf16 v[52:55], v[164:167], a[76:79], v[52:55]
    v_mfma_f32_16x16x32_bf16 v[56:59], v[168:171], a[76:79], v[56:59]
    v_mfma_f32_16x16x32_bf16 v[60:63], v[172:175], a[76:79], v[60:63]
    s_waitcnt vmcnt(4)
    v_mfma_f32_16x16x32_bf16 v[48:51], v[176:179], a[84:87], v[48:51]
    v_mfma_f32_16x16x32_bf16 v[52:55], v[180:183], a[84:87], v[52:55]
    v_mfma_f32_16x16x32_bf16 v[56:59], v[184:187], a[84:87], v[56:59]
    v_mfma_f32_16x16x32_bf16 v[60:63], v[188:191], a[84:87], v[60:63]
    s_waitcnt vmcnt(3)
    v_mfma_f32_16x16x32_bf16 v[48:51], v[192:195], a[88:91], v[48:51]
    v_mfma_f32_16x16x32_bf16 v[52:55], v[196:199], a[88:91], v[52:55]
    v_mfma_f32_16x16x32_bf16 v[56:59], v[200:203], a[88:91], v[56:59]
    v_mfma_f32_16x16x32_bf16 v[60:63], v[204:207], a[88:91], v[60:63]
    s_waitcnt vmcnt(2)
    v_mfma_f32_16x16x32_bf16 v[48:51], v[208:211], a[112:115], v[48:51]
    v_mfma_f32_16x16x32_bf16 v[52:55], v[212:215], a[112:115], v[52:55]
    v_mfma_f32_16x16x32_bf16 v[56:59], v[216:219], a[112:115], v[56:59]
    v_mfma_f32_16x16x32_bf16 v[60:63], v[220:223], a[112:115], v[60:63]
    s_waitcnt vmcnt(1)
    v_mfma_f32_16x16x32_bf16 v[48:51], v[224:227], a[120:123], v[48:51]
    v_mfma_f32_16x16x32_bf16 v[52:55], v[228:231], a[120:123], v[52:55]
    v_mfma_f32_16x16x32_bf16 v[56:59], v[232:235], a[120:123], v[56:59]
    v_mfma_f32_16x16x32_bf16 v[60:63], v[236:239], a[120:123], v[60:63]
    s_waitcnt vmcnt(0)
    v_mfma_f32_16x16x32_bf16 v[48:51], v[240:243], a[124:127], v[48:51]
    v_mfma_f32_16x16x32_bf16 v[52:55], v[244:247], a[124:127], v[52:55]
    v_mfma_f32_16x16x32_bf16 v[56:59], v[248:251], a[124:127], v[56:59]
    v_mfma_f32_16x16x32_bf16 v[60:63], v[252:255], a[124:127], v[60:63]
    s_nop 7
    v_cmp_u_f32 vcc, v60, v60
    s_add_u32 s59, s59, 1
    s_cmp_lt_u32 s59, 100000
    s_cselect_b64 vcc, vcc, 0
    s_cbranch_vccnz L_rtl1a
    s_branch L_rtok1a
L_rt2a:
    s_waitcnt vmcnt(0) lgkmcnt(0)
    s_mov_b32 s59, 0
L_rtl2a:
    global_load_dwordx4 a[132:135], v11, s[20:21] offset:-4096 sc1
    global_load_dwordx4 a[136:139], v11, s[20:21] offset:-3072 sc1
    global_load_dwordx4 a[144:147], v11, s[20:21] offset:-2048 sc1
    global_load_dwordx4 a[148:151], v11, s[20:21] offset:-1024 sc1
    global_load_dwordx4 a[156:159], v11, s[20:21] offset:0 sc1
    global_load_dwordx4 a[160:163], v11, s[20:21] offset:1024 sc1
    global_load_dwordx4 a[168:171], v11, s[20:21] offset:2048 sc1
    global_load_dwordx4 a[172:175], v11, s[20:21] offset:3072 sc1
    global_load_dwordx4 a[180:183], v12, s[20:21] offset:-4096 sc1
    global_load_dwordx4 a[184:187], v12, s[20:21] offset:-3072 sc1
    global_load_dwordx4 a[8:11], v12, s[20:21] offset:-2048 sc1
    s_waitcnt vmcnt(10)
    v_mfma_f32_16x16x32_bf16 v[104:107], a[192:195], a[132:135], v[80:83]
    v_mfma_f32_16x16x32_bf16 v[108:111], a[196:199], a[132:135], 0
    v_mfma_f32_16x16x32_bf16 v[112:115], a[200:203], a[132:135], 0
    v_mfma_f32_16x16x32_bf16 v[116:119], a[204:207], a[132:135], 0
    s_waitcnt vmcnt(9)
    v_mfma_f32_16x16x32_bf16 v[104:107], a[208:211], a[136:139], v[104:107]
    v_mfma_f32_16x16x32_bf16 v[108:111], a[212:215], a[136:139], v[108:111]
    v_mfma_f32_16x16x32_bf16 v[112:115], a[216:219], a[136:139], v[112:115]
    v_mfma_f32_16x16x32_bf16 v[116:119], a[220:223], a[136:139], v[116:119]
    s_waitcnt vmcnt(8)
    v_mfma_f32_16x16x32_bf16 v[104:107], a[224:227], a[144:147], v[104:107]
    v_mfma_f32_16x16x32_bf16 v[108:111], a[228:231], a[144:147], v[108:111]
    v_mfma_f32_16x16x32_bf16 v[112:115], a[232:235], a[144:147], v[112:115]
    v_mfma_f32_16x16x32_bf16 v[116:119], a[236:239], a[144:147], v[116:119]
    s_waitcnt vmcnt(7)
    v_mfma_f32_16x16x32_bf16 v[104:107], v[128:131], a[148:151], v[104:107]
    v_mfma_f32_16x16x32_bf16 v[108:111], v[132:135], a[148:151], v[108:111]
    v_mfma_f32_16x16x32_bf16 v[112:115], v[136:139], a[148:151], v[112:115]
    v_mfma_f32_16x16x32_bf16 v[116:119], v[140:143], a[148:151], v[116:119]
    s_waitcnt vmcnt(6)
    v_mfma_f32_16x16x32_bf16 v[104:107], v[144:147], a[156:159], v[104:107]
    v_mfma_f32_16x16x32_bf16 v[108:111], v[148:151], a[156:159], v[108:111]
    v_mfma_f32_16x16x32_bf16 v[112:115], v[152:155], a[156:159], v[112:115]
    v_mfma_f32_16x16x32_bf16 v[116:119], v[156:159], a[156:159], v[116:119]
    s_waitcnt vmcnt(5)
    v_mfma_f32_16x16x32_bf16 v[104:107], v[160:163], a[160:163], v[104:107]
    v_mfma_f32_16x16x32_bf16 v[108:111], v[164:167], a[160:163], v[108:111]
    v_mfma_f32_16x16x32_bf16 v[112:115], v[168:171], a[160:163], v[112:115]
    v_mfma_f32_16x16x32_bf16 v[116:119], v[172:175], a[160:163], v[116:119]
    s_waitcnt vmcnt(4)
    v_mfma_f32_16x16x32_bf16 v[104:107], v[176:179], a[168:171], v[104:107]
    v_mfma_f32_16x16x32_bf16 v[108:111], v[180:183], a[168:171], v[108:111]
    v_mfma_f32_16x16x32_bf16 v[112:115], v[184:187], a[168:171], v[112:115]
    v_mfma_f32_16x16x32_bf16 v[116:119], v[188:191], a[168:171], v[116:119]
    s_waitcnt vmcnt(3)
    v_mfma_f32_16x16x32_bf16 v[104:107], v[192:195], a[172:175], v[104:107]
    v_mfma_f32_16x16x32_bf16 v[108:111], v[196:199], a[172:175], v[108:111]
    v_mfma_f32_16x16x32_bf16 v[112:115], v[200:203], a[172:175], v[112:115]
    v_mfma_f32_16x16x32_bf16 v[116:119], v[204:207], a[172:175], v[116:119]
    s_waitcnt vmcnt(2)
    v_mfma_f32_16x16x32_bf16 v[104:107], v[208:211], a[180:183], v[104:107]
    v_mfma_f32_16x16x32_bf16 v[108:111], v[212:215], a[180:183], v[108:111]
    v_mfma_f32_16x16x32_bf16 v[112:115], v[216:219], a[180:183], v[112:115]
    v_mfma_f32_16x16x32_bf16 v[116:119], v[220:223], a[180:183], v[116:119]
    s_waitcnt vmcnt(1)
    v_mfma_f32_16x16x32_bf16 v[104:107], v[224:227], a[184:187], v[104:107]
    v_mfma_f32_16x16x32_bf16 v[108:111], v[228:231], a[184:187], v[108:111]
    v_mfma_f32_16x16x32_bf16 v[112:115], v[232:235], a[184:187], v[112:115]
    v_mfma_f32_16x16x32_bf16 v[116:119], v[236:239], a[184:187], v[116:119]
    s_waitcnt vmcnt(0)
    v_mfma_f32_16x16x32_bf16 v[104:107], v[240:243], a[8:11], v[104:107]
    v_mfma_f32_16x16x32_bf16 v[108:111], v[244:247], a[8:11], v[108:111]
    v_mfma_f32_16x16x32_bf16 v[112:115], v[248:251], a[8:11], v[112:115]
    v_mfma_f32_16x16x32_bf16 v[116:119], v[252:255], a[8:11], v[116:119]
    s_nop 7
    v_cmp_u_f32 vcc, v116, v116
    s_add_u32 s59, s59, 1
    s_cmp_lt_u32 s59, 100000
    s_cselect_b64 vcc, vcc, 0
    s_cbranch_vccnz L_rtl2a
    s_branch L_rtok2a
L_rt3a:
    s_waitcnt vmcnt(0) lgkmcnt(0)
    s_mov_b32 s59, 0
L_rtl3a:
    global_load_dwordx4 a[20:23], v11, s[22:23] offset:-4096 sc1
    global_load_dwordx4 a[32:35], v11, s[22:23] offset:-3072 sc1
    global_load_dwordx4 a[44:47], v11, s[22:23] offset:-2048 sc1
    global_load_dwordx4 a[56:59], v11, s[22:23] offset:-1024 sc1
    global_load_dwordx4 a[68:71], v11, s[22:23] offset:0 sc1
    global_load_dwordx4 a[80:83], v11, s[22:23] offset:1024 sc1
    global_load_dwordx4 a[92:95], v11, s[22:23] offset:2048 sc1
    global_load_dwordx4 a[104:107], v11, s[22:23] offset:3072 sc1
    global_load_dwordx4 a[116:119], v12, s[22:23] offset:-4096 sc1
    global_load_dwordx4 a[128:131], v12, s[22:23] offset:-3072 sc1
    global_load_dwordx4 a[140:143], v12, s[22:23] offset:-2048 sc1
    s_waitcnt vmcnt(10)
    v_mfma_f32_16x16x32_bf16 v[32:35], a[192:195], a[20:23], v[84:87]
    v_mfma_f32_16x16x32_bf16 v[36:39], a[196:199], a[20:23], 0
    v_mfma_f32_16x16x32_bf16 v[40:43], a[200:203], a[20:23], 0
    v_mfma_f32_16x16x32_bf16 v[44:47], a[204:207], a[20:23], 0
    s_waitcnt vmcnt(9)
    v_mfma_f32_16x16x32_bf16 v[32:35], a[208:211], a[32:35], v[32:35]
    v_mfma_f32_16x16x32_bf16 v[36:39], a[212:215], a[32:35], v[36:39]
    v_mfma_f32_16x16x32_bf16 v[40:43], a[216:219], a[32:35], v[40:43]
    v_mfma_f32_16x16x32_bf16 v[44:47], a[220:223], a[32:35], v[44:47]
    s_waitcnt vmcnt(8)
    v_mfma_f32_16x16x32_bf16 v[32:35], a[224:227], a[44:47], v[32:35]
    v_mfma_f32_16x16x32_bf16 v[36:39], a[228:231], a[44:47], v[36:39]
    v_mfma_f32_16x16x32_bf16 v[40:43], a[232:235], a[44:47], v[40:43]
    v_mfma_f32_16x16x32_bf16 v[44:47], a[236:239], a[44:47], v[44:47]
    s_waitcnt vmcnt(7)
    v_mfma_f32_16x16x32_bf16 v[32:35], v[128:131], a[56:59], v[32:35]
    v_mfma_f32_16x16x32_bf16 v[36:39], v[132:135], a[56:59], v[36:39]
    v_mfma_f32_16x16x32_bf16 v[40:43], v[136:139], a[56:59], v[40:43]
    v_mfma_f32_16x16x32_bf16 v[44:47], v[140:143], a[56:59], v[44:47]
    s_waitcnt vmcnt(6)
    v_mfma_f32_16x16x32_bf16 v[32:35], v[144:147], a[68:71], v[32:35]
    v_mfma_f32_16x16x32_bf16 v[36:39], v[148:151], a[68:71], v[36:39]
    v_mfma_f32_16x16x32_bf16 v[40:43], v[152:155], a[68:71], v[40:43]
    v_mfma_f32_16x16x32_bf16 v[44:47], v[156:159], a[68:71], v[44:47]
    s_waitcnt vmcnt(5)
    v_mfma_f32_16x16x32_bf16 v[32:35], v[160:163], a[80:83], v[32:35]
    v_mfma_f32_16x16x32_bf16 v[36:39], v[164:167], a[80:83], v[36:39]
    v_mfma_f32_16x16x32_bf16 v[40:43], v[168:171], a[80:83], v[40:43]
    v_mfma_f32_16x16x32_bf16 v[44:47], v[172:175], a[80:83], v[44:47]
    s_waitcnt vmcnt(4)
    v_mfma_f32_16x16x32_bf16 v[32:35], v[176:179], a[92:95], v[32:35]
    v_mfma_f32_16x16x32_bf16 v[36:39], v[180:183], a[92:95], v[36:39]
    v_mfma_f32_16x16x32_bf16 v[40:43], v[184:187], a[92:95], v[40:43]
    v_mfma_f32_16x16x32_bf16 v[44:47], v[188:191], a[92:95], v[44:47]
    s_waitcnt vmcnt(3)
    v_mfma_f32_16x16x32_bf16 v[32:35], v[192:195], a[104:107], v[32:35]
    v_mfma_f32_16x16x32_bf16 v[36:39], v[196:199], a[104:107], v[36:39]
    v_mfma_f32_16x16x32_bf16 v[40:43], v[200:203], a[104:107], v[40:43]
    v_mfma_f32_16x16x32_bf16 v[44:47], v[204:207], a[104:107], v[44:47]
    s_waitcnt vmcnt(2)
    v_mfma_f32_16x16x32_bf16 v[32:35], v[208:211], a[116:119], v[32:35]
    v_mfma_f32_16x16x32_bf16 v[36:39], v[212:215], a[116:119], v[36:39]
    v_mfma_f32_16x16x32_bf16 v[40:43], v[216:219], a[116:119], v[40:43]
    v_mfma_f32_16x16x32_bf16 v[44:47], v[220:223], a[116:119], v[44:47]
    s_waitcnt vmcnt(1)
    v_mfma_f32_16x16x32_bf16 v[32:35], v[224:227], a[128:131], v[32:35]
    v_mfma_f32_16x16x32_bf16 v[36:39], v[228:231], a[128:131], v[36:39]
    v_mfma_f32_16x16x32_bf16 v[40:43], v[232:235], a[128:131], v[40:43]
    v_mfma_f32_16x16x32_bf16 v[44:47], v[236:239], a[128:131], v[44:47]
    s_waitcnt vmcnt(0)
    v_mfma_f32_16x16x32_bf16 v[32:35], v[240:243], a[140:143], v[32:35]
    v_mfma_f32_16x16x32_bf16 v[36:39], v[244:247], a[140:143], v[36:39]
    v_mfma_f32_16x16x32_bf16 v[40:43], v[248:251], a[140:143], v[40:43]
    v_mfma_f32_16x16x32_bf16 v[44:47], v[252:255], a[140:143], v[44:47]
    s_nop 7
    v_cmp_u_f32 vcc, v44, v44
    s_add_u32 s59, s59, 1
    s_cmp_lt_u32 s59, 100000
    s_cselect_b64 vcc, vcc, 0
    s_cbranch_vccnz L_rtl3a
    ds_write_b128 v16, v[32:35] offset:49152
    ds_write_b128 v17, v[36:39] offset:49152
    ds_write_b128 v18, v[40:43] offset:49152
    s_branch L_rtok3a
L_h2rb:
    s_mov_b32 s59, 0
L_h2lb:
    s_sleep 2
    v_subrev_u32 v4, 0x80000, v4
    s_add_u32 m0, s12, 65536
    s_nop 0
    global_load_lds_dwordx4 v4, s[42:43] offset:0 sc1
    global_load_lds_dwordx4 v4, s[42:43] offset:1024 sc1
    global_load_lds_dwordx4 v4, s[42:43] offset:2048 sc1
    global_load_lds_dwordx4 v4, s[42:43] offset:3072 sc1
    v_add_u32 v4, 4096, v4
    s_add_u32 m0, s12, 69632
    s_nop 0
    global_load_lds_dwordx4 v4, s[42:43] offset:0 sc1
    global_load_lds_dwordx4 v4, s[42:43] offset:1024 sc1
    global_load_lds_dwordx4 v4, s[42:43] offset:2048 sc1
    global_load_lds_dwordx4 v4, s[42:43] offset:3072 sc1
    v_add_u32 v4, 520192, v4
    s_mov_b64 exec, -1
    s_waitcnt vmcnt(0)
    v_lshl_add_u32 v253, v2, 2, s12
    v_lshl_add_u32 v253, v1, 7, v253
    v_add_u32 v253, 0x10000, v253
    ds_read2_b32 v[254:255], v253 offset0:0 offset1:16
    s_waitcnt lgkmcnt(0)
    v_max_u32 v255, v254, v255
    v_cmp_eq_u32 vcc, -1, v255
    s_add_u32 s59, s59, 1
    s_cmp_lt_u32 s59, 100000
    s_cselect_b64 vcc, vcc, 0
    s_cbranch_vccnz L_h2lb
    s_branch L_h2okb
L_rsrb:
    s_add_u32 s59, s59, 1
    s_cmp_ge_u32 s59, 100000
    s_cbranch_scc1 L_rsokb
    v_lshl_add_u32 v4, v1, 4, s15
    s_add_u32 m0, s14, 0
    s_nop 0
    global_load_lds_dwordx4 v4, s[42:43] sc1
    v_add_u32 v4, 0x80000, v4
    s_add_u32 m0, s14, 1024
    s_nop 0
    global_load_lds_dwordx4 v4, s[42:43] sc1
    v_add_u32 v4, 0x80000, v4
    s_add_u32 m0, s14, 2048
    s_nop 0
    global_load_lds_dwordx4 v4, s[42:43] sc1
    v_add_u32 v4, 0x80000, v4
    s_add_u32 m0, s14, 3072
    s_nop 0
    global_load_lds_dwordx4 v4, s[42:43] sc1
    s_waitcnt vmcnt(0)
    ds_read_b64_tr_b16 v[88:89], v13 offset:0
    ds_read_b64_tr_b16 v[90:91], v13 offset:1024
    ds_read_b64_tr_b16 v[92:93], v13 offset:2048
    ds_read_b64_tr_b16 v[94:95], v13 offset:3072
    s_waitcnt lgkmcnt(0)
    s_branch L_rsb
L_flrb:
    s_mov_b32 s59, 0
L_flr2b:
    s_sleep 4
    s_mov_b64 exec, vcc
    global_load_dword v105, v104, s[42:43] sc1
    s_mov_b64 exec, -1
    s_waitcnt vmcnt(0)
    v_cmp_ne_u32 vcc, s52, v105
    s_add_u32 s59, s59, 1
    s_cmp_lt_u32 s59, 100000
    s_cselect_b64 vcc, vcc, 0
    s_cbranch_vccnz L_flr2b
    s_branch L_flokb
L_pc2b:
    s_mov_b32 s59, 0
L_pcl2b:
    s_mov_b64 exec, vcc
    global_load_dwordx4 a[132:135], v11, s[20:21] offset:-4096 sc1
    global_load_dwordx4 a[136:139], v11, s[20:21] offset:-3072 sc1
    global_load_dwordx4 a[144:147], v11, s[20:21] offset:-2048 sc1
    global_load_dwordx4 a[148:151], v11, s[20:21] offset:-1024 sc1
    global_load_dwordx4 a[156:159], v11, s[20:21] offset:0 sc1
    global_load_dwordx4 a[160:163], v11, s[20:21] offset:1024 sc1
    global_load_dwordx4 a[168:171], v11, s[20:21] offset:2048 sc1
    global_load_dwordx4 a[172:175], v11, s[20:21] offset:3072 sc1
    global_load_dwordx4 a[180:183], v12, s[20:21] offset:-4096 sc1
    global_load_dwordx4 a[184:187], v12, s[20:21] offset:-3072 sc1
    global_load_dwordx4 a[8:11], v12, s[20:21] offset:-2048 sc1
    s_mov_b64 exec, -1
    s_waitcnt vmcnt(0)
    v_accvgpr_read_b32 v20, a132
    v_accvgpr_read_b32 v21, a136
    v_accvgpr_read_b32 v22, a144
    v_accvgpr_read_b32 v23, a148
    v_accvgpr_read_b32 v24, a156
    v_accvgpr_read_b32 v25, a160
    v_accvgpr_read_b32 v26, a168
    v_accvgpr_read_b32 v27, a172
    v_accvgpr_read_b32 v28, a180
    v_accvgpr_read_b32 v29, a184
    v_accvgpr_read_b32 v30, a8
    v_max3_u32 v20, v20, v21, v22
    v_max3_u32 v23, v23, v24, v25
    v_max3_u32 v26, v26, v27, v28
    v_max3_u32 v20, v20, v29, v30
    v_max3_u32 v20, v20, v23, v26
    v_cmp_eq_u32 vcc, -1, v20
    s_add_u32 s59, s59, 1
    s_cmp_lt_u32 s59, 100000
    s_cselect_b64 vcc, vcc, 0
    s_cbranch_vccnz L_pcl2b
    s_branch L_pcok2b
L_pc3b:
    s_mov_b32 s59, 0
L_pcl3b:
    s_mov_b64 exec, vcc
    global_load_dwordx4 a[20:23], v11, s[22:23] offset:-4096 sc1
    global_load_dwordx4 a[32:35], v11, s[22:23] offset:-3072 sc1
    global_load_dwordx4 a[44:47], v11, s[22:23] offset:-2048 sc1
    global_load_dwordx4 a[56:59], v11, s[22:23] offset:-1024 sc1
    global_load_dwordx4 a[68:71], v11, s[22:23] offset:0 sc1
    global_load_dwordx4 a[80:83], v11, s[22:23] offset:1024 sc1
    global_load_dwordx4 a[92:95], v11, s[22:23] offset:2048 sc1
    global_load_dwordx4 a[104:107], v11, s[22:23] offset:3072 sc1
    global_load_dwordx4 a[116:119], v12, s[22:23] offset:-4096 sc1
    global_load_dwordx4 a[128:131], v12, s[22:23] offset:-3072 sc1
    global_load_dwordx4 a[140:143], v12, s[22:23] offset:-2048 sc1
    s_mov_b64 exec, -1
    s_waitcnt vmcnt(0)
    v_accvgpr_read_b32 v20, a20
    v_accvgpr_read_b32 v21, a32
    v_accvgpr_read_b32 v22, a44
    v_accvgpr_read_b32 v23, a56
    v_accvgpr_read_b32 v24, a68
    v_accvgpr_read_b32 v25, a80
    v_accvgpr_read_b32 v26, a92
    v_accvgpr_read_b32 v27, a104
    v_accvgpr_read_b32 v28, a116
    v_accvgpr_read_b32 v29, a128
    v_accvgpr_read_b32 v30, a140
    v_max3_u32 v20, v20, v21, v22
    v_max3_u32 v23, v23, v24, v25
    v_max3_u32 v26, v26, v27, v28
    v_max3_u32 v20, v20, v29, v30
    v_max3_u32 v20, v20, v23, v26
    v_cmp_eq_u32 vcc, -1, v20
    s_add_u32 s59, s59, 1
    s_cmp_lt_u32 s59, 100000
    s_cselect_b64 vcc, vcc, 0
    s_cbranch_vccnz L_pcl3b
    s_branch L_pcok3b
L_rt0b:
    s_waitcnt vmcnt(0) lgkmcnt(0)
    s_mov_b32 s59, 0
L_rtl0b:
    global_load_dwordx4 a[0:3], v11, s[16:17] offset:-4096 sc1
    global_load_dwordx4 a[4:7], v11, s[16:17] offset:-3072 sc1
    global_load_dwordx4 a[12:15], v11, s[16:17] offset:-2048 sc1
    global_load_dwordx4 a[16:19], v11, s[16:17] offset:-1024 sc1
    global_load_dwordx4 a[24:27], v11, s[16:17] offset:0 sc1
    global_load_dwordx4 a[28:31], v11, s[16:17] offset:1024 sc1
    global_load_dwordx4 a[36:39], v11, s[16:17] offset:2048 sc1
    global_load_dwordx4 a[40:43], v11, s[16:17] offset:3072 sc1
    global_load_dwordx4 a[96:99], v12, s[16:17] offset:-4096 sc1
    global_load_dwordx4 a[100:103], v12, s[16:17] offset:-3072 sc1
    global_load_dwordx4 a[108:111], v12, s[16:17] offset:-2048 sc1
    s_waitcnt vmcnt(10)
    v_mfma_f32_16x16x32_bf16 v[32:35], a[192:195], a[0:3], v[72:75]
    v_mfma_f32_16x16x32_bf16 v[36:39], a[196:199], a[0:3], 0
    v_mfma_f32_16x16x32_bf16 v[40:43], a[200:203], a[0:3], 0
    v_mfma_f32_16x16x32_bf16 v[44:47], a[204:207], a[0:3], 0
    s_waitcnt vmcnt(9)
    v_mfma_f32_16x16x32_bf16 v[32:35], a[208:211], a[4:7], v[32:35]
    v_mfma_f32_16x16x32_bf16 v[36:39], a[212:215], a[4:7], v[36:39]
    v_mfma_f32_16x16x32_bf16 v[40:43], a[216:219], a[4:7], v[40:43]
    v_mfma_f32_16x16x32_bf16 v[44:47], a[220:223], a[4:7], v[44:47]
    s_waitcnt vmcnt(8)
    v_mfma_f32_16x16x32_bf16 v[32:35], a[224:227], a[12:15], v[32:35]
    v_mfma_f32_16x16x32_bf16 v[36:39], a[228:231], a[12:15], v[36:39]
    v_mfma_f32_16x16x32_bf16 v[40:43], a[232:235], a[12:15], v[40:43]
    v_mfma_f32_16x16x32_bf16 v[44:47], a[236:239], a[12:15], v[44:47]
    s_waitcnt vmcnt(7)
    v_mfma_f32_16x16x32_bf16 v[32:35], v[128:131], a[16:19], v[32:35]
    v_mfma_f32_16x16x32_bf16 v[36:39], v[132:135], a[16:19], v[36:39]
    v_mfma_f32_16x16x32_bf16 v[40:43], v[136:139], a[16:19], v[40:43]
    v_mfma_f32_16x16x32_bf16 v[44:47], v[140:143], a[16:19], v[44:47]
    s_waitcnt vmcnt(6)
    v_mfma_f32_16x16x32_bf16 v[32:35], v[144:147], a[24:27], v[32:35]
    v_mfma_f32_16x16x32_bf16 v[36:39], v[148:151], a[24:27], v[36:39]
    v_mfma_f32_16x16x32_bf16 v[40:43], v[152:155], a[24:27], v[40:43]
    v_mfma_f32_16x16x32_bf16 v[44:47], v[156:159], a[24:27], v[44:47]
    s_waitcnt vmcnt(5)
    v_mfma_f32_16x16x32_bf16 v[32:35], v[160:163], a[28:31], v[32:35]
    v_mfma_f32_16x16x32_bf16 v[36:39], v[164:167], a[28:31], v[36:39]
    v_mfma_f32_16x16x32_bf16 v[40:43], v[168:171], a[28:31], v[40:43]
    v_mfma_f32_16x16x32_bf16 v[44:47], v[172:175], a[28:31], v[44:47]
    s_waitcnt vmcnt(4)
    v_mfma_f32_16x16x32_bf16 v[32:35], v[176:179], a[36:39], v[32:35]
    v_mfma_f32_16x16x32_bf16 v[36:39], v[180:183], a[36:39], v[36:39]
    v_mfma_f32_16x16x32_bf16 v[40:43], v[184:187], a[36:39], v[40:43]
    v_mfma_f32_16x16x32_bf16 v[44:47], v[188:191], a[36:39], v[44:47]
    s_waitcnt vmcnt(3)
    v_mfma_f32_16x16x32_bf16 v[32:35], v[192:195], a[40:43], v[32:35]
    v_mfma_f32_16x16x32_bf16 v[36:39], v[196:199], a[40:43], v[36:39]
    v_mfma_f32_16x16x32_bf16 v[40:43], v[200:203], a[40:43], v[40:43]
    v_mfma_f32_16x16x32_bf16 v[44:47], v[204:207], a[40:43], v[44:47]
    s_waitcnt vmcnt(2)
    v_mfma_f32_16x16x32_bf16 v[32:35], v[208:211], a[96:99], v[32:35]
    v_mfma_f32_16x16x32_bf16 v[36:39], v[212:215], a[96:99], v[36:39]
    v_mfma_f32_16x16x32_bf16 v[40:43], v[216:219], a[96:99], v[40:43]
    v_mfma_f32_16x16x32_bf16 v[44:47], v[220:223], a[96:99], v[44:47]
    s_waitcnt vmcnt(1)
    v_mfma_f32_16x16x32_bf16 v[32:35], v[224:227], a[100:103], v[32:35]
    v_mfma_f32_16x16x32_bf16 v[36:39], v[228:231], a[100:103], v[36:39]
    v_mfma_f32_16x16x32_bf16 v[40:43], v[232:235], a[100:103], v[40:43]
    v_mfma_f32_16x16x32_bf16 v[44:47], v[236:239], a[100:103], v[44:47]
    s_waitcnt vmcnt(0)
    v_mfma_f32_16x16x32_bf16 v[32:35], v[240:243], a[108:111], v[32:35]
    v_mfma_f32_16x16x32_bf16 v[36:39], v[244:247], a[108:111], v[36:39]
    v_mfma_f32_16x16x32_bf16 v[40:43], v[248:251], a[108:111], v[40:43]
    v_mfma_f32_16x16x32_bf16 v[44:47], v[252:255], a[108:111], v[44:47]
    s_nop 7
    v_cmp_u_f32 vcc, v44, v44
    s_add_u32 s59, s59, 1
    s_cmp_lt_u32 s59, 100000
    s_cselect_b64 vcc, vcc, 0
    s_cbranch_vccnz L_rtl0b
    s_branch L_rtok0b
L_rt1b:
    s_waitcnt vmcnt(0) lgkmcnt(0)
    s_mov_b32 s59, 0
L_rtl1b:
    global_load_dwordx4 a[48:51], v11, s[18:19] offset:-4096 sc1
    global_load_dwordx4 a[52:55], v11, s[18:19] offset:-3072 sc1
    global_load_dwordx4 a[60:63], v11, s[18:19] offset:-2048 sc1
    global_load_dwordx4 a[64:67], v11, s[18:19] offset:-1024 sc1
    global_load_dwordx4 a[72:75], v11, s[18:19] offset:0 sc1
    global_load_dwordx4 a[76:79], v11, s[18:19] offset:1024 sc1
    global_load_dwordx4 a[84:87], v11, s[18:19] offset:2048 sc1
    global_load_dwordx4 a[88:91], v11, s[18:19] offset:3072 sc1
    global_load_dwordx4 a[112:115], v12, s[18:19] offset:-4096 sc1
    global_load_dwordx4 a[120:123], v12, s[18:19] offset:-3072 sc1
    global_load_dwordx4 a[124:127], v12, s[18:19] offset:-2048 sc1
    s_waitcnt vmcnt(10)
    v_mfma_f32_16x16x32_bf16 v[48:51], a[192:195], a[48:51], v[76:79]
    v_mfma_f32_16x16x32_bf16 v[52:55], a[196:199], a[48:51], 0
    v_mfma_f32_16x16x32_bf16 v[56:59], a[200:203], a[48:51], 0
    v_mfma_f32_16x16x32_bf16 v[60:63], a[204:207], a[48:51], 0
    s_waitcnt vmcnt(9)
    v_mfma_f32_16x16x32_bf16 v[48:51], a[208:211], a[52:55], v[48:51]
    v_mfma_f32_16x16x32_bf16 v[52:55], a[212:215], a[52:55], v[52:55]
    v_mfma_f32_16x16x32_bf16 v[56:59], a[216:219], a[52:55], v[56:59]
    v_mfma_f32_16x16x32_bf16 v[60:63], a[220:223], a[52:55], v[60:63]
    s_waitcnt vmcnt(8)
    v_mfma_f32_16x16x32_bf16 v[48:51], a[224:227], a[60:63], v[48:51]
    v_mfma_f32_16x16x32_bf16 v[52:55], a[228:231], a[60:63], v[52:55]
    v_mfma_f32_16x16x32_bf16 v[56:59], a[232:235], a[60:63], v[56:59]
    v_mfma_f32_16x16x32_bf16 v[60:63], a[236:239], a[60:63], v[60:63]
    s_waitcnt vmcnt(7)
    v_mfma_f32_16x16x32_bf16 v[48:51], v[128:131], a[64:67], v[48:51]
    v_mfma_f32_16x16x32_bf16 v[52:55], v[132:135], a[64:67], v[52:55]
    v_mfma_f32_16x16x32_bf16 v[56:59], v[136:139], a[64:67], v[56:59]
    v_mfma_f32_16x16x32_bf16 v[60:63], v[140:143], a[64:67], v[60:63]
    s_waitcnt vmcnt(6)
    v_mfma_f32_16x16x32_bf16 v[48:51], v[144:147], a[72:75], v[48:51]
    v_mfma_f32_16x16x32_bf16 v[52:55], v[148:151], a[72:75], v[52:55]
    v_mfma_f32_16x16x32_bf16 v[56:59], v[152:155], a[72:75], v[56:59]
    v_mfma_f32_16x16x32_bf16 v[60:63], v[156:159], a[72:75], v[60:63]
    s_waitcnt vmcnt(5)
    v_mfma_f32_16x16x32_bf16 v[48:51], v[160:163], a[76:79], v[48:51]
    v_mfma_f32_16x16x32_bf16 v[52:55], v[164:167], a[76:79], v[52:55]
    v_mfma_f32_16x16x32_bf16 v[56:59], v[168:171], a[76:79], v[56:59]
    v_mfma_f32_16x16x32_bf16 v[60:63], v[172:175], a[76:79], v[60:63]
    s_waitcnt vmcnt(4)
    v_mfma_f32_16x16x32_bf16 v[48:51], v[176:179], a[84:87], v[48:51]
    v_mfma_f32_16x16x32_bf16 v[52:55], v[180:183], a[84:87], v[52:55]
    v_mfma_f32_16x16x32_bf16 v[56:59], v[184:187], a[84:87], v[56:59]
    v_mfma_f32_16x16x32_bf16 v[60:63], v[188:191], a[84:87], v[60:63]
    s_waitcnt vmcnt(3)
    v_mfma_f32_16x16x32_bf16 v[48:51], v[192:195], a[88:91], v[48:51]
    v_mfma_f32_16x16x32_bf16 v[52:55], v[196:199], a[88:91], v[52:55]
    v_mfma_f32_16x16x32_bf16 v[56:59], v[200:203], a[88:91], v[56:59]
    v_mfma_f32_16x16x32_bf16 v[60:63], v[204:207], a[88:91], v[60:63]
    s_waitcnt vmcnt(2)
    v_mfma_f32_16x16x32_bf16 v[48:51], v[208:211], a[112:115], v[48:51]
    v_mfma_f32_16x16x32_bf16 v[52:55], v[212:215], a[112:115], v[52:55]
    v_mfma_f32_16x16x32_bf16 v[56:59], v[216:219], a[112:115], v[56:59]
    v_mfma_f32_16x16x32_bf16 v[60:63], v[220:223], a[112:115], v[60:63]
    s_waitcnt vmcnt(1)
    v_mfma_f32_16x16x32_bf16 v[48:51], v[224:227], a[120:123], v[48:51]
    v_mfma_f32_16x16x32_bf16 v[52:55], v[228:231], a[120:123], v[52:55]
    v_mfma_f32_16x16x32_bf16 v[56:59], v[232:235], a[120:123], v[56:59]
    v_mfma_f32_16x16x32_bf16 v[60:63], v[236:239], a[120:123], v[60:63]
    s_waitcnt vmcnt(0)
    v_mfma_f32_16x16x32_bf16 v[48:51], v[240:243], a[124:127], v[48:51]
    v_mfma_f32_16x16x32_bf16 v[52:55], v[244:247], a[124:127], v[52:55]
    v_mfma_f32_16x16x32_bf16 v[56:59], v[248:251], a[124:127], v[56:59]
    v_mfma_f32_16x16x32_bf16 v[60:63], v[252:255], a[124:127], v[60:63]
    s_nop 7
    v_cmp_u_f32 vcc, v60, v60
    s_add_u32 s59, s59, 1
    s_cmp_lt_u32 s59, 100000
    s_cselect_b64 vcc, vcc, 0
    s_cbranch_vccnz L_rtl1b
    s_branch L_rtok1b
L_rt2b:
    s_waitcnt vmcnt(0) lgkmcnt(0)
    s_mov_b32 s59, 0
L_rtl2b:
    global_load_dwordx4 a[132:135], v11, s[20:21] offset:-4096 sc1
    global_load_dwordx4 a[136:139], v11, s[20:21] offset:-3072 sc1
    global_load_dwordx4 a[144:147], v11, s[20:21] offset:-2048 sc1
    global_load_dwordx4 a[148:151], v11, s[20:21] offset:-1024 sc1
    global_load_dwordx4 a[156:159], v11, s[20:21] offset:0 sc1
    global_load_dwordx4 a[160:163], v11, s[20:21] offset:1024 sc1
    global_load_dwordx4 a[168:171], v11, s[20:21] offset:2048 sc1
    global_load_dwordx4 a[172:175], v11, s[20:21] offset:3072 sc1
    global_load_dwordx4 a[180:183], v12, s[20:21] offset:-4096 sc1
    global_load_dwordx4 a[184:187], v12, s[20:21] offset:-3072 sc1
    global_load_dwordx4 a[8:11], v12, s[20:21] offset:-2048 sc1
    s_waitcnt vmcnt(10)
    v_mfma_f32_16x16x32_bf16 v[104:107], a[192:195], a[132:135], v[80:83]
    v_mfma_f32_16x16x32_bf16 v[108:111], a[196:199], a[132:135], 0
    v_mfma_f32_16x16x32_bf16 v[112:115], a[200:203], a[132:135], 0
    v_mfma_f32_16x16x32_bf16 v[116:119], a[204:207], a[132:135], 0
    s_waitcnt vmcnt(9)
    v_mfma_f32_16x16x32_bf16 v[104:107], a[208:211], a[136:139], v[104:107]
    v_mfma_f32_16x16x32_bf16 v[108:111], a[212:215], a[136:139], v[108:111]
    v_mfma_f32_16x16x32_bf16 v[112:115], a[216:219], a[136:139], v[112:115]
    v_mfma_f32_16x16x32_bf16 v[116:119], a[220:223], a[136:139], v[116:119]
    s_waitcnt vmcnt(8)
    v_mfma_f32_16x16x32_bf16 v[104:107], a[224:227], a[144:147], v[104:107]
    v_mfma_f32_16x16x32_bf16 v[108:111], a[228:231], a[144:147], v[108:111]
    v_mfma_f32_16x16x32_bf16 v[112:115], a[232:235], a[144:147], v[112:115]
    v_mfma_f32_16x16x32_bf16 v[116:119], a[236:239], a[144:147], v[116:119]
    s_waitcnt vmcnt(7)
    v_mfma_f32_16x16x32_bf16 v[104:107], v[128:131], a[148:151], v[104:107]
    v_mfma_f32_16x16x32_bf16 v[108:111], v[132:135], a[148:151], v[108:111]
    v_mfma_f32_16x16x32_bf16 v[112:115], v[136:139], a[148:151], v[112:115]
    v_mfma_f32_16x16x32_bf16 v[116:119], v[140:143], a[148:151], v[116:119]
    s_waitcnt vmcnt(6)
    v_mfma_f32_16x16x32_bf16 v[104:107], v[144:147], a[156:159], v[104:107]
    v_mfma_f32_16x16x32_bf16 v[108:111], v[148:151], a[156:159], v[108:111]
    v_mfma_f32_16x16x32_bf16 v[112:115], v[152:155], a[156:159], v[112:115]
    v_mfma_f32_16x16x32_bf16 v[116:119], v[156:159], a[156:159], v[116:119]
    s_waitcnt vmcnt(5)
    v_mfma_f32_16x16x32_bf16 v[104:107], v[160:163], a[160:163], v[104:107]
    v_mfma_f32_16x16x32_bf16 v[108:111], v[164:167], a[160:163], v[108:111]
    v_mfma_f32_16x16x32_bf16 v[112:115], v[168:171], a[160:163], v[112:115]
    v_mfma_f32_16x16x32_bf16 v[116:119], v[172:175], a[160:163], v[116:119]
    s_waitcnt vmcnt(4)
    v_mfma_f32_16x16x32_bf16 v[104:107], v[176:179], a[168:171], v[104:107]
    v_mfma_f32_16x16x32_bf16 v[108:111], v[180:183], a[168:171], v[108:111]
    v_mfma_f32_16x16x32_bf16 v[112:115], v[184:187], a[168:171], v[112:115]
    v_mfma_f32_16x16x32_bf16 v[116:119], v[188:191], a[168:171], v[116:119]
    s_waitcnt vmcnt(3)
    v_mfma_f32_16x16x32_bf16 v[104:107], v[192:195], a[172:175], v[104:107]
    v_mfma_f32_16x16x32_bf16 v[108:111], v[196:199], a[172:175], v[108:111]
    v_mfma_f32_16x16x32_bf16 v[112:115], v[200:203], a[172:175], v[112:115]
    v_mfma_f32_16x16x32_bf16 v[116:119], v[204:207], a[172:175], v[116:119]
    s_waitcnt vmcnt(2)
    v_mfma_f32_16x16x32_bf16 v[104:107], v[208:211], a[180:183], v[104:107]
    v_mfma_f32_16x16x32_bf16 v[108:111], v[212:215], a[180:183], v[108:111]
    v_mfma_f32_16x16x32_bf16 v[112:115], v[216:219], a[180:183], v[112:115]
    v_mfma_f32_16x16x32_bf16 v[116:119], v[220:223], a[180:183], v[116:119]
    s_waitcnt vmcnt(1)
    v_mfma_f32_16x16x32_bf16 v[104:107], v[224:227], a[184:187], v[104:107]
    v_mfma_f32_16x16x32_bf16 v[108:111], v[228:231], a[184:187], v[108:111]
    v_mfma_f32_16x16x32_bf16 v[112:115], v[232:235], a[184:187], v[112:115]
    v_mfma_f32_16x16x32_bf16 v[116:119], v[236:239], a[184:187], v[116:119]
    s_waitcnt vmcnt(0)
    v_mfma_f32_16x16x32_bf16 v[104:107], v[240:243], a[8:11], v[104:107]
    v_mfma_f32_16x16x32_bf16 v[108:111], v[244:247], a[8:11], v[108:111]
    v_mfma_f32_16x16x32_bf16 v[112:115], v[248:251], a[8:11], v[112:115]
    v_mfma_f32_16x16x32_bf16 v[116:119], v[252:255], a[8:11], v[116:119]
    s_nop 7
    v_cmp_u_f32 vcc, v116, v116
    s_add_u32 s59, s59, 1
    s_cmp_lt_u32 s59, 100000
    s_cselect_b64 vcc, vcc, 0
    s_cbranch_vccnz L_rtl2b
    s_branch L_rtok2b
L_rt3b:
    s_waitcnt vmcnt(0) lgkmcnt(0)
    s_mov_b32 s59, 0
L_rtl3b:
    global_load_dwordx4 a[20:23], v11, s[22:23] offset:-4096 sc1
    global_load_dwordx4 a[32:35], v11, s[22:23] offset:-3072 sc1
    global_load_dwordx4 a[44:47], v11, s[22:23] offset:-2048 sc1
    global_load_dwordx4 a[56:59], v11, s[22:23] offset:-1024 sc1
    global_load_dwordx4 a[68:71], v11, s[22:23] offset:0 sc1
    global_load_dwordx4 a[80:83], v11, s[22:23] offset:1024 sc1
    global_load_dwordx4 a[92:95], v11, s[22:23] offset:2048 sc1
    global_load_dwordx4 a[104:107], v11, s[22:23] offset:3072 sc1
    global_load_dwordx4 a[116:119], v12, s[22:23] offset:-4096 sc1
    global_load_dwordx4 a[128:131], v12, s[22:23] offset:-3072 sc1
    global_load_dwordx4 a[140:143], v12, s[22:23] offset:-2048 sc1
    s_waitcnt vmcnt(10)
    v_mfma_f32_16x16x32_bf16 v[32:35], a[192:195], a[20:23], v[84:87]
    v_mfma_f32_16x16x32_bf16 v[36:39], a[196:199], a[20:23], 0
    v_mfma_f32_16x16x32_bf16 v[40:43], a[200:203], a[20:23], 0
    v_mfma_f32_16x16x32_bf16 v[44:47], a[204:207], a[20:23], 0
    s_waitcnt vmcnt(9)
    v_mfma_f32_16x16x32_bf16 v[32:35], a[208:211], a[32:35], v[32:35]
    v_mfma_f32_16x16x32_bf16 v[36:39], a[212:215], a[32:35], v[36:39]
    v_mfma_f32_16x16x32_bf16 v[40:43], a[216:219], a[32:35], v[40:43]
    v_mfma_f32_16x16x32_bf16 v[44:47], a[220:223], a[32:35], v[44:47]
    s_waitcnt vmcnt(8)
    v_mfma_f32_16x16x32_bf16 v[32:35], a[224:227], a[44:47], v[32:35]
    v_mfma_f32_16x16x32_bf16 v[36:39], a[228:231], a[44:47], v[36:39]
    v_mfma_f32_16x16x32_bf16 v[40:43], a[232:235], a[44:47], v[40:43]
    v_mfma_f32_16x16x32_bf16 v[44:47], a[236:239], a[44:47], v[44:47]
    s_waitcnt vmcnt(7)
    v_mfma_f32_16x16x32_bf16 v[32:35], v[128:131], a[56:59], v[32:35]
    v_mfma_f32_16x16x32_bf16 v[36:39], v[132:135], a[56:59], v[36:39]
    v_mfma_f32_16x16x32_bf16 v[40:43], v[136:139], a[56:59], v[40:43]
    v_mfma_f32_16x16x32_bf16 v[44:47], v[140:143], a[56:59], v[44:47]
    s_waitcnt vmcnt(6)
    v_mfma_f32_16x16x32_bf16 v[32:35], v[144:147], a[68:71], v[32:35]
    v_mfma_f32_16x16x32_bf16 v[36:39], v[148:151], a[68:71], v[36:39]
    v_mfma_f32_16x16x32_bf16 v[40:43], v[152:155], a[68:71], v[40:43]
    v_mfma_f32_16x16x32_bf16 v[44:47], v[156:159], a[68:71], v[44:47]
    s_waitcnt vmcnt(5)
    v_mfma_f32_16x16x32_bf16 v[32:35], v[160:163], a[80:83], v[32:35]
    v_mfma_f32_16x16x32_bf16 v[36:39], v[164:167], a[80:83], v[36:39]
    v_mfma_f32_16x16x32_bf16 v[40:43], v[168:171], a[80:83], v[40:43]
    v_mfma_f32_16x16x32_bf16 v[44:47], v[172:175], a[80:83], v[44:47]
    s_waitcnt vmcnt(4)
    v_mfma_f32_16x16x32_bf16 v[32:35], v[176:179], a[92:95], v[32:35]
    v_mfma_f32_16x16x32_bf16 v[36:39], v[180:183], a[92:95], v[36:39]
    v_mfma_f32_16x16x32_bf16 v[40:43], v[184:187], a[92:95], v[40:43]
    v_mfma_f32_16x16x32_bf16 v[44:47], v[188:191], a[92:95], v[44:47]
    s_waitcnt vmcnt(3)
    v_mfma_f32_16x16x32_bf16 v[32:35], v[192:195], a[104:107], v[32:35]
    v_mfma_f32_16x16x32_bf16 v[36:39], v[196:199], a[104:107], v[36:39]
    v_mfma_f32_16x16x32_bf16 v[40:43], v[200:203], a[104:107], v[40:43]
    v_mfma_f32_16x16x32_bf16 v[44:47], v[204:207], a[104:107], v[44:47]
    s_waitcnt vmcnt(2)
    v_mfma_f32_16x16x32_bf16 v[32:35], v[208:211], a[116:119], v[32:35]
    v_mfma_f32_16x16x32_bf16 v[36:39], v[212:215], a[116:119], v[36:39]
    v_mfma_f32_16x16x32_bf16 v[40:43], v[216:219], a[116:119], v[40:43]
    v_mfma_f32_16x16x32_bf16 v[44:47], v[220:223], a[116:119], v[44:47]
    s_waitcnt vmcnt(1)
    v_mfma_f32_16x16x32_bf16 v[32:35], v[224:227], a[128:131], v[32:35]
    v_mfma_f32_16x16x32_bf16 v[36:39], v[228:231], a[128:131], v[36:39]
    v_mfma_f32_16x16x32_bf16 v[40:43], v[232:235], a[128:131], v[40:43]
    v_mfma_f32_16x16x32_bf16 v[44:47], v[236:239], a[128:131], v[44:47]
    s_waitcnt vmcnt(0)
    v_mfma_f32_16x16x32_bf16 v[32:35], v[240:243], a[140:143], v[32:35]
    v_mfma_f32_16x16x32_bf16 v[36:39], v[244:247], a[140:143], v[36:39]
    v_mfma_f32_16x16x32_bf16 v[40:43], v[248:251], a[140:143], v[40:43]
    v_mfma_f32_16x16x32_bf16 v[44:47], v[252:255], a[140:143], v[44:47]
    s_nop 7
    v_cmp_u_f32 vcc, v44, v44
    s_add_u32 s59, s59, 1
    s_cmp_lt_u32 s59, 100000
    s_cselect_b64 vcc, vcc, 0
    s_cbranch_vccnz L_rtl3b
    ds_write_b128 v16, v[32:35] offset:49152
    ds_write_b128 v17, v[36:39] offset:49152
    ds_write_b128 v18, v[40:43] offset:49152
    s_branch L_rtok3b
.section .rodata,"a"
.p2align 6
.amdhsa_kernel sequential_preLN__ssm_conv_s4d__geglu_ffn__prompt_kernel
  .amdhsa_next_free_vgpr 512
  .amdhsa_next_free_sgpr 102
  .amdhsa_accum_offset 256
  .amdhsa_group_segment_fixed_size 0
  .amdhsa_kernarg_size 112
  .amdhsa_user_sgpr_count 2
  .amdhsa_user_sgpr_kernarg_segment_ptr 1
  .amdhsa_system_sgpr_workgroup_id_x 1
  .amdhsa_float_denorm_mode_32 3
.end_amdhsa_kernel
```
